```python
import torch

def _softmax(x, axis=-1):
    return torch.softmax(x, dim=axis)
def _gelu(x):
    return torch.nn.functional.gelu(x, approximate="tanh")
def _silu(x):
    return torch.nn.functional.silu(x)
def _sigmoid(x):
    return torch.sigmoid(x)
def _layernorm(x, axis=-1, eps=1e-5):
    m = x.mean(dim=axis, keepdim=True)
    v = x.var(dim=axis, keepdim=True, unbiased=False)
    return (x - m) / torch.sqrt(v + eps)
def _scatter_add(tgt, idx, src, axis=0):
    return tgt.clone().index_add_(axis, idx, src)
def _segment_sum(src, seg, n):
    out = torch.zeros((n,) + src.shape[1:], dtype=src.dtype)
    return out.index_add_(0, seg, src)
def _pad(x, pw):
    flat = tuple(v for pair in reversed(pw) for v in pair)
    return torch.nn.functional.pad(x, flat)

kernel_name = 'recurrent_scan__linear_attn_block__swiglu_ffn__prompt'

def setup_inputs():

    _w = (lambda a: (lambda t: t.to(torch.bfloat16) if t.is_floating_point() else t)(torch.as_tensor(a)))
    def _A_setup():
        B, S, D = 1, 2048, 1024
        return {
            "x": _w((lambda *s: torch.randn(*s, dtype=torch.bfloat16) * 0.05)(B, S, D)),
            "wqkv": _w((lambda *s: torch.randn(*s, dtype=torch.bfloat16) * 0.1)(D, 3 * D)),
            "wo": _w((lambda *s: torch.randn(*s, dtype=torch.bfloat16) * 0.05)(D, D)),
        }
    _A_in = _A_setup()

    def _B_setup():
        B, S, D, F = 1, 2048, 1024, 3584
        return {
            "x": _w((lambda *s: torch.randn(*s, dtype=torch.bfloat16) * 0.05)(B, S, D)),
            "w_gate": _w((lambda *s: torch.randn(*s, dtype=torch.bfloat16) * 0.05)(D, F)),
            "w_up": _w((lambda *s: torch.randn(*s, dtype=torch.bfloat16) * 0.05)(D, F)),
            "w_down": _w((lambda *s: torch.randn(*s, dtype=torch.bfloat16) * 0.05)(F, D)),
        }
    _B_in = _B_setup()

    return {
        "A_x": _A_in["x"],
        "A_wqkv": _A_in["wqkv"],
        "A_wo": _A_in["wo"],
        "B_x": _B_in["x"],
        "B_w_gate": _B_in["w_gate"],
        "B_w_up": _B_in["w_up"],
        "B_w_down": _B_in["w_down"],
    }

def reference(A_x, A_wqkv, A_wo, B_x, B_w_gate, B_w_up, B_w_down):
    def _A_ref(x, wqkv, wo):
        B, S, D = x.shape
        H = 32; Dh = D // H
        qkv = (lambda x, *d: x.permute(*d))((x @ wqkv).reshape(B, S, 3, H, Dh), 2, 0, 3, 1, 4)
        q, k, v = qkv[0], qkv[1], qkv[2]
        phi = lambda t: torch.where(t > 0, t + 1, torch.exp(t)) + 1e-6
        pq, pk = phi(q), phi(k)
        kv = torch.einsum("bhsd,bhse->bhde", pk, v)
        z = torch.einsum("bhsd->bhd", pk)
        num = torch.einsum("bhqd,bhde->bhqe", pq, kv)
        den = torch.einsum("bhqd,bhd->bhq", pq, z)[..., None] + 1e-6
        o = num / den
        return (lambda x, *d: x.permute(*d))(o, 0, 2, 1, 3).reshape(B, S, D) @ wo

    def _B_ref(x, w_gate, w_up, w_down):
        g = _silu(x @ w_gate)
        u = x @ w_up
        return (g * u) @ w_down

    x = A_x
    xn = _layernorm(x, axis=-1)
    s = _A_ref(xn, A_wqkv, A_wo)
    g = _silu(_B_ref(xn, B_w_gate, B_w_up, B_w_down))
    return x + s * g
```

```asm
; @launch grid=(256,1,1) block=(256,1,1) lds=162816
.amdgcn_target "amdgcn-amd-amdhsa--gfx950"
.text
.globl recurrent_scan__linear_attn_block__swiglu_ffn__prompt_kernel
.p2align 8
.type recurrent_scan__linear_attn_block__swiglu_ffn__prompt_kernel,@function
recurrent_scan__linear_attn_block__swiglu_ffn__prompt_kernel:
    s_cmp_ge_u32 s2, 256
    s_cbranch_scc1 M_end
    s_load_dwordx4 s[68:71], s[0:1], 0
    s_load_dwordx4 s[8:11], s[0:1], 32
    s_load_dwordx4 s[12:15], s[0:1], 64
    s_load_dwordx2 s[84:85], s[0:1], 16
    s_load_dwordx2 s[40:41], s[0:1], 48
    s_getpc_b64 s[66:67]
    s_and_b32 s66, s66, 0xffffff00
    s_bfe_u32 s64, s2, 0x30003
    s_lshl_b32 s64, s64, 12
    v_lshrrev_b32 v14, 3, v0
    v_lshlrev_b32 v14, 7, v14
    v_add_u32 v14, s64, v14
    global_load_dword v23, v14, s[66:67]
    v_lshrrev_b32 v14, 6, v0
    v_and_b32 v0, 63, v0
    v_readfirstlane_b32 s48, v14
    s_and_b32 s64, s2, 7
    s_lshr_b32 s65, s2, 3
    s_and_b32 s50, s65, 7
    s_lshr_b32 s65, s65, 3
    s_lshl_b32 s49, s64, 2
    s_add_u32 s49, s49, s65
    v_lshlrev_b32 v13, 4, v0
    s_lshl_b32 s90, s50, 5
    s_add_u32 s90, s90, s49
    v_and_b32 v112, 7, v0
    v_lshrrev_b32 v113, 3, v0
    v_lshlrev_b32 v114, 11, v112
    v_lshl_add_u32 v114, v113, 4, v114
    s_lshl_b32 s64, s90, 14
    s_lshl_b32 s65, s48, 9
    s_add_u32 s64, s64, s65
    v_add_u32 v114, s64, v114
    s_waitcnt lgkmcnt(0)
    s_mov_b32 s16, s68
    s_mov_b32 s17, s69
    s_mov_b32 s18, 0x400000
    s_mov_b32 s19, 0x00020000
    buffer_load_dwordx4 v[32:35], v114, s[16:19], 0 offen offset:0 nt
    buffer_load_dwordx4 v[36:39], v114, s[16:19], 0 offen offset:128 nt
    buffer_load_dwordx4 v[40:43], v114, s[16:19], 0 offen offset:256 nt
    buffer_load_dwordx4 v[44:47], v114, s[16:19], 0 offen offset:384 nt
    v_and_b32 v118, 0xfffff800, v114
    buffer_load_ushort v119, v118, s[16:19], 0 offen
    s_mov_b32 s4, s70
    s_mov_b32 s5, s71
    s_add_u32 s92, s14, 0x2800000
    s_addc_u32 s93, s15, 0
    s_mov_b32 s94, 0x1080
    s_mov_b32 s95, 0x00020000
    s_mov_b32 s64, 4096
    buffer_load_dword v18, off, s[92:95], s64 sc1
    s_lshr_b32 s64, s2, 3
    s_lshl_b32 s64, s64, 2
    s_add_u32 s64, s64, s48
    s_lshl_b32 s64, s64, 1
    s_and_b32 s65, s2, 7
    s_mul_i32 s66, s64, 7168
    s_mul_i32 s67, s65, 896
    s_add_u32 s66, s66, s67
    s_mul_i32 s67, s64, 6144
    s_lshl_b32 s65, s65, 8
    s_add_u32 s67, s67, s65
    v_cmp_le_u32 vcc, 7, v0
    v_lshlrev_b32 v21, 7, v0
    v_mov_b32 v14, 6272
    v_cndmask_b32 v14, 0, v14, vcc
    v_add3_u32 v21, v21, v14, s66
    v_cmp_le_u32 vcc, 14, v0
    v_mov_b32 v14, 0x70000000
    v_lshrrev_b32 v15, 1, v0
    v_cndmask_b32 v21, v21, v14, vcc
    v_and_b32 v20, 1, v0
    v_lshlrev_b32 v20, 7, v20
    v_lshl_add_u32 v20, v15, 11, v20
    v_cmp_le_u32 vcc, 12, v0
    v_add_u32 v20, s67, v20
    s_mov_b32 s88, 0
    v_cndmask_b32 v20, v20, v14, vcc
    s_mov_b32 s89, 0
    s_mov_b32 s76, s4
    s_mov_b32 s77, s5
    s_mov_b32 s78, 0x600000
    s_mov_b32 s79, 0x00020000
    s_mov_b32 s80, s8
    s_mov_b32 s81, s9
    s_mov_b32 s82, 0x700000
    s_mov_b32 s83, 0x00020000
    s_mov_b32 s44, s10
    s_mov_b32 s45, s11
    s_mov_b32 s46, 0x700000
    s_mov_b32 s47, 0x00020000
    s_lshr_b32 s13, s2, 3
    s_lshl_b32 s13, s13, 2
    s_add_u32 s13, s13, s48
    s_sub_u32 s13, 0, s13
    s_mul_i32 s88, s13, 6144
    s_mul_i32 s89, s13, 7168
    v_mov_b32 v14, 0x70000000
    v_cmp_le_u32 vcc, 7, v0
    s_nop 1
    v_cndmask_b32 v21, v21, v14, vcc
    v_cmp_le_u32 vcc, 6, v0
    s_nop 1
    v_cndmask_b32 v20, v20, v14, vcc
    v_add_u32 v20, s88, v20
    v_add_u32 v21, s89, v21
    s_mov_b32 s88, 0
    s_mov_b32 s89, 0
    v_lshrrev_b32 v120, 4, v0
    v_bfe_u32 v121, v0, 2, 2
    v_lshl_add_u32 v122, v120, 3, v121
    v_mul_u32_u24 v122, 6144, v122
    v_bfe_u32 v123, v0, 1, 1
    v_and_b32 v124, 1, v120
    v_xor_b32 v123, v123, v124
    v_lshl_add_u32 v122, v123, 5, v122
    v_and_b32 v123, 1, v0
    v_lshl_add_u32 v122, v123, 4, v122
    s_mul_i32 s66, s48, 5
    s_and_b32 s67, s49, 1
    s_lshl_b32 s67, s67, 1
    s_mul_i32 s68, s49, 224
    s_add_u32 s69, s66, 0
    s_cmp_lt_u32 s69, 6
    s_cbranch_scc0 M_gu0
    s_lshr_b32 s70, s69, 1
    s_lshl_b32 s70, s70, 11
    s_and_b32 s71, s69, 1
    s_mul_i32 s71, s71, 24576
    s_add_u32 s70, s70, s71
    s_lshl_b32 s71, s49, 6
    s_add_u32 s70, s70, s71
    v_add_u32 v2, s70, v122
    s_mov_b32 s20, s4
    s_mov_b32 s21, s5
    s_mov_b32 s22, 6291456
    s_mov_b32 s54, 196608
    s_branch M_dn0
M_gu0:
    s_sub_u32 s70, s69, 6
    s_sub_u32 s71, s69, 13
    s_cmp_lt_u32 s69, 13
    s_cselect_b32 s70, s70, s71
    s_cselect_b32 s20, s8, s10
    s_cselect_b32 s21, s9, s11
    s_mov_b32 s22, 7340032
    s_mov_b32 s54, 229376
    s_lshl_b32 s70, s70, 6
    v_add_u32 v123, s70, v0
    v_mul_u32_u24 v124, 4682, v123
    v_lshrrev_b32 v124, 16, v124
    v_mul_u32_u24 v125, 14, v124
    v_sub_u32 v125, v123, v125
    v_add_u32 v125, s67, v125
    v_subrev_u32 v126, 14, v125
    v_min_u32 v125, v125, v126
    v_bfe_u32 v126, v124, 2, 2
    v_lshrrev_b32 v127, 4, v124
    v_and_b32 v124, 3, v124
    v_lshl_add_u32 v124, v126, 3, v124
    v_lshl_add_u32 v124, v127, 2, v124
    v_mul_u32_u24 v124, 7168, v124
    v_lshl_add_u32 v124, v125, 4, v124
    v_add_u32 v2, s68, v124
M_dn0:
    s_mov_b32 s23, 0x00020000
    s_add_u32 s69, s66, 1
    s_cmp_lt_u32 s69, 6
    s_cbranch_scc0 M_gu1
    s_lshr_b32 s70, s69, 1
    s_lshl_b32 s70, s70, 11
    s_and_b32 s71, s69, 1
    s_mul_i32 s71, s71, 24576
    s_add_u32 s70, s70, s71
    s_lshl_b32 s71, s49, 6
    s_add_u32 s70, s70, s71
    v_add_u32 v3, s70, v122
    s_mov_b32 s24, s4
    s_mov_b32 s25, s5
    s_mov_b32 s26, 6291456
    s_mov_b32 s55, 196608
    s_branch M_dn1
M_gu1:
    s_sub_u32 s70, s69, 6
    s_sub_u32 s71, s69, 13
    s_cmp_lt_u32 s69, 13
    s_cselect_b32 s70, s70, s71
    s_cselect_b32 s24, s8, s10
    s_cselect_b32 s25, s9, s11
    s_mov_b32 s26, 7340032
    s_mov_b32 s55, 229376
    s_lshl_b32 s70, s70, 6
    v_add_u32 v123, s70, v0
    v_mul_u32_u24 v124, 4682, v123
    v_lshrrev_b32 v124, 16, v124
    v_mul_u32_u24 v125, 14, v124
    v_sub_u32 v125, v123, v125
    v_add_u32 v125, s67, v125
    v_subrev_u32 v126, 14, v125
    v_min_u32 v125, v125, v126
    v_bfe_u32 v126, v124, 2, 2
    v_lshrrev_b32 v127, 4, v124
    v_and_b32 v124, 3, v124
    v_lshl_add_u32 v124, v126, 3, v124
    v_lshl_add_u32 v124, v127, 2, v124
    v_mul_u32_u24 v124, 7168, v124
    v_lshl_add_u32 v124, v125, 4, v124
    v_add_u32 v3, s68, v124
M_dn1:
    s_mov_b32 s27, 0x00020000
    s_add_u32 s69, s66, 2
    s_cmp_lt_u32 s69, 6
    s_cbranch_scc0 M_gu2
    s_lshr_b32 s70, s69, 1
    s_lshl_b32 s70, s70, 11
    s_and_b32 s71, s69, 1
    s_mul_i32 s71, s71, 24576
    s_add_u32 s70, s70, s71
    s_lshl_b32 s71, s49, 6
    s_add_u32 s70, s70, s71
    v_add_u32 v4, s70, v122
    s_mov_b32 s28, s4
    s_mov_b32 s29, s5
    s_mov_b32 s30, 6291456
    s_mov_b32 s55, 196608
    s_branch M_dn2
M_gu2:
    s_sub_u32 s70, s69, 6
    s_sub_u32 s71, s69, 13
    s_cmp_lt_u32 s69, 13
    s_cselect_b32 s70, s70, s71
    s_cselect_b32 s28, s8, s10
    s_cselect_b32 s29, s9, s11
    s_mov_b32 s30, 7340032
    s_mov_b32 s55, 229376
    s_lshl_b32 s70, s70, 6
    v_add_u32 v123, s70, v0
    v_mul_u32_u24 v124, 4682, v123
    v_lshrrev_b32 v124, 16, v124
    v_mul_u32_u24 v125, 14, v124
    v_sub_u32 v125, v123, v125
    v_add_u32 v125, s67, v125
    v_subrev_u32 v126, 14, v125
    v_min_u32 v125, v125, v126
    v_bfe_u32 v126, v124, 2, 2
    v_lshrrev_b32 v127, 4, v124
    v_and_b32 v124, 3, v124
    v_lshl_add_u32 v124, v126, 3, v124
    v_lshl_add_u32 v124, v127, 2, v124
    v_mul_u32_u24 v124, 7168, v124
    v_lshl_add_u32 v124, v125, 4, v124
    v_add_u32 v4, s68, v124
M_dn2:
    s_mov_b32 s31, 0x00020000
    s_add_u32 s69, s66, 3
    s_cmp_lt_u32 s69, 6
    s_cbranch_scc0 M_gu3
    s_lshr_b32 s70, s69, 1
    s_lshl_b32 s70, s70, 11
    s_and_b32 s71, s69, 1
    s_mul_i32 s71, s71, 24576
    s_add_u32 s70, s70, s71
    s_lshl_b32 s71, s49, 6
    s_add_u32 s70, s70, s71
    v_add_u32 v5, s70, v122
    s_mov_b32 s32, s4
    s_mov_b32 s33, s5
    s_mov_b32 s34, 6291456
    s_mov_b32 s55, 196608
    s_branch M_dn3
M_gu3:
    s_sub_u32 s70, s69, 6
    s_sub_u32 s71, s69, 13
    s_cmp_lt_u32 s69, 13
    s_cselect_b32 s70, s70, s71
    s_cselect_b32 s32, s8, s10
    s_cselect_b32 s33, s9, s11
    s_mov_b32 s34, 7340032
    s_mov_b32 s55, 229376
    s_lshl_b32 s70, s70, 6
    v_add_u32 v123, s70, v0
    v_mul_u32_u24 v124, 4682, v123
    v_lshrrev_b32 v124, 16, v124
    v_mul_u32_u24 v125, 14, v124
    v_sub_u32 v125, v123, v125
    v_add_u32 v125, s67, v125
    v_subrev_u32 v126, 14, v125
    v_min_u32 v125, v125, v126
    v_bfe_u32 v126, v124, 2, 2
    v_lshrrev_b32 v127, 4, v124
    v_and_b32 v124, 3, v124
    v_lshl_add_u32 v124, v126, 3, v124
    v_lshl_add_u32 v124, v127, 2, v124
    v_mul_u32_u24 v124, 7168, v124
    v_lshl_add_u32 v124, v125, 4, v124
    v_add_u32 v5, s68, v124
M_dn3:
    s_mov_b32 s35, 0x00020000
    s_add_u32 s69, s66, 4
    s_cmp_lt_u32 s69, 6
    s_cbranch_scc0 M_gu4
    s_lshr_b32 s70, s69, 1
    s_lshl_b32 s70, s70, 11
    s_and_b32 s71, s69, 1
    s_mul_i32 s71, s71, 24576
    s_add_u32 s70, s70, s71
    s_lshl_b32 s71, s49, 6
    s_add_u32 s70, s70, s71
    v_add_u32 v6, s70, v122
    s_mov_b32 s36, s4
    s_mov_b32 s37, s5
    s_mov_b32 s38, 6291456
    s_mov_b32 s55, 196608
    s_branch M_dn4
M_gu4:
    s_sub_u32 s70, s69, 6
    s_sub_u32 s71, s69, 13
    s_cmp_lt_u32 s69, 13
    s_cselect_b32 s70, s70, s71
    s_cselect_b32 s36, s8, s10
    s_cselect_b32 s37, s9, s11
    s_mov_b32 s38, 7340032
    s_mov_b32 s55, 229376
    s_lshl_b32 s70, s70, 6
    v_add_u32 v123, s70, v0
    v_mul_u32_u24 v124, 4682, v123
    v_lshrrev_b32 v124, 16, v124
    v_mul_u32_u24 v125, 14, v124
    v_sub_u32 v125, v123, v125
    v_add_u32 v125, s67, v125
    v_subrev_u32 v126, 14, v125
    v_min_u32 v125, v125, v126
    v_bfe_u32 v126, v124, 2, 2
    v_lshrrev_b32 v127, 4, v124
    v_and_b32 v124, 3, v124
    v_lshl_add_u32 v124, v126, 3, v124
    v_lshl_add_u32 v124, v127, 2, v124
    v_mul_u32_u24 v124, 7168, v124
    v_lshl_add_u32 v124, v125, 4, v124
    v_add_u32 v6, s68, v124
M_dn4:
    s_mov_b32 s39, 0x00020000
    s_mov_b32 s8, s16
    s_mov_b32 s9, s17
    s_lshr_b32 s64, s90, 1
    s_lshl_b32 s64, s64, 10
    s_and_b32 s65, s90, 1
    s_lshl_b32 s65, s65, 7
    s_add_u32 s64, s64, s65
    s_lshl_b32 s65, s48, 20
    s_add_u32 s64, s64, s65
    v_lshrrev_b32 v115, 2, v113
    v_lshlrev_b32 v115, 17, v115
    v_and_b32 v116, 3, v113
    v_lshl_add_u32 v115, v116, 8, v115
    v_lshl_add_u32 v115, v112, 4, v115
    v_add_u32 v115, s64, v115
    v_lshlrev_b32 v117, 6, v112
    v_add_u32 v117, 122880, v117
    s_lshl_b32 s64, s48, 4
    v_lshl_add_u32 v116, v120, 2, v117
    v_add_u32 v116, s64, v116
    s_mov_b32 s16, s14
    s_mov_b32 s17, s15
    s_mov_b32 s18, 0x400000
    s_mov_b32 s19, 0x00020000
    s_lshr_b32 s90, s2, 3
    s_mul_i32 s90, s90, 128
    s_and_b32 s64, s2, 7
    s_lshl_b32 s64, s64, 4
    s_add_u32 s90, s90, s64
    s_mov_b32 s51, 0
    s_mul_i32 s62, s48, 5120
    s_sub_u32 s62, s62, 1024
    s_mov_b32 s56, s62
    s_mov_b32 s52, 0
    s_mov_b32 s53, 0
    s_mov_b32 s59, 20480
    s_lshl_b32 s64, s50, 14
    s_lshl_b32 s65, s48, 12
    s_add_u32 s64, s64, s65
    v_add_u32 v1, s64, v13
    s_lshl_b32 s64, s50, 3
    v_and_b32 v17, 7, v0
    v_bfe_u32 v123, v0, 3, 2
    v_lshl_add_u32 v17, v123, 6, v17
    v_add_u32 v17, s64, v17
    v_and_b32 v14, 7, v17
    v_lshrrev_b32 v17, 3, v17
    v_mul_u32_u24 v17, 128, v17
    v_lshl_add_u32 v17, v14, 4, v17
    v_lshrrev_b32 v123, 2, v0
    v_and_b32 v124, 3, v0
    v_lshlrev_b32 v124, 3, v124
    v_lshl_add_u32 v10, v123, 6, v124
    v_and_b32 v125, 1, v120
    v_lshl_add_u32 v10, v125, 5, v10
    v_xor_b32 v11, 32, v10
    v_mul_u32_u24 v12, 224, v123
    v_add_u32 v12, v12, v124
    v_mov_b32 v7, v10
    v_mov_b32 v8, v11
    v_mov_b32 v9, v12
    s_mov_b32 s57, 0
    s_mov_b32 s58, 0
    s_mov_b32 s60, 122880
    s_add_u32 s61, s62, s60
    s_lshl_b32 s64, s2, 2
    s_add_u32 s64, s64, s48
    s_lshl_b32 s64, s64, 10
    v_add_u32 v16, s64, v13
    v_lshrrev_b32 v123, 3, v0
    v_and_b32 v124, 7, v0
    v_xor_b32 v124, v124, v123
    v_lshlrev_b32 v123, 11, v123
    v_lshl_add_u32 v22, v124, 4, v123
    s_lshl_b32 s66, s48, 14
    s_and_b32 s67, s2, 15
    s_lshl_b32 s67, s67, 7
    s_add_u32 s66, s66, s67
    s_lshr_b32 s65, s2, 4
    s_mul_i32 s64, s65, 7
    s_add_u32 s63, s64, 1
    s_lshr_b32 s63, s63, 1
    s_lshl_b32 s63, s63, 16
    s_add_u32 s63, s63, s66
    s_add_u32 s64, s64, 3
    s_lshl_b32 s64, s64, 16
    s_add_u32 s64, s64, s67
    s_lshl_b32 s65, s65, 16
    s_add_u32 s65, s65, s66
    s_add_u32 s66, s65, 0x100000
    s_mov_b32 s3, 0xffe00000
    s_mov_b32 s42, 7340032
    s_mov_b32 s43, 0x00020000
    s_waitcnt vmcnt(5)
    v_lshlrev_b32 v48, 16, v32
    v_and_b32 v49, 0xffff0000, v32
    v_lshlrev_b32 v50, 16, v33
    v_and_b32 v51, 0xffff0000, v33
    v_lshlrev_b32 v52, 16, v34
    v_and_b32 v53, 0xffff0000, v34
    v_lshlrev_b32 v54, 16, v35
    v_and_b32 v55, 0xffff0000, v35
    s_waitcnt vmcnt(4)
    v_lshlrev_b32 v56, 16, v36
    v_and_b32 v57, 0xffff0000, v36
    v_lshlrev_b32 v58, 16, v37
    v_and_b32 v59, 0xffff0000, v37
    v_lshlrev_b32 v60, 16, v38
    v_and_b32 v61, 0xffff0000, v38
    v_lshlrev_b32 v62, 16, v39
    v_and_b32 v63, 0xffff0000, v39
    s_waitcnt vmcnt(3)
    v_lshlrev_b32 v64, 16, v40
    v_and_b32 v65, 0xffff0000, v40
    v_lshlrev_b32 v66, 16, v41
    v_and_b32 v67, 0xffff0000, v41
    v_lshlrev_b32 v68, 16, v42
    v_and_b32 v69, 0xffff0000, v42
    v_lshlrev_b32 v70, 16, v43
    v_and_b32 v71, 0xffff0000, v43
    s_waitcnt vmcnt(2)
    v_lshlrev_b32 v72, 16, v44
    v_and_b32 v73, 0xffff0000, v44
    v_lshlrev_b32 v74, 16, v45
    v_and_b32 v75, 0xffff0000, v45
    v_lshlrev_b32 v76, 16, v46
    v_and_b32 v77, 0xffff0000, v46
    v_lshlrev_b32 v78, 16, v47
    v_and_b32 v79, 0xffff0000, v47
    s_waitcnt vmcnt(1)
    buffer_load_dword v23, v20, s[76:79], s88 offen
    buffer_load_dword v23, v21, s[80:83], s89 offen
    buffer_load_dword v23, v21, s[44:47], s89 offen
    s_add_u32 s88, s88, 786432
    s_add_u32 s89, s89, 917504
    v_lshlrev_b32 v119, 16, v119
    v_sub_f32 v84, 0, v119
    v_mov_b32 v85, v84
    v_pk_add_f32 v[80:81], v[48:49], v[84:85]
    v_pk_add_f32 v[82:83], v[50:51], v[84:85]
    v_pk_mul_f32 v[108:109], v[80:81], v[80:81]
    v_pk_mul_f32 v[110:111], v[82:83], v[82:83]
    v_pk_add_f32 v[104:105], v[52:53], v[84:85]
    v_pk_add_f32 v[106:107], v[54:55], v[84:85]
    v_pk_fma_f32 v[108:109], v[104:105], v[104:105], v[108:109]
    v_pk_fma_f32 v[110:111], v[106:107], v[106:107], v[110:111]
    v_pk_add_f32 v[80:81], v[80:81], v[104:105]
    v_pk_add_f32 v[82:83], v[82:83], v[106:107]
    v_pk_add_f32 v[104:105], v[56:57], v[84:85]
    v_pk_add_f32 v[106:107], v[58:59], v[84:85]
    v_pk_fma_f32 v[108:109], v[104:105], v[104:105], v[108:109]
    v_pk_fma_f32 v[110:111], v[106:107], v[106:107], v[110:111]
    v_pk_add_f32 v[80:81], v[80:81], v[104:105]
    v_pk_add_f32 v[82:83], v[82:83], v[106:107]
    v_pk_add_f32 v[104:105], v[60:61], v[84:85]
    v_pk_add_f32 v[106:107], v[62:63], v[84:85]
    v_pk_fma_f32 v[108:109], v[104:105], v[104:105], v[108:109]
    v_pk_fma_f32 v[110:111], v[106:107], v[106:107], v[110:111]
    v_pk_add_f32 v[80:81], v[80:81], v[104:105]
    v_pk_add_f32 v[82:83], v[82:83], v[106:107]
    v_pk_add_f32 v[104:105], v[64:65], v[84:85]
    v_pk_add_f32 v[106:107], v[66:67], v[84:85]
    v_pk_fma_f32 v[108:109], v[104:105], v[104:105], v[108:109]
    v_pk_fma_f32 v[110:111], v[106:107], v[106:107], v[110:111]
    v_pk_add_f32 v[80:81], v[80:81], v[104:105]
    v_pk_add_f32 v[82:83], v[82:83], v[106:107]
    v_pk_add_f32 v[104:105], v[68:69], v[84:85]
    v_pk_add_f32 v[106:107], v[70:71], v[84:85]
    v_pk_fma_f32 v[108:109], v[104:105], v[104:105], v[108:109]
    v_pk_fma_f32 v[110:111], v[106:107], v[106:107], v[110:111]
    v_pk_add_f32 v[80:81], v[80:81], v[104:105]
    v_pk_add_f32 v[82:83], v[82:83], v[106:107]
    v_pk_add_f32 v[104:105], v[72:73], v[84:85]
    v_pk_add_f32 v[106:107], v[74:75], v[84:85]
    v_pk_fma_f32 v[108:109], v[104:105], v[104:105], v[108:109]
    v_pk_fma_f32 v[110:111], v[106:107], v[106:107], v[110:111]
    v_pk_add_f32 v[80:81], v[80:81], v[104:105]
    v_pk_add_f32 v[82:83], v[82:83], v[106:107]
    v_pk_add_f32 v[104:105], v[76:77], v[84:85]
    v_pk_add_f32 v[106:107], v[78:79], v[84:85]
    v_pk_fma_f32 v[108:109], v[104:105], v[104:105], v[108:109]
    v_pk_fma_f32 v[110:111], v[106:107], v[106:107], v[110:111]
    v_pk_add_f32 v[80:81], v[80:81], v[104:105]
    v_pk_add_f32 v[82:83], v[82:83], v[106:107]
    v_pk_add_f32 v[80:81], v[80:81], v[82:83]
    v_pk_add_f32 v[108:109], v[108:109], v[110:111]
    v_add_f32 v80, v80, v81
    v_add_f32 v108, v108, v109
    s_nop 0
    v_add_f32_dpp v80, v80, v80 row_ror:8 row_mask:0xf bank_mask:0xf
    v_add_f32_dpp v108, v108, v108 row_ror:8 row_mask:0xf bank_mask:0xf
    ds_write_b32 v116, v80
    ds_write_b32 v116, v108 offset:512
    s_waitcnt lgkmcnt(0)
    s_barrier
    ds_read_b128 v[88:91], v117 offset:0
    ds_read_b128 v[92:95], v117 offset:16
    ds_read_b128 v[96:99], v117 offset:32
    ds_read_b128 v[100:103], v117 offset:48
    ds_read_b128 v[128:131], v117 offset:512
    ds_read_b128 v[132:135], v117 offset:528
    ds_read_b128 v[136:139], v117 offset:544
    ds_read_b128 v[140:143], v117 offset:560
    s_waitcnt lgkmcnt(4)
    v_pk_add_f32 v[88:89], v[88:89], v[90:91]
    v_pk_add_f32 v[92:93], v[92:93], v[94:95]
    v_pk_add_f32 v[96:97], v[96:97], v[98:99]
    v_pk_add_f32 v[100:101], v[100:101], v[102:103]
    v_pk_add_f32 v[88:89], v[88:89], v[92:93]
    v_pk_add_f32 v[96:97], v[96:97], v[100:101]
    v_pk_add_f32 v[88:89], v[88:89], v[96:97]
    v_add_f32 v88, v88, v89
    v_mul_f32 v88, 0x3a800000, v88
    s_waitcnt lgkmcnt(0)
    v_pk_add_f32 v[128:129], v[128:129], v[130:131]
    v_pk_add_f32 v[132:133], v[132:133], v[134:135]
    v_pk_add_f32 v[136:137], v[136:137], v[138:139]
    v_pk_add_f32 v[140:141], v[140:141], v[142:143]
    v_pk_add_f32 v[128:129], v[128:129], v[132:133]
    v_pk_add_f32 v[136:137], v[136:137], v[140:141]
    v_pk_add_f32 v[128:129], v[128:129], v[136:137]
    v_add_f32 v128, v128, v129
    v_mul_f32 v128, 0x3a800000, v128
    v_add_f32 v86, v119, v88
    v_fma_f32 v88, -v88, v88, v128
    v_cvt_pk_bf16_f32 v86, v86, v86
    v_max_f32 v88, 0, v88
    v_lshlrev_b32 v86, 16, v86
    v_cvt_pk_bf16_f32 v88, v88, v88
    v_lshlrev_b32 v88, 16, v88
    v_add_f32 v88, 0x3727c5ac, v88
    v_cvt_pk_bf16_f32 v88, v88, v88
    v_lshlrev_b32 v88, 16, v88
    v_sqrt_f32 v88, v88
    s_nop 0
    v_cvt_pk_bf16_f32 v88, v88, v88
    v_lshlrev_b32 v88, 16, v88
    v_rcp_f32 v88, v88
    v_sub_f32 v84, 0, v86
    v_mov_b32 v85, v84
    v_mov_b32 v89, v88
    s_mov_b32 s67, 0
    v_pk_add_f32 v[48:49], v[48:49], v[84:85]
    v_pk_add_f32 v[50:51], v[50:51], v[84:85]
    v_pk_add_f32 v[52:53], v[52:53], v[84:85]
    v_pk_add_f32 v[54:55], v[54:55], v[84:85]
    v_cvt_pk_bf16_f32 v32, v48, v49
    v_cvt_pk_bf16_f32 v33, v50, v51
    v_cvt_pk_bf16_f32 v34, v52, v53
    v_cvt_pk_bf16_f32 v35, v54, v55
    v_lshlrev_b32 v48, 16, v32
    v_and_b32 v49, 0xffff0000, v32
    v_lshlrev_b32 v50, 16, v33
    v_and_b32 v51, 0xffff0000, v33
    v_lshlrev_b32 v52, 16, v34
    v_and_b32 v53, 0xffff0000, v34
    v_lshlrev_b32 v54, 16, v35
    v_and_b32 v55, 0xffff0000, v35
    v_pk_mul_f32 v[48:49], v[48:49], v[88:89]
    v_pk_mul_f32 v[50:51], v[50:51], v[88:89]
    v_pk_mul_f32 v[52:53], v[52:53], v[88:89]
    v_pk_mul_f32 v[54:55], v[54:55], v[88:89]
    v_cvt_pk_bf16_f32 v32, v48, v49
    v_cvt_pk_bf16_f32 v33, v50, v51
    v_cvt_pk_bf16_f32 v34, v52, v53
    v_cvt_pk_bf16_f32 v35, v54, v55
    buffer_store_dwordx4 v[32:35], v115, s[16:19], s67 offen sc1
    s_add_u32 s67, s67, 0x40000
    v_pk_add_f32 v[56:57], v[56:57], v[84:85]
    v_pk_add_f32 v[58:59], v[58:59], v[84:85]
    v_pk_add_f32 v[60:61], v[60:61], v[84:85]
    v_pk_add_f32 v[62:63], v[62:63], v[84:85]
    v_cvt_pk_bf16_f32 v36, v56, v57
    v_cvt_pk_bf16_f32 v37, v58, v59
    v_cvt_pk_bf16_f32 v38, v60, v61
    v_cvt_pk_bf16_f32 v39, v62, v63
    v_lshlrev_b32 v56, 16, v36
    v_and_b32 v57, 0xffff0000, v36
    v_lshlrev_b32 v58, 16, v37
    v_and_b32 v59, 0xffff0000, v37
    v_lshlrev_b32 v60, 16, v38
    v_and_b32 v61, 0xffff0000, v38
    v_lshlrev_b32 v62, 16, v39
    v_and_b32 v63, 0xffff0000, v39
    v_pk_mul_f32 v[56:57], v[56:57], v[88:89]
    v_pk_mul_f32 v[58:59], v[58:59], v[88:89]
    v_pk_mul_f32 v[60:61], v[60:61], v[88:89]
    v_pk_mul_f32 v[62:63], v[62:63], v[88:89]
    v_cvt_pk_bf16_f32 v36, v56, v57
    v_cvt_pk_bf16_f32 v37, v58, v59
    v_cvt_pk_bf16_f32 v38, v60, v61
    v_cvt_pk_bf16_f32 v39, v62, v63
    buffer_store_dwordx4 v[36:39], v115, s[16:19], s67 offen sc1
    s_add_u32 s67, s67, 0x40000
    v_pk_add_f32 v[64:65], v[64:65], v[84:85]
    v_pk_add_f32 v[66:67], v[66:67], v[84:85]
    v_pk_add_f32 v[68:69], v[68:69], v[84:85]
    v_pk_add_f32 v[70:71], v[70:71], v[84:85]
    v_cvt_pk_bf16_f32 v40, v64, v65
    v_cvt_pk_bf16_f32 v41, v66, v67
    v_cvt_pk_bf16_f32 v42, v68, v69
    v_cvt_pk_bf16_f32 v43, v70, v71
    v_lshlrev_b32 v64, 16, v40
    v_and_b32 v65, 0xffff0000, v40
    v_lshlrev_b32 v66, 16, v41
    v_and_b32 v67, 0xffff0000, v41
    v_lshlrev_b32 v68, 16, v42
    v_and_b32 v69, 0xffff0000, v42
    v_lshlrev_b32 v70, 16, v43
    v_and_b32 v71, 0xffff0000, v43
    v_pk_mul_f32 v[64:65], v[64:65], v[88:89]
    v_pk_mul_f32 v[66:67], v[66:67], v[88:89]
    v_pk_mul_f32 v[68:69], v[68:69], v[88:89]
    v_pk_mul_f32 v[70:71], v[70:71], v[88:89]
    v_cvt_pk_bf16_f32 v40, v64, v65
    v_cvt_pk_bf16_f32 v41, v66, v67
    v_cvt_pk_bf16_f32 v42, v68, v69
    v_cvt_pk_bf16_f32 v43, v70, v71
    buffer_store_dwordx4 v[40:43], v115, s[16:19], s67 offen sc1
    s_add_u32 s67, s67, 0x40000
    v_pk_add_f32 v[72:73], v[72:73], v[84:85]
    v_pk_add_f32 v[74:75], v[74:75], v[84:85]
    v_pk_add_f32 v[76:77], v[76:77], v[84:85]
    v_pk_add_f32 v[78:79], v[78:79], v[84:85]
    v_cvt_pk_bf16_f32 v44, v72, v73
    v_cvt_pk_bf16_f32 v45, v74, v75
    v_cvt_pk_bf16_f32 v46, v76, v77
    v_cvt_pk_bf16_f32 v47, v78, v79
    v_lshlrev_b32 v72, 16, v44
    v_and_b32 v73, 0xffff0000, v44
    v_lshlrev_b32 v74, 16, v45
    v_and_b32 v75, 0xffff0000, v45
    v_lshlrev_b32 v76, 16, v46
    v_and_b32 v77, 0xffff0000, v46
    v_lshlrev_b32 v78, 16, v47
    v_and_b32 v79, 0xffff0000, v47
    v_pk_mul_f32 v[72:73], v[72:73], v[88:89]
    v_pk_mul_f32 v[74:75], v[74:75], v[88:89]
    v_pk_mul_f32 v[76:77], v[76:77], v[88:89]
    v_pk_mul_f32 v[78:79], v[78:79], v[88:89]
    v_cvt_pk_bf16_f32 v44, v72, v73
    v_cvt_pk_bf16_f32 v45, v74, v75
    v_cvt_pk_bf16_f32 v46, v76, v77
    v_cvt_pk_bf16_f32 v47, v78, v79
    buffer_store_dwordx4 v[44:47], v115, s[16:19], s67 offen sc1
    s_add_u32 s67, s67, 0x40000
    s_add_u32 s72, s14, 0x1c00000
    s_addc_u32 s73, s15, 0
    s_mov_b32 s74, 0x900000
    s_mov_b32 s75, 0x00020000
    s_add_u32 m0, s56, 0x400
    s_nop 0
    buffer_load_dwordx4 v2, s[20:23], s52 offen lds
    v_accvgpr_write_b32 a0, 0
    v_accvgpr_write_b32 a1, 0
    v_accvgpr_write_b32 a2, 0
    v_accvgpr_write_b32 a3, 0
    v_accvgpr_write_b32 a4, 0
    v_accvgpr_write_b32 a5, 0
    v_accvgpr_write_b32 a6, 0
    v_accvgpr_write_b32 a7, 0
    v_accvgpr_write_b32 a8, 0
    v_accvgpr_write_b32 a9, 0
    v_accvgpr_write_b32 a10, 0
    v_accvgpr_write_b32 a11, 0
    v_accvgpr_write_b32 a12, 0
    v_accvgpr_write_b32 a13, 0
    v_accvgpr_write_b32 a14, 0
    v_accvgpr_write_b32 a15, 0
    v_accvgpr_write_b32 a16, 0
    v_accvgpr_write_b32 a17, 0
    v_accvgpr_write_b32 a18, 0
    v_accvgpr_write_b32 a19, 0
    v_accvgpr_write_b32 a20, 0
    v_accvgpr_write_b32 a21, 0
    v_accvgpr_write_b32 a22, 0
    v_accvgpr_write_b32 a23, 0
    v_accvgpr_write_b32 a24, 0
    v_accvgpr_write_b32 a25, 0
    v_accvgpr_write_b32 a26, 0
    v_accvgpr_write_b32 a27, 0
    v_accvgpr_write_b32 a28, 0
    v_accvgpr_write_b32 a29, 0
    v_accvgpr_write_b32 a30, 0
    v_accvgpr_write_b32 a31, 0
    v_accvgpr_write_b32 a32, 0
    v_accvgpr_write_b32 a33, 0
    v_accvgpr_write_b32 a34, 0
    v_accvgpr_write_b32 a35, 0
    v_accvgpr_write_b32 a36, 0
    v_accvgpr_write_b32 a37, 0
    v_accvgpr_write_b32 a38, 0
    v_accvgpr_write_b32 a39, 0
    v_accvgpr_write_b32 a40, 0
    v_accvgpr_write_b32 a41, 0
    v_accvgpr_write_b32 a42, 0
    s_add_u32 m0, s56, 0x800
    s_nop 0
    buffer_load_dwordx4 v3, s[24:27], s53 offen lds
    v_accvgpr_write_b32 a43, 0
    v_accvgpr_write_b32 a44, 0
    v_accvgpr_write_b32 a45, 0
    v_accvgpr_write_b32 a46, 0
    v_accvgpr_write_b32 a47, 0
    v_accvgpr_write_b32 a48, 0
    v_accvgpr_write_b32 a49, 0
    v_accvgpr_write_b32 a50, 0
    v_accvgpr_write_b32 a51, 0
    v_accvgpr_write_b32 a52, 0
    v_accvgpr_write_b32 a53, 0
    v_accvgpr_write_b32 a54, 0
    v_accvgpr_write_b32 a55, 0
    v_accvgpr_write_b32 a56, 0
    v_accvgpr_write_b32 a57, 0
    v_accvgpr_write_b32 a58, 0
    v_accvgpr_write_b32 a59, 0
    v_accvgpr_write_b32 a60, 0
    v_accvgpr_write_b32 a61, 0
    v_accvgpr_write_b32 a62, 0
    v_accvgpr_write_b32 a63, 0
    v_accvgpr_write_b32 a64, 0
    v_accvgpr_write_b32 a65, 0
    v_accvgpr_write_b32 a66, 0
    v_accvgpr_write_b32 a67, 0
    v_accvgpr_write_b32 a68, 0
    v_accvgpr_write_b32 a69, 0
    v_accvgpr_write_b32 a70, 0
    v_accvgpr_write_b32 a71, 0
    v_accvgpr_write_b32 a72, 0
    v_accvgpr_write_b32 a73, 0
    v_accvgpr_write_b32 a74, 0
    v_accvgpr_write_b32 a75, 0
    v_accvgpr_write_b32 a76, 0
    v_accvgpr_write_b32 a77, 0
    v_accvgpr_write_b32 a78, 0
    v_accvgpr_write_b32 a79, 0
    v_accvgpr_write_b32 a80, 0
    v_accvgpr_write_b32 a81, 0
    v_accvgpr_write_b32 a82, 0
    v_accvgpr_write_b32 a83, 0
    v_accvgpr_write_b32 a84, 0
    v_accvgpr_write_b32 a85, 0
    s_add_u32 m0, s56, 0xc00
    s_nop 0
    buffer_load_dwordx4 v4, s[28:31], s53 offen lds
    v_accvgpr_write_b32 a86, 0
    v_accvgpr_write_b32 a87, 0
    v_accvgpr_write_b32 a208, 0
    v_accvgpr_write_b32 a209, 0
    v_accvgpr_write_b32 a210, 0
    v_accvgpr_write_b32 a211, 0
    v_accvgpr_write_b32 a212, 0
    v_accvgpr_write_b32 a213, 0
    v_accvgpr_write_b32 a214, 0
    v_accvgpr_write_b32 a215, 0
    v_pk_mov_b32 v[144:145], 0, 0
    v_pk_mov_b32 v[146:147], 0, 0
    v_pk_mov_b32 v[148:149], 0, 0
    v_pk_mov_b32 v[150:151], 0, 0
    v_pk_mov_b32 v[152:153], 0, 0
    v_pk_mov_b32 v[154:155], 0, 0
    v_pk_mov_b32 v[156:157], 0, 0
    v_pk_mov_b32 v[158:159], 0, 0
    v_pk_mov_b32 v[160:161], 0, 0
    v_pk_mov_b32 v[162:163], 0, 0
    v_pk_mov_b32 v[164:165], 0, 0
    v_pk_mov_b32 v[166:167], 0, 0
    v_pk_mov_b32 v[168:169], 0, 0
    v_pk_mov_b32 v[170:171], 0, 0
    v_pk_mov_b32 v[172:173], 0, 0
    v_pk_mov_b32 v[174:175], 0, 0
    v_pk_mov_b32 v[176:177], 0, 0
    v_pk_mov_b32 v[178:179], 0, 0
    v_pk_mov_b32 v[180:181], 0, 0
    v_pk_mov_b32 v[182:183], 0, 0
    v_pk_mov_b32 v[184:185], 0, 0
    v_pk_mov_b32 v[186:187], 0, 0
    v_pk_mov_b32 v[188:189], 0, 0
    v_pk_mov_b32 v[190:191], 0, 0
    v_pk_mov_b32 v[192:193], 0, 0
    v_pk_mov_b32 v[194:195], 0, 0
    v_pk_mov_b32 v[196:197], 0, 0
    v_pk_mov_b32 v[198:199], 0, 0
    v_pk_mov_b32 v[200:201], 0, 0
    v_pk_mov_b32 v[202:203], 0, 0
    v_pk_mov_b32 v[204:205], 0, 0
    v_pk_mov_b32 v[206:207], 0, 0
    v_pk_mov_b32 v[208:209], 0, 0
    s_add_u32 m0, s56, 0x1000
    s_nop 0
    buffer_load_dwordx4 v5, s[32:35], s53 offen lds
    v_pk_mov_b32 v[210:211], 0, 0
    v_pk_mov_b32 v[212:213], 0, 0
    v_pk_mov_b32 v[214:215], 0, 0
    v_pk_mov_b32 v[216:217], 0, 0
    v_pk_mov_b32 v[218:219], 0, 0
    v_pk_mov_b32 v[220:221], 0, 0
    v_pk_mov_b32 v[222:223], 0, 0
    v_pk_mov_b32 v[224:225], 0, 0
    v_pk_mov_b32 v[226:227], 0, 0
    v_pk_mov_b32 v[228:229], 0, 0
    v_pk_mov_b32 v[230:231], 0, 0
    v_pk_mov_b32 v[232:233], 0, 0
    v_pk_mov_b32 v[234:235], 0, 0
    v_pk_mov_b32 v[236:237], 0, 0
    v_pk_mov_b32 v[238:239], 0, 0
    v_pk_mov_b32 v[240:241], 0, 0
    v_pk_mov_b32 v[242:243], 0, 0
    v_pk_mov_b32 v[244:245], 0, 0
    v_pk_mov_b32 v[246:247], 0, 0
    v_pk_mov_b32 v[248:249], 0, 0
    v_pk_mov_b32 v[250:251], 0, 0
    v_pk_mov_b32 v[252:253], 0, 0
    v_pk_mov_b32 v[254:255], 0, 0
    v_pk_mov_b32 v[24:25], 0, 0
    v_pk_mov_b32 v[26:27], 0, 0
    v_pk_mov_b32 v[28:29], 0, 0
    v_pk_mov_b32 v[30:31], 0, 0
    v_pk_mov_b32 v[32:33], 0, 0
    v_pk_mov_b32 v[34:35], 0, 0
    v_pk_mov_b32 v[36:37], 0, 0
    v_pk_mov_b32 v[38:39], 0, 0
    v_pk_mov_b32 v[40:41], 0, 0
    v_pk_mov_b32 v[42:43], 0, 0
    v_pk_mov_b32 v[44:45], 0, 0
    v_pk_mov_b32 v[46:47], 0, 0
    v_pk_mov_b32 v[48:49], 0, 0
    v_pk_mov_b32 v[50:51], 0, 0
    v_pk_mov_b32 v[52:53], 0, 0
    v_pk_mov_b32 v[54:55], 0, 0
    v_pk_mov_b32 v[56:57], 0, 0
    v_pk_mov_b32 v[58:59], 0, 0
    v_pk_mov_b32 v[60:61], 0, 0
    v_pk_mov_b32 v[62:63], 0, 0
    s_add_u32 m0, s56, 0x1400
    s_nop 0
    buffer_load_dwordx4 v6, s[36:39], s53 offen lds
    v_pk_mov_b32 v[64:65], 0, 0
    v_pk_mov_b32 v[66:67], 0, 0
    v_pk_mov_b32 v[68:69], 0, 0
    v_pk_mov_b32 v[70:71], 0, 0
    v_pk_mov_b32 v[72:73], 0, 0
    v_pk_mov_b32 v[74:75], 0, 0
    v_pk_mov_b32 v[76:77], 0, 0
    v_pk_mov_b32 v[78:79], 0, 0
    v_pk_mov_b32 v[80:81], 0, 0
    v_pk_mov_b32 v[82:83], 0, 0
    v_pk_mov_b32 v[84:85], 0, 0
    v_pk_mov_b32 v[86:87], 0, 0
    v_pk_mov_b32 v[88:89], 0, 0
    v_pk_mov_b32 v[90:91], 0, 0
    v_pk_mov_b32 v[92:93], 0, 0
    v_pk_mov_b32 v[94:95], 0, 0
    v_pk_mov_b32 v[96:97], 0, 0
    v_pk_mov_b32 v[98:99], 0, 0
    v_pk_mov_b32 v[100:101], 0, 0
    v_pk_mov_b32 v[102:103], 0, 0
    v_pk_mov_b32 v[104:105], 0, 0
    v_pk_mov_b32 v[106:107], 0, 0
    v_pk_mov_b32 v[108:109], 0, 0
    v_pk_mov_b32 v[110:111], 0, 0
    v_pk_mov_b32 v[112:113], 0, 0
    v_pk_mov_b32 v[114:115], 0, 0
    v_pk_mov_b32 v[116:117], 0, 0
    v_pk_mov_b32 v[118:119], 0, 0
    v_pk_mov_b32 v[120:121], 0, 0
    v_pk_mov_b32 v[122:123], 0, 0
    v_pk_mov_b32 v[124:125], 0, 0
    v_pk_mov_b32 v[126:127], 0, 0
    v_pk_mov_b32 v[128:129], 0, 0
    v_pk_mov_b32 v[130:131], 0, 0
    v_pk_mov_b32 v[132:133], 0, 0
    v_pk_mov_b32 v[134:135], 0, 0
    v_pk_mov_b32 v[136:137], 0, 0
    v_pk_mov_b32 v[138:139], 0, 0
    v_pk_mov_b32 v[140:141], 0, 0
    v_pk_mov_b32 v[142:143], 0, 0
    s_waitcnt vmcnt(5)
    v_readfirstlane_b32 s12, v18
    s_barrier
    s_mul_i32 s12, s12, 0x9e3779b1
    s_add_u32 s12, s12, 0x7f4a7c15
    s_cmp_eq_u32 s48, 0
    s_cbranch_scc0 M_fs1
    v_mov_b32 v14, s12
    v_mov_b32 v15, 1
    s_mov_b64 exec, 1
    buffer_store_dwordx2 v[14:15], off, s[92:95], s90 sc1
    s_mov_b64 exec, -1
M_fs1:
    s_add_u32 s56, s56, s59
    s_add_u32 s52, s52, s54
    s_add_u32 s53, s53, s55
    s_add_u32 m0, s56, 0x400
    s_nop 0
    buffer_load_dwordx4 v2, s[20:23], s52 offen lds
    s_add_u32 m0, s56, 0x800
    s_nop 0
    buffer_load_dwordx4 v3, s[24:27], s53 offen lds
    s_add_u32 m0, s56, 0xc00
    s_nop 0
    buffer_load_dwordx4 v4, s[28:31], s53 offen lds
    s_add_u32 m0, s56, 0x1000
    s_nop 0
    buffer_load_dwordx4 v5, s[32:35], s53 offen lds
    s_add_u32 m0, s56, 0x1400
    s_nop 0
    buffer_load_dwordx4 v6, s[36:39], s53 offen lds
    s_add_u32 s56, s56, s59
    s_add_u32 s52, s52, s54
    s_add_u32 s53, s53, s55
    s_add_u32 m0, s56, 0x400
    s_nop 0
    buffer_load_dwordx4 v2, s[20:23], s52 offen lds
    s_add_u32 m0, s56, 0x800
    s_nop 0
    buffer_load_dwordx4 v3, s[24:27], s53 offen lds
    s_add_u32 m0, s56, 0xc00
    s_nop 0
    buffer_load_dwordx4 v4, s[28:31], s53 offen lds
    s_add_u32 m0, s56, 0x1000
    s_nop 0
    buffer_load_dwordx4 v5, s[32:35], s53 offen lds
    s_add_u32 m0, s56, 0x1400
    s_nop 0
    buffer_load_dwordx4 v6, s[36:39], s53 offen lds
    s_cmp_eq_u32 s48, 0
    s_cbranch_scc0 M_lng
    buffer_load_dwordx2 v[18:19], v17, s[92:95], 0 offen sc1
    s_waitcnt vmcnt(0)
    s_mov_b32 s91, 0
M_pc2:
    v_xor_b32 v14, s12, v18
    v_bfe_u32 v15, v19, 0, 1
    v_xor_b32 v15, 1, v15
    v_or_b32 v14, v14, v15
    v_cmp_ne_u32 vcc, 0, v14
    s_nop 3
    s_cmp_eq_u32 vcc_lo, 0
    s_cbranch_scc1 M_pc2_ok
    s_add_u32 s91, s91, 1
    s_cmp_ge_u32 s91, 0x40000
    s_cbranch_scc1 M_pc2_ok
    s_sleep 1
    buffer_load_dwordx2 v[18:19], v17, s[92:95], 0 offen sc1
    s_waitcnt vmcnt(0)
    s_branch M_pc2
M_pc2_ok:
M_lng:
    s_waitcnt vmcnt(0)
    s_barrier
    s_and_b32 s67, s2, 7
    s_lshr_b32 s68, s67, 1
    s_lshl_b32 s68, s68, 2
    s_bfe_u32 s70, s2, 0x20003
    s_add_u32 s68, s68, s70
    s_and_b32 s69, s67, 1
    s_lshl_b32 s69, s69, 3
    s_lshr_b32 s70, s2, 5
    s_add_u32 s69, s69, s70
    buffer_load_dwordx4 a[88:91], v1, s[16:19], s51 offen offset:0 sc1
    buffer_load_dwordx4 a[92:95], v1, s[16:19], s51 offen offset:1024 sc1
    buffer_load_dwordx4 a[96:99], v1, s[16:19], s51 offen offset:2048 sc1
    buffer_load_dwordx4 a[100:103], v1, s[16:19], s51 offen offset:3072 sc1
    s_add_u32 s51, s51, 0x20000
    buffer_load_dwordx4 a[104:107], v1, s[16:19], s51 offen offset:0 sc1
    buffer_load_dwordx4 a[108:111], v1, s[16:19], s51 offen offset:1024 sc1
    buffer_load_dwordx4 a[112:115], v1, s[16:19], s51 offen offset:2048 sc1
    buffer_load_dwordx4 a[116:119], v1, s[16:19], s51 offen offset:3072 sc1
    s_add_u32 s51, s51, 0x20000
    buffer_load_dword v23, v20, s[76:79], s88 offen
    buffer_load_dword v23, v21, s[80:83], s89 offen
    buffer_load_dword v23, v21, s[44:47], s89 offen
    s_add_u32 s88, s88, 786432
    s_add_u32 s89, s89, 917504
    s_lshr_b32 s67, s68, 1
    s_lshl_b32 s67, s67, 3
    v_and_b32 v14, 7, v0
    v_bfe_u32 v15, v0, 3, 2
    v_lshl_add_u32 v15, v15, 6, v14
    v_add_u32 v17, s67, v15
    s_and_b32 s67, s48, 1
    s_lshl_b32 s67, s67, 2
    s_lshr_b32 s70, s48, 1
    s_add_u32 s67, s67, s70
    s_lshl_b32 s67, s67, 13
    v_and_b32 v14, 0x7ff, v22
    v_bfe_u32 v15, v0, 3, 2
    v_lshl_add_u32 v14, v15, 11, v14
    v_lshrrev_b32 v15, 5, v0
    v_lshl_add_u32 v14, v15, 14, v14
    v_add_u32 v14, s67, v14
    s_getpc_b64 s[4:5]
    s_and_b32 s4, s4, 0xffffff80
    s_bfe_u32 s67, s2, 0x30003
    s_lshl_b32 s67, s67, 2
    s_add_u32 s67, s67, s48
    s_mul_i32 s67, s67, 1408
    s_add_u32 s67, s67, 5120
    v_min_u32 v18, 10, v0
    v_lshlrev_b32 v18, 7, v18
    v_add_u32 v18, s67, v18
    s_lshr_b32 s67, s48, 1
    s_lshl_b32 s67, s67, 2
    v_and_b32 v15, 3, v0
    v_or_b32 v15, s67, v15
    v_bfe_u32 v19, v0, 2, 3
    v_xor_b32 v15, v15, v19
    v_lshrrev_b32 v19, 2, v0
    v_lshlrev_b32 v19, 7, v19
    v_lshl_add_u32 v19, v15, 4, v19
    s_and_b32 s70, s48, 1
    s_lshl_b32 s70, s70, 3
    s_add_u32 s67, s70, 122880
    v_add_u32 v19, s67, v19
    s_lshl_b32 s10, s68, 18
    s_lshl_b32 s67, s48, 16
    s_add_u32 s10, s10, s67
    s_lshl_b32 s67, s69, 7
    s_add_u32 s10, s10, s67
    s_sub_u32 s10, s10, 163840
    s_lshl_b32 s11, s48, 12
    s_add_u32 s11, s11, 136192
    s_lshl_b32 s67, s48, 10
    ds_read_b64_tr_b16 a[152:153], v9 offset:6144
    ds_read_b64_tr_b16 a[154:155], v9 offset:9728
    ds_read_b64_tr_b16 a[156:157], v9 offset:26624
    ds_read_b64_tr_b16 a[158:159], v9 offset:30208
    ds_read_b64_tr_b16 a[160:161], v9 offset:13312
    ds_read_b64_tr_b16 a[162:163], v9 offset:16896
    ds_read_b64_tr_b16 a[164:165], v9 offset:33792
    ds_read_b64_tr_b16 a[166:167], v9 offset:37376
    ds_read_b64_tr_b16 a[168:169], v9 offset:6176
    ds_read_b64_tr_b16 a[170:171], v9 offset:9760
    ds_read_b64_tr_b16 a[172:173], v9 offset:26656
    ds_read_b64_tr_b16 a[174:175], v9 offset:30240
    s_waitcnt vmcnt(3)
M_loop1:
    s_waitcnt vmcnt(10) lgkmcnt(8)
    v_mfma_f32_16x16x32_bf16 v[88:91], a[152:155], a[88:91], v[88:91]
    ds_read_b64_tr_b16 a[176:177], v9 offset:13344
    v_mfma_f32_16x16x32_bf16 v[88:91], a[156:159], a[104:107], v[88:91]
    ds_read_b64_tr_b16 a[178:179], v9 offset:16928
    v_mfma_f32_16x16x32_bf16 v[92:95], a[156:159], a[108:111], v[92:95]
    v_mfma_f32_16x16x32_bf16 v[92:95], a[152:155], a[92:95], v[92:95]
    v_mfma_f32_16x16x32_bf16 v[96:99], a[152:155], a[96:99], v[96:99]
    ds_read_b64_tr_b16 a[180:181], v9 offset:33824
    s_add_u32 s56, s56, s59
    s_add_u32 s52, s52, s54
    s_add_u32 s53, s53, s55
    v_mfma_f32_16x16x32_bf16 v[96:99], a[156:159], a[112:115], v[96:99]
    ds_read_b64_tr_b16 a[182:183], v9 offset:37408
    s_cmp_eq_u32 s56, s61
    s_cselect_b32 s56, s62, s56
    s_add_u32 m0, s56, 0x400
    v_mfma_f32_16x16x32_bf16 v[100:103], a[156:159], a[116:119], v[100:103]
    buffer_load_dwordx4 v2, s[20:23], s52 offen lds
    v_mfma_f32_16x16x32_bf16 v[100:103], a[152:155], a[100:103], v[100:103]
    s_waitcnt lgkmcnt(8)
    v_mfma_f32_16x16x32_bf16 v[212:215], a[160:163], a[100:103], v[212:215]
    ds_read_b64_tr_b16 a[152:153], v7 offset:2048
    v_mfma_f32_16x16x32_bf16 v[212:215], a[164:167], a[116:119], v[212:215]
    ds_read_b64_tr_b16 a[154:155], v7 offset:3072
    v_mfma_f32_16x16x32_bf16 v[208:211], a[164:167], a[112:115], v[208:211]
    ds_read_b64_tr_b16 a[208:209], v19 offset:0
    v_mfma_f32_16x16x32_bf16 v[208:211], a[160:163], a[96:99], v[208:211]
    ds_read_b64_tr_b16 a[210:211], v19 offset:2048
    v_mfma_f32_16x16x32_bf16 v[204:207], a[160:163], a[92:95], v[204:207]
    ds_read_b64_tr_b16 a[156:157], v7 offset:22528
    v_mfma_f32_16x16x32_bf16 v[204:207], a[164:167], a[108:111], v[204:207]
    ds_read_b64_tr_b16 a[158:159], v7 offset:23552
    s_add_u32 m0, s56, 0x800
    v_mfma_f32_16x16x32_bf16 v[200:203], a[164:167], a[104:107], v[200:203]
    buffer_load_dwordx4 v3, s[24:27], s53 offen lds
    v_mfma_f32_16x16x32_bf16 v[200:203], a[160:163], a[88:91], v[200:203]
    s_waitcnt lgkmcnt(8)
    v_mfma_f32_16x16x32_bf16 v[104:107], a[168:171], a[88:91], v[104:107]
    ds_read_b64_tr_b16 a[160:161], v8 offset:2048
    v_mfma_f32_16x16x32_bf16 v[104:107], a[172:175], a[104:107], v[104:107]
    ds_read_b64_tr_b16 a[162:163], v8 offset:3072
    s_add_u32 m0, s56, 0xc00
    v_mfma_f32_16x16x32_bf16 v[108:111], a[172:175], a[108:111], v[108:111]
    buffer_load_dwordx4 v4, s[28:31], s53 offen lds
    v_mfma_f32_16x16x32_bf16 v[108:111], a[168:171], a[92:95], v[108:111]
    v_mfma_f32_16x16x32_bf16 v[112:115], a[168:171], a[96:99], v[112:115]
    ds_read_b64_tr_b16 a[164:165], v8 offset:22528
    v_mfma_f32_16x16x32_bf16 v[112:115], a[172:175], a[112:115], v[112:115]
    ds_read_b64_tr_b16 a[166:167], v8 offset:23552
    v_mfma_f32_16x16x32_bf16 v[116:119], a[172:175], a[116:119], v[116:119]
    ds_read_b64_tr_b16 a[212:213], v19 offset:4096
    v_mfma_f32_16x16x32_bf16 v[116:119], a[168:171], a[100:103], v[116:119]
    ds_read_b64_tr_b16 a[214:215], v19 offset:6144
    s_waitcnt lgkmcnt(8)
    v_mfma_f32_16x16x32_bf16 v[228:231], a[176:179], a[100:103], v[228:231]
    ds_read_b64_tr_b16 a[168:169], v7 offset:4096
    v_mfma_f32_16x16x32_bf16 v[228:231], a[180:183], a[116:119], v[228:231]
    ds_read_b64_tr_b16 a[170:171], v7 offset:5120
    s_add_u32 m0, s56, 0x1000
    v_mfma_f32_16x16x32_bf16 v[224:227], a[180:183], a[112:115], v[224:227]
    buffer_load_dwordx4 v5, s[32:35], s53 offen lds
    v_mfma_f32_16x16x32_bf16 v[224:227], a[176:179], a[96:99], v[224:227]
    v_mfma_f32_16x16x32_bf16 v[220:223], a[176:179], a[92:95], v[220:223]
    ds_read_b64_tr_b16 a[172:173], v7 offset:24576
    v_mfma_f32_16x16x32_bf16 v[220:223], a[180:183], a[108:111], v[220:223]
    ds_read_b64_tr_b16 a[174:175], v7 offset:25600
    s_add_u32 m0, s56, 0x1400
    v_mfma_f32_16x16x32_bf16 v[216:219], a[180:183], a[104:107], v[216:219]
    buffer_load_dwordx4 v6, s[36:39], s53 offen lds
    v_mfma_f32_16x16x32_bf16 v[216:219], a[176:179], a[88:91], v[216:219]
    s_waitcnt lgkmcnt(8)
    v_mfma_f32_16x16x32_bf16 v[24:27], a[88:91], a[152:155], v[24:27]
    ds_read_b64_tr_b16 a[176:177], v8 offset:4096
    v_mfma_f32_16x16x32_bf16 v[24:27], a[104:107], a[156:159], v[24:27]
    ds_read_b64_tr_b16 a[178:179], v8 offset:5120
    v_mfma_f32_16x16x32_bf16 v[28:31], a[108:111], a[156:159], v[28:31]
    v_xor_b32 v19, 0x3e000, v19
    v_mfma_f32_16x16x32_bf16 v[28:31], a[92:95], a[152:155], v[28:31]
    s_xor_b32 s67, s67, 0x2000
    v_mfma_f32_16x16x32_bf16 v[32:35], a[96:99], a[152:155], v[32:35]
    ds_read_b64_tr_b16 a[180:181], v8 offset:24576
    v_mfma_f32_16x16x32_bf16 v[32:35], a[112:115], a[156:159], v[32:35]
    ds_read_b64_tr_b16 a[182:183], v8 offset:25600
    v_mfma_f32_16x16x32_bf16 v[36:39], a[116:119], a[156:159], v[36:39]
    buffer_load_dwordx4 a[120:123], v1, s[16:19], s51 offen offset:0 sc1
    v_mfma_f32_16x16x32_bf16 v[36:39], a[100:103], a[152:155], v[36:39]
    s_waitcnt lgkmcnt(8)
    v_mfma_f32_16x16x32_bf16 v[52:55], a[100:103], a[160:163], v[52:55]
    ds_read_b64_tr_b16 a[152:153], v7 offset:0
    v_mfma_f32_16x16x32_bf16 v[52:55], a[116:119], a[164:167], v[52:55]
    ds_read_b64_tr_b16 a[154:155], v7 offset:1024
    v_mfma_f32_16x16x32_bf16 v[48:51], a[112:115], a[164:167], v[48:51]
    buffer_load_dwordx4 a[124:127], v1, s[16:19], s51 offen offset:1024 sc1
    v_mfma_f32_16x16x32_bf16 v[48:51], a[96:99], a[160:163], v[48:51]
    v_mfma_f32_16x16x32_bf16 v[44:47], a[92:95], a[160:163], v[44:47]
    ds_read_b64_tr_b16 a[156:157], v7 offset:20480
    v_mfma_f32_16x16x32_bf16 v[44:47], a[108:111], a[164:167], v[44:47]
    ds_read_b64_tr_b16 a[158:159], v7 offset:21504
    v_mfma_f32_16x16x32_bf16 v[40:43], a[104:107], a[164:167], v[40:43]
    buffer_load_dwordx4 a[128:131], v1, s[16:19], s51 offen offset:2048 sc1
    v_mfma_f32_16x16x32_bf16 v[40:43], a[88:91], a[160:163], v[40:43]
    s_waitcnt lgkmcnt(8)
    v_mfma_f32_16x16x32_bf16 v[56:59], a[88:91], a[168:171], v[56:59]
    ds_read_b64_tr_b16 a[160:161], v8 offset:0
    v_mfma_f32_16x16x32_bf16 v[56:59], a[104:107], a[172:175], v[56:59]
    ds_read_b64_tr_b16 a[162:163], v8 offset:1024
    v_mfma_f32_16x16x32_bf16 v[60:63], a[108:111], a[172:175], v[60:63]
    v_mfma_f32_16x16x32_bf16 v[60:63], a[92:95], a[168:171], v[60:63]
    v_mfma_f32_16x16x32_bf16 v[64:67], a[96:99], a[168:171], v[64:67]
    ds_read_b64_tr_b16 a[164:165], v8 offset:20480
    v_mfma_f32_16x16x32_bf16 v[64:67], a[112:115], a[172:175], v[64:67]
    ds_read_b64_tr_b16 a[166:167], v8 offset:21504
    v_mfma_f32_16x16x32_bf16 v[68:71], a[116:119], a[172:175], v[68:71]
    buffer_load_dwordx4 a[132:135], v1, s[16:19], s51 offen offset:3072 sc1
    v_mfma_f32_16x16x32_bf16 v[68:71], a[100:103], a[168:171], v[68:71]
    s_add_u32 s51, s51, 0x20000
    s_waitcnt lgkmcnt(8)
    v_mfma_f32_16x16x32_bf16 v[84:87], a[100:103], a[176:179], v[84:87]
    ds_read_b64_tr_b16 a[168:169], v9 offset:6208
    v_mfma_f32_16x16x32_bf16 v[84:87], a[116:119], a[180:183], v[84:87]
    ds_read_b64_tr_b16 a[170:171], v9 offset:9792
    v_mfma_f32_16x16x32_bf16 v[80:83], a[112:115], a[180:183], v[80:83]
    buffer_load_dwordx4 a[136:139], v1, s[16:19], s51 offen offset:0 sc1
    v_mfma_f32_16x16x32_bf16 v[80:83], a[96:99], a[176:179], v[80:83]
    v_mfma_f32_16x16x32_bf16 v[76:79], a[92:95], a[176:179], v[76:79]
    ds_read_b64_tr_b16 a[172:173], v9 offset:26688
    v_mfma_f32_16x16x32_bf16 v[76:79], a[108:111], a[180:183], v[76:79]
    ds_read_b64_tr_b16 a[174:175], v9 offset:30272
    v_mfma_f32_16x16x32_bf16 v[72:75], a[104:107], a[180:183], v[72:75]
    buffer_load_dwordx4 a[140:143], v1, s[16:19], s51 offen offset:1024 sc1
    v_mfma_f32_16x16x32_bf16 v[72:75], a[88:91], a[176:179], v[72:75]
    s_waitcnt lgkmcnt(8)
    v_mfma_f32_16x16x32_bf16 a[56:59], a[152:155], a[88:91], a[56:59]
    ds_read_b64_tr_b16 a[176:177], v9 offset:13376
    v_mfma_f32_16x16x32_bf16 a[56:59], a[156:159], a[104:107], a[56:59]
    ds_read_b64_tr_b16 a[178:179], v9 offset:16960
    v_mfma_f32_16x16x32_bf16 a[60:63], a[156:159], a[108:111], a[60:63]
    v_mfma_f32_16x16x32_bf16 a[60:63], a[152:155], a[92:95], a[60:63]
    v_mfma_f32_16x16x32_bf16 a[64:67], a[152:155], a[96:99], a[64:67]
    ds_read_b64_tr_b16 a[180:181], v9 offset:33856
    v_mfma_f32_16x16x32_bf16 a[64:67], a[156:159], a[112:115], a[64:67]
    ds_read_b64_tr_b16 a[182:183], v9 offset:37440
    v_mfma_f32_16x16x32_bf16 a[68:71], a[156:159], a[116:119], a[68:71]
    buffer_load_dwordx4 a[144:147], v1, s[16:19], s51 offen offset:2048 sc1
    v_mfma_f32_16x16x32_bf16 a[68:71], a[152:155], a[100:103], a[68:71]
    s_waitcnt lgkmcnt(8)
    v_mfma_f32_16x16x32_bf16 a[84:87], a[160:163], a[100:103], a[84:87]
    ds_read_b64_tr_b16 a[152:153], v9 offset:6240
    v_mfma_f32_16x16x32_bf16 a[84:87], a[164:167], a[116:119], a[84:87]
    ds_read_b64_tr_b16 a[154:155], v9 offset:9824
    v_mfma_f32_16x16x32_bf16 a[80:83], a[164:167], a[112:115], a[80:83]
    buffer_load_dwordx4 a[148:151], v1, s[16:19], s51 offen offset:3072 sc1
    v_mfma_f32_16x16x32_bf16 a[80:83], a[160:163], a[96:99], a[80:83]
    s_add_u32 s51, s51, 0x20000
    v_mfma_f32_16x16x32_bf16 a[76:79], a[160:163], a[92:95], a[76:79]
    ds_read_b64_tr_b16 a[156:157], v9 offset:26720
    v_mfma_f32_16x16x32_bf16 a[76:79], a[164:167], a[108:111], a[76:79]
    ds_read_b64_tr_b16 a[158:159], v9 offset:30304
    v_mfma_f32_16x16x32_bf16 a[72:75], a[164:167], a[104:107], a[72:75]
    buffer_store_dwordx4 a[208:211], v16, s[72:75], s3 offen sc1
    v_mfma_f32_16x16x32_bf16 a[72:75], a[160:163], a[88:91], a[72:75]
    s_add_u32 s3, s3, 0x100000
    s_waitcnt lgkmcnt(8)
    v_mfma_f32_16x16x32_bf16 v[120:123], a[168:171], a[88:91], v[120:123]
    ds_read_b64_tr_b16 a[160:161], v9 offset:13408
    v_mfma_f32_16x16x32_bf16 v[120:123], a[172:175], a[104:107], v[120:123]
    ds_read_b64_tr_b16 a[162:163], v9 offset:16992
    v_mfma_f32_16x16x32_bf16 v[124:127], a[172:175], a[108:111], v[124:127]
    s_cmp_eq_u32 s58, 3
    s_cselect_b64 s[70:71], -1, 0
    v_mfma_f32_16x16x32_bf16 v[124:127], a[168:171], a[92:95], v[124:127]
    v_cndmask_b32 v15, v22, v14, s[70:71]
    v_mfma_f32_16x16x32_bf16 v[128:131], a[168:171], a[96:99], v[128:131]
    ds_read_b64_tr_b16 a[164:165], v9 offset:33888
    s_add_u32 m0, s67, 122880
    s_cmp_ge_u32 s58, 5
    s_cselect_b32 m0, s11, m0
    v_mfma_f32_16x16x32_bf16 v[128:131], a[172:175], a[112:115], v[128:131]
    ds_read_b64_tr_b16 a[166:167], v9 offset:37472
    s_cselect_b32 s63, s10, s63
    s_add_u32 s10, s10, 16384
    s_add_u32 s11, s11, 1024
    v_mfma_f32_16x16x32_bf16 v[132:135], a[172:175], a[116:119], v[132:135]
    buffer_load_dwordx4 v15, s[40:43], s63 offen nt lds
    v_mfma_f32_16x16x32_bf16 v[132:135], a[168:171], a[100:103], v[132:135]
    s_add_u32 s63, s63, 3670016
    s_cmp_eq_u32 s58, 3
    s_cselect_b32 s63, s65, s63
    s_cselect_b32 s40, s84, s40
    s_cselect_b32 s41, s85, s41
    s_cselect_b32 s42, 2097152, s42
    s_cmp_eq_u32 s58, 4
    s_cselect_b32 s42, 0, s42
    s_waitcnt lgkmcnt(8)
    v_mfma_f32_16x16x32_bf16 v[244:247], a[176:179], a[100:103], v[244:247]
    ds_read_b64_tr_b16 a[168:169], v9 offset:6272
    v_mfma_f32_16x16x32_bf16 v[244:247], a[180:183], a[116:119], v[244:247]
    ds_read_b64_tr_b16 a[170:171], v9 offset:9856
    v_mfma_f32_16x16x32_bf16 v[240:243], a[180:183], a[112:115], v[240:243]
    v_mfma_f32_16x16x32_bf16 v[240:243], a[176:179], a[96:99], v[240:243]
    v_mfma_f32_16x16x32_bf16 v[236:239], a[176:179], a[92:95], v[236:239]
    ds_read_b64_tr_b16 a[172:173], v9 offset:26752
    s_add_u32 m0, s67, 126976
    s_cmp_ge_u32 s58, 5
    s_cselect_b32 m0, s11, m0
    v_mfma_f32_16x16x32_bf16 v[236:239], a[180:183], a[108:111], v[236:239]
    ds_read_b64_tr_b16 a[174:175], v9 offset:30336
    s_cselect_b32 s63, s10, s63
    s_add_u32 s10, s10, 16384
    s_add_u32 s11, s11, 1024
    v_mfma_f32_16x16x32_bf16 v[232:235], a[180:183], a[104:107], v[232:235]
    buffer_load_dwordx4 v22, s[40:43], s63 offen nt lds
    v_mfma_f32_16x16x32_bf16 v[232:235], a[176:179], a[88:91], v[232:235]
    s_waitcnt lgkmcnt(8)
    v_mfma_f32_16x16x32_bf16 v[136:139], a[152:155], a[88:91], v[136:139]
    ds_read_b64_tr_b16 a[176:177], v9 offset:13440
    v_mfma_f32_16x16x32_bf16 v[136:139], a[156:159], a[104:107], v[136:139]
    ds_read_b64_tr_b16 a[178:179], v9 offset:17024
    v_mfma_f32_16x16x32_bf16 v[140:143], a[156:159], a[108:111], v[140:143]
    v_mfma_f32_16x16x32_bf16 v[140:143], a[152:155], a[92:95], v[140:143]
    v_mfma_f32_16x16x32_bf16 v[144:147], a[152:155], a[96:99], v[144:147]
    ds_read_b64_tr_b16 a[180:181], v9 offset:33920
    v_mfma_f32_16x16x32_bf16 v[144:147], a[156:159], a[112:115], v[144:147]
    ds_read_b64_tr_b16 a[182:183], v9 offset:37504
    v_mfma_f32_16x16x32_bf16 v[148:151], a[156:159], a[116:119], v[148:151]
    v_mfma_f32_16x16x32_bf16 v[148:151], a[152:155], a[100:103], v[148:151]
    s_waitcnt lgkmcnt(8)
    v_mfma_f32_16x16x32_bf16 a[4:7], a[160:163], a[100:103], a[4:7]
    ds_read_b64_tr_b16 a[152:153], v9 offset:6304
    v_mfma_f32_16x16x32_bf16 a[4:7], a[164:167], a[116:119], a[4:7]
    ds_read_b64_tr_b16 a[154:155], v9 offset:9888
    v_mfma_f32_16x16x32_bf16 a[0:3], a[164:167], a[112:115], a[0:3]
    s_add_u32 s57, s57, 40960
    v_mfma_f32_16x16x32_bf16 a[0:3], a[160:163], a[96:99], a[0:3]
    s_cmp_eq_u32 s57, s60
    s_cselect_b32 s57, 0, s57
    v_mfma_f32_16x16x32_bf16 v[252:255], a[160:163], a[92:95], v[252:255]
    ds_read_b64_tr_b16 a[156:157], v9 offset:26784
    v_mfma_f32_16x16x32_bf16 v[252:255], a[164:167], a[108:111], v[252:255]
    ds_read_b64_tr_b16 a[158:159], v9 offset:30368
    v_mfma_f32_16x16x32_bf16 v[248:251], a[164:167], a[104:107], v[248:251]
    v_mfma_f32_16x16x32_bf16 v[248:251], a[160:163], a[88:91], v[248:251]
    s_waitcnt lgkmcnt(8)
    v_mfma_f32_16x16x32_bf16 v[152:155], a[168:171], a[88:91], v[152:155]
    ds_read_b64_tr_b16 a[160:161], v9 offset:13472
    v_mfma_f32_16x16x32_bf16 v[152:155], a[172:175], a[104:107], v[152:155]
    ds_read_b64_tr_b16 a[162:163], v9 offset:17056
    v_mfma_f32_16x16x32_bf16 v[156:159], a[172:175], a[108:111], v[156:159]
    v_mfma_f32_16x16x32_bf16 v[156:159], a[168:171], a[92:95], v[156:159]
    v_mfma_f32_16x16x32_bf16 v[160:163], a[168:171], a[96:99], v[160:163]
    ds_read_b64_tr_b16 a[164:165], v9 offset:33952
    v_mfma_f32_16x16x32_bf16 v[160:163], a[172:175], a[112:115], v[160:163]
    ds_read_b64_tr_b16 a[166:167], v9 offset:37536
    v_mfma_f32_16x16x32_bf16 v[164:167], a[172:175], a[116:119], v[164:167]
    v_mfma_f32_16x16x32_bf16 v[164:167], a[168:171], a[100:103], v[164:167]
    s_waitcnt lgkmcnt(8)
    v_mfma_f32_16x16x32_bf16 a[20:23], a[176:179], a[100:103], a[20:23]
    ds_read_b64_tr_b16 a[168:169], v9 offset:6336
    v_mfma_f32_16x16x32_bf16 a[20:23], a[180:183], a[116:119], a[20:23]
    ds_read_b64_tr_b16 a[170:171], v9 offset:9920
    v_mfma_f32_16x16x32_bf16 a[16:19], a[180:183], a[112:115], a[16:19]
    v_mfma_f32_16x16x32_bf16 a[16:19], a[176:179], a[96:99], a[16:19]
    v_mfma_f32_16x16x32_bf16 a[12:15], a[176:179], a[92:95], a[12:15]
    ds_read_b64_tr_b16 a[172:173], v9 offset:26816
    v_mfma_f32_16x16x32_bf16 a[12:15], a[180:183], a[108:111], a[12:15]
    ds_read_b64_tr_b16 a[174:175], v9 offset:30400
    v_mfma_f32_16x16x32_bf16 a[8:11], a[180:183], a[104:107], a[8:11]
    v_mfma_f32_16x16x32_bf16 a[8:11], a[176:179], a[88:91], a[8:11]
    s_waitcnt lgkmcnt(8)
    v_mfma_f32_16x16x32_bf16 v[168:171], a[152:155], a[88:91], v[168:171]
    ds_read_b64_tr_b16 a[176:177], v9 offset:13504
    v_mfma_f32_16x16x32_bf16 v[168:171], a[156:159], a[104:107], v[168:171]
    ds_read_b64_tr_b16 a[178:179], v9 offset:17088
    v_mfma_f32_16x16x32_bf16 v[172:175], a[156:159], a[108:111], v[172:175]
    v_mfma_f32_16x16x32_bf16 v[172:175], a[152:155], a[92:95], v[172:175]
    v_mfma_f32_16x16x32_bf16 v[176:179], a[152:155], a[96:99], v[176:179]
    ds_read_b64_tr_b16 a[180:181], v9 offset:33984
    v_mfma_f32_16x16x32_bf16 v[176:179], a[156:159], a[112:115], v[176:179]
    ds_read_b64_tr_b16 a[182:183], v9 offset:37568
    v_mfma_f32_16x16x32_bf16 v[180:183], a[156:159], a[116:119], v[180:183]
    v_add_u32 v7, s57, v10
    v_add_u32 v8, s57, v11
    v_mfma_f32_16x16x32_bf16 v[180:183], a[152:155], a[100:103], v[180:183]
    v_add_u32 v9, s57, v12
    s_waitcnt vmcnt(11) lgkmcnt(8)
    s_barrier
    s_cmp_eq_u32 s58, 6
    s_cbranch_scc0 M_l1c
    s_cmp_eq_u32 s48, 0
    s_cbranch_scc0 M_fs3
    v_mov_b32 v14, s12
    v_mov_b32 v15, 3
    s_mov_b64 exec, 1
    buffer_store_dwordx2 v[14:15], off, s[92:95], s90 sc1
    s_mov_b64 exec, -1
M_fs3:
M_l1c:
    v_mfma_f32_16x16x32_bf16 a[36:39], a[160:163], a[100:103], a[36:39]
    ds_read_b64_tr_b16 a[152:153], v9 offset:6144
    v_mfma_f32_16x16x32_bf16 a[36:39], a[164:167], a[116:119], a[36:39]
    ds_read_b64_tr_b16 a[154:155], v9 offset:9728
    v_mfma_f32_16x16x32_bf16 a[32:35], a[164:167], a[112:115], a[32:35]
    v_mfma_f32_16x16x32_bf16 a[32:35], a[160:163], a[96:99], a[32:35]
    v_mfma_f32_16x16x32_bf16 a[28:31], a[160:163], a[92:95], a[28:31]
    ds_read_b64_tr_b16 a[156:157], v9 offset:26624
    s_add_u32 s56, s56, s59
    s_add_u32 s52, s52, s54
    s_add_u32 s53, s53, s55
    v_mfma_f32_16x16x32_bf16 a[28:31], a[164:167], a[108:111], a[28:31]
    ds_read_b64_tr_b16 a[158:159], v9 offset:30208
    s_cmp_eq_u32 s56, s61
    s_cselect_b32 s56, s62, s56
    s_add_u32 m0, s56, 0x400
    v_mfma_f32_16x16x32_bf16 a[24:27], a[164:167], a[104:107], a[24:27]
    buffer_load_dwordx4 v2, s[20:23], s52 offen lds
    v_mfma_f32_16x16x32_bf16 a[24:27], a[160:163], a[88:91], a[24:27]
    s_waitcnt lgkmcnt(8)
    v_mfma_f32_16x16x32_bf16 v[184:187], a[168:171], a[88:91], v[184:187]
    ds_read_b64_tr_b16 a[160:161], v9 offset:13312
    v_mfma_f32_16x16x32_bf16 v[184:187], a[172:175], a[104:107], v[184:187]
    ds_read_b64_tr_b16 a[162:163], v9 offset:16896
    s_add_u32 m0, s56, 0x800
    v_mfma_f32_16x16x32_bf16 v[188:191], a[172:175], a[108:111], v[188:191]
    buffer_load_dwordx4 v3, s[24:27], s53 offen lds
    v_mfma_f32_16x16x32_bf16 v[188:191], a[168:171], a[92:95], v[188:191]
    v_mfma_f32_16x16x32_bf16 v[192:195], a[168:171], a[96:99], v[192:195]
    ds_read_b64_tr_b16 a[164:165], v9 offset:33792
    v_mfma_f32_16x16x32_bf16 v[192:195], a[172:175], a[112:115], v[192:195]
    ds_read_b64_tr_b16 a[166:167], v9 offset:37376
    s_add_u32 m0, s56, 0xc00
    v_mfma_f32_16x16x32_bf16 v[196:199], a[172:175], a[116:119], v[196:199]
    buffer_load_dwordx4 v4, s[28:31], s53 offen lds
    v_mfma_f32_16x16x32_bf16 v[196:199], a[168:171], a[100:103], v[196:199]
    s_waitcnt lgkmcnt(8)
    v_mfma_f32_16x16x32_bf16 a[52:55], a[176:179], a[100:103], a[52:55]
    ds_read_b64_tr_b16 a[168:169], v9 offset:6176
    v_mfma_f32_16x16x32_bf16 a[52:55], a[180:183], a[116:119], a[52:55]
    ds_read_b64_tr_b16 a[170:171], v9 offset:9760
    s_add_u32 m0, s56, 0x1000
    v_mfma_f32_16x16x32_bf16 a[48:51], a[180:183], a[112:115], a[48:51]
    buffer_load_dwordx4 v5, s[32:35], s53 offen lds
    v_mfma_f32_16x16x32_bf16 a[48:51], a[176:179], a[96:99], a[48:51]
    v_mfma_f32_16x16x32_bf16 a[44:47], a[176:179], a[92:95], a[44:47]
    ds_read_b64_tr_b16 a[172:173], v9 offset:26656
    v_mfma_f32_16x16x32_bf16 a[44:47], a[180:183], a[108:111], a[44:47]
    ds_read_b64_tr_b16 a[174:175], v9 offset:30240
    s_add_u32 m0, s56, 0x1400
    v_mfma_f32_16x16x32_bf16 a[40:43], a[180:183], a[104:107], a[40:43]
    buffer_load_dwordx4 v6, s[36:39], s53 offen lds
    v_mfma_f32_16x16x32_bf16 a[40:43], a[176:179], a[88:91], a[40:43]
    s_waitcnt vmcnt(8) lgkmcnt(8)
    v_mfma_f32_16x16x32_bf16 v[88:91], a[152:155], a[120:123], v[88:91]
    ds_read_b64_tr_b16 a[176:177], v9 offset:13344
    v_mfma_f32_16x16x32_bf16 v[88:91], a[156:159], a[136:139], v[88:91]
    ds_read_b64_tr_b16 a[178:179], v9 offset:16928
    v_mfma_f32_16x16x32_bf16 v[92:95], a[156:159], a[140:143], v[92:95]
    v_mfma_f32_16x16x32_bf16 v[92:95], a[152:155], a[124:127], v[92:95]
    v_mfma_f32_16x16x32_bf16 v[96:99], a[152:155], a[128:131], v[96:99]
    ds_read_b64_tr_b16 a[180:181], v9 offset:33824
    s_add_u32 s56, s56, s59
    s_add_u32 s52, s52, s54
    s_add_u32 s53, s53, s55
    v_mfma_f32_16x16x32_bf16 v[96:99], a[156:159], a[144:147], v[96:99]
    ds_read_b64_tr_b16 a[182:183], v9 offset:37408
    s_cmp_eq_u32 s56, s61
    s_cselect_b32 s56, s62, s56
    s_add_u32 m0, s56, 0x400
    v_mfma_f32_16x16x32_bf16 v[100:103], a[156:159], a[148:151], v[100:103]
    buffer_load_dwordx4 v2, s[20:23], s52 offen lds
    v_mfma_f32_16x16x32_bf16 v[100:103], a[152:155], a[132:135], v[100:103]
    s_waitcnt lgkmcnt(8)
    v_mfma_f32_16x16x32_bf16 v[212:215], a[160:163], a[132:135], v[212:215]
    ds_read_b64_tr_b16 a[152:153], v7 offset:2048
    v_mfma_f32_16x16x32_bf16 v[212:215], a[164:167], a[148:151], v[212:215]
    ds_read_b64_tr_b16 a[154:155], v7 offset:3072
    v_mfma_f32_16x16x32_bf16 v[208:211], a[164:167], a[144:147], v[208:211]
    v_mfma_f32_16x16x32_bf16 v[208:211], a[160:163], a[128:131], v[208:211]
    v_mfma_f32_16x16x32_bf16 v[204:207], a[160:163], a[124:127], v[204:207]
    ds_read_b64_tr_b16 a[156:157], v7 offset:22528
    v_mfma_f32_16x16x32_bf16 v[204:207], a[164:167], a[140:143], v[204:207]
    ds_read_b64_tr_b16 a[158:159], v7 offset:23552
    s_add_u32 m0, s56, 0x800
    v_mfma_f32_16x16x32_bf16 v[200:203], a[164:167], a[136:139], v[200:203]
    buffer_load_dwordx4 v3, s[24:27], s53 offen lds
    v_mfma_f32_16x16x32_bf16 v[200:203], a[160:163], a[120:123], v[200:203]
    s_waitcnt lgkmcnt(8)
    v_mfma_f32_16x16x32_bf16 v[104:107], a[168:171], a[120:123], v[104:107]
    ds_read_b64_tr_b16 a[160:161], v8 offset:2048
    v_mfma_f32_16x16x32_bf16 v[104:107], a[172:175], a[136:139], v[104:107]
    ds_read_b64_tr_b16 a[162:163], v8 offset:3072
    s_add_u32 m0, s56, 0xc00
    v_mfma_f32_16x16x32_bf16 v[108:111], a[172:175], a[140:143], v[108:111]
    buffer_load_dwordx4 v4, s[28:31], s53 offen lds
    v_mfma_f32_16x16x32_bf16 v[108:111], a[168:171], a[124:127], v[108:111]
    v_mfma_f32_16x16x32_bf16 v[112:115], a[168:171], a[128:131], v[112:115]
    ds_read_b64_tr_b16 a[164:165], v8 offset:22528
    v_mfma_f32_16x16x32_bf16 v[112:115], a[172:175], a[144:147], v[112:115]
    ds_read_b64_tr_b16 a[166:167], v8 offset:23552
    v_mfma_f32_16x16x32_bf16 v[116:119], a[172:175], a[148:151], v[116:119]
    v_mfma_f32_16x16x32_bf16 v[116:119], a[168:171], a[132:135], v[116:119]
    s_waitcnt lgkmcnt(8)
    v_mfma_f32_16x16x32_bf16 v[228:231], a[176:179], a[132:135], v[228:231]
    ds_read_b64_tr_b16 a[168:169], v7 offset:4096
    v_mfma_f32_16x16x32_bf16 v[228:231], a[180:183], a[148:151], v[228:231]
    ds_read_b64_tr_b16 a[170:171], v7 offset:5120
    s_add_u32 m0, s56, 0x1000
    v_mfma_f32_16x16x32_bf16 v[224:227], a[180:183], a[144:147], v[224:227]
    buffer_load_dwordx4 v5, s[32:35], s53 offen lds
    v_mfma_f32_16x16x32_bf16 v[224:227], a[176:179], a[128:131], v[224:227]
    v_mfma_f32_16x16x32_bf16 v[220:223], a[176:179], a[124:127], v[220:223]
    ds_read_b64_tr_b16 a[172:173], v7 offset:24576
    v_mfma_f32_16x16x32_bf16 v[220:223], a[180:183], a[140:143], v[220:223]
    ds_read_b64_tr_b16 a[174:175], v7 offset:25600
    s_add_u32 m0, s56, 0x1400
    v_mfma_f32_16x16x32_bf16 v[216:219], a[180:183], a[136:139], v[216:219]
    buffer_load_dwordx4 v6, s[36:39], s53 offen lds
    v_mfma_f32_16x16x32_bf16 v[216:219], a[176:179], a[120:123], v[216:219]
    s_waitcnt lgkmcnt(8)
    v_mfma_f32_16x16x32_bf16 v[24:27], a[120:123], a[152:155], v[24:27]
    ds_read_b64_tr_b16 a[176:177], v8 offset:4096
    v_mfma_f32_16x16x32_bf16 v[24:27], a[136:139], a[156:159], v[24:27]
    ds_read_b64_tr_b16 a[178:179], v8 offset:5120
    v_mfma_f32_16x16x32_bf16 v[28:31], a[140:143], a[156:159], v[28:31]
    v_mfma_f32_16x16x32_bf16 v[28:31], a[124:127], a[152:155], v[28:31]
    v_mfma_f32_16x16x32_bf16 v[32:35], a[128:131], a[152:155], v[32:35]
    ds_read_b64_tr_b16 a[180:181], v8 offset:24576
    v_mfma_f32_16x16x32_bf16 v[32:35], a[144:147], a[156:159], v[32:35]
    ds_read_b64_tr_b16 a[182:183], v8 offset:25600
    v_mfma_f32_16x16x32_bf16 v[36:39], a[148:151], a[156:159], v[36:39]
    buffer_load_dwordx4 a[88:91], v1, s[16:19], s51 offen offset:0 sc1
    v_mfma_f32_16x16x32_bf16 v[36:39], a[132:135], a[152:155], v[36:39]
    s_waitcnt lgkmcnt(8)
    v_mfma_f32_16x16x32_bf16 v[52:55], a[132:135], a[160:163], v[52:55]
    ds_read_b64_tr_b16 a[152:153], v7 offset:0
    v_mfma_f32_16x16x32_bf16 v[52:55], a[148:151], a[164:167], v[52:55]
    ds_read_b64_tr_b16 a[154:155], v7 offset:1024
    v_mfma_f32_16x16x32_bf16 v[48:51], a[144:147], a[164:167], v[48:51]
    buffer_load_dwordx4 a[92:95], v1, s[16:19], s51 offen offset:1024 sc1
    v_mfma_f32_16x16x32_bf16 v[48:51], a[128:131], a[160:163], v[48:51]
    v_mfma_f32_16x16x32_bf16 v[44:47], a[124:127], a[160:163], v[44:47]
    ds_read_b64_tr_b16 a[156:157], v7 offset:20480
    v_mfma_f32_16x16x32_bf16 v[44:47], a[140:143], a[164:167], v[44:47]
    ds_read_b64_tr_b16 a[158:159], v7 offset:21504
    v_mfma_f32_16x16x32_bf16 v[40:43], a[136:139], a[164:167], v[40:43]
    buffer_load_dwordx4 a[96:99], v1, s[16:19], s51 offen offset:2048 sc1
    v_mfma_f32_16x16x32_bf16 v[40:43], a[120:123], a[160:163], v[40:43]
    s_waitcnt lgkmcnt(8)
    v_mfma_f32_16x16x32_bf16 v[56:59], a[120:123], a[168:171], v[56:59]
    ds_read_b64_tr_b16 a[160:161], v8 offset:0
    v_mfma_f32_16x16x32_bf16 v[56:59], a[136:139], a[172:175], v[56:59]
    ds_read_b64_tr_b16 a[162:163], v8 offset:1024
    v_mfma_f32_16x16x32_bf16 v[60:63], a[140:143], a[172:175], v[60:63]
    v_mfma_f32_16x16x32_bf16 v[60:63], a[124:127], a[168:171], v[60:63]
    v_mfma_f32_16x16x32_bf16 v[64:67], a[128:131], a[168:171], v[64:67]
    ds_read_b64_tr_b16 a[164:165], v8 offset:20480
    v_mfma_f32_16x16x32_bf16 v[64:67], a[144:147], a[172:175], v[64:67]
    ds_read_b64_tr_b16 a[166:167], v8 offset:21504
    v_mfma_f32_16x16x32_bf16 v[68:71], a[148:151], a[172:175], v[68:71]
    buffer_load_dwordx4 a[100:103], v1, s[16:19], s51 offen offset:3072 sc1
    v_mfma_f32_16x16x32_bf16 v[68:71], a[132:135], a[168:171], v[68:71]
    s_add_u32 s51, s51, 0x20000
    s_waitcnt lgkmcnt(8)
    v_mfma_f32_16x16x32_bf16 v[84:87], a[132:135], a[176:179], v[84:87]
    ds_read_b64_tr_b16 a[168:169], v9 offset:6208
    v_mfma_f32_16x16x32_bf16 v[84:87], a[148:151], a[180:183], v[84:87]
    ds_read_b64_tr_b16 a[170:171], v9 offset:9792
    v_mfma_f32_16x16x32_bf16 v[80:83], a[144:147], a[180:183], v[80:83]
    buffer_load_dwordx4 a[104:107], v1, s[16:19], s51 offen offset:0 sc1
    v_mfma_f32_16x16x32_bf16 v[80:83], a[128:131], a[176:179], v[80:83]
    v_mfma_f32_16x16x32_bf16 v[76:79], a[124:127], a[176:179], v[76:79]
    ds_read_b64_tr_b16 a[172:173], v9 offset:26688
    v_mfma_f32_16x16x32_bf16 v[76:79], a[140:143], a[180:183], v[76:79]
    ds_read_b64_tr_b16 a[174:175], v9 offset:30272
    v_mfma_f32_16x16x32_bf16 v[72:75], a[136:139], a[180:183], v[72:75]
    buffer_load_dwordx4 a[108:111], v1, s[16:19], s51 offen offset:1024 sc1
    v_mfma_f32_16x16x32_bf16 v[72:75], a[120:123], a[176:179], v[72:75]
    s_waitcnt lgkmcnt(8)
    v_mfma_f32_16x16x32_bf16 a[56:59], a[152:155], a[120:123], a[56:59]
    ds_read_b64_tr_b16 a[176:177], v9 offset:13376
    v_mfma_f32_16x16x32_bf16 a[56:59], a[156:159], a[136:139], a[56:59]
    ds_read_b64_tr_b16 a[178:179], v9 offset:16960
    v_mfma_f32_16x16x32_bf16 a[60:63], a[156:159], a[140:143], a[60:63]
    v_mfma_f32_16x16x32_bf16 a[60:63], a[152:155], a[124:127], a[60:63]
    v_mfma_f32_16x16x32_bf16 a[64:67], a[152:155], a[128:131], a[64:67]
    ds_read_b64_tr_b16 a[180:181], v9 offset:33856
    v_mfma_f32_16x16x32_bf16 a[64:67], a[156:159], a[144:147], a[64:67]
    ds_read_b64_tr_b16 a[182:183], v9 offset:37440
    v_mfma_f32_16x16x32_bf16 a[68:71], a[156:159], a[148:151], a[68:71]
    buffer_load_dwordx4 a[112:115], v1, s[16:19], s51 offen offset:2048 sc1
    v_mfma_f32_16x16x32_bf16 a[68:71], a[152:155], a[132:135], a[68:71]
    s_waitcnt lgkmcnt(8)
    v_mfma_f32_16x16x32_bf16 a[84:87], a[160:163], a[132:135], a[84:87]
    ds_read_b64_tr_b16 a[152:153], v9 offset:6240
    v_mfma_f32_16x16x32_bf16 a[84:87], a[164:167], a[148:151], a[84:87]
    ds_read_b64_tr_b16 a[154:155], v9 offset:9824
    v_mfma_f32_16x16x32_bf16 a[80:83], a[164:167], a[144:147], a[80:83]
    buffer_load_dwordx4 a[116:119], v1, s[16:19], s51 offen offset:3072 sc1
    v_mfma_f32_16x16x32_bf16 a[80:83], a[160:163], a[128:131], a[80:83]
    s_add_u32 s51, s51, 0x20000
    v_mfma_f32_16x16x32_bf16 a[76:79], a[160:163], a[124:127], a[76:79]
    ds_read_b64_tr_b16 a[156:157], v9 offset:26720
    v_mfma_f32_16x16x32_bf16 a[76:79], a[164:167], a[140:143], a[76:79]
    ds_read_b64_tr_b16 a[158:159], v9 offset:30304
    v_mfma_f32_16x16x32_bf16 a[72:75], a[164:167], a[136:139], a[72:75]
    buffer_store_dwordx4 a[212:215], v16, s[72:75], s3 offen sc1
    v_mfma_f32_16x16x32_bf16 a[72:75], a[160:163], a[120:123], a[72:75]
    s_add_u32 s3, s3, 0x100000
    s_waitcnt lgkmcnt(8)
    v_mfma_f32_16x16x32_bf16 v[120:123], a[168:171], a[120:123], v[120:123]
    ds_read_b64_tr_b16 a[160:161], v9 offset:13408
    v_mfma_f32_16x16x32_bf16 v[120:123], a[172:175], a[136:139], v[120:123]
    ds_read_b64_tr_b16 a[162:163], v9 offset:16992
    v_mfma_f32_16x16x32_bf16 v[124:127], a[172:175], a[140:143], v[124:127]
    v_mfma_f32_16x16x32_bf16 v[124:127], a[168:171], a[124:127], v[124:127]
    v_mfma_f32_16x16x32_bf16 v[128:131], a[168:171], a[128:131], v[128:131]
    ds_read_b64_tr_b16 a[164:165], v9 offset:33888
    v_mfma_f32_16x16x32_bf16 v[128:131], a[172:175], a[144:147], v[128:131]
    ds_read_b64_tr_b16 a[166:167], v9 offset:37472
    v_mfma_f32_16x16x32_bf16 v[132:135], a[172:175], a[148:151], v[132:135]
    buffer_load_dword v23, v20, s[76:79], s88 offen
    v_mfma_f32_16x16x32_bf16 v[132:135], a[168:171], a[132:135], v[132:135]
    s_waitcnt lgkmcnt(8)
    v_mfma_f32_16x16x32_bf16 v[244:247], a[176:179], a[132:135], v[244:247]
    ds_read_b64_tr_b16 a[168:169], v9 offset:6272
    v_mfma_f32_16x16x32_bf16 v[244:247], a[180:183], a[148:151], v[244:247]
    ds_read_b64_tr_b16 a[170:171], v9 offset:9856
    v_mfma_f32_16x16x32_bf16 v[240:243], a[180:183], a[144:147], v[240:243]
    buffer_load_dword v23, v21, s[80:83], s89 offen
    v_mfma_f32_16x16x32_bf16 v[240:243], a[176:179], a[128:131], v[240:243]
    v_mfma_f32_16x16x32_bf16 v[236:239], a[176:179], a[124:127], v[236:239]
    ds_read_b64_tr_b16 a[172:173], v9 offset:26752
    v_mfma_f32_16x16x32_bf16 v[236:239], a[180:183], a[140:143], v[236:239]
    ds_read_b64_tr_b16 a[174:175], v9 offset:30336
    v_mfma_f32_16x16x32_bf16 v[232:235], a[180:183], a[136:139], v[232:235]
    buffer_load_dword v23, v21, s[44:47], s89 offen
    v_mfma_f32_16x16x32_bf16 v[232:235], a[176:179], a[120:123], v[232:235]
    s_waitcnt lgkmcnt(8)
    v_mfma_f32_16x16x32_bf16 v[136:139], a[152:155], a[120:123], v[136:139]
    ds_read_b64_tr_b16 a[176:177], v9 offset:13440
    v_mfma_f32_16x16x32_bf16 v[136:139], a[156:159], a[136:139], v[136:139]
    ds_read_b64_tr_b16 a[178:179], v9 offset:17024
    v_mfma_f32_16x16x32_bf16 v[140:143], a[156:159], a[140:143], v[140:143]
    global_load_dword v23, v18, s[4:5]
    v_mfma_f32_16x16x32_bf16 v[140:143], a[152:155], a[124:127], v[140:143]
    v_mfma_f32_16x16x32_bf16 v[144:147], a[152:155], a[128:131], v[144:147]
    ds_read_b64_tr_b16 a[180:181], v9 offset:33920
    v_mfma_f32_16x16x32_bf16 v[144:147], a[156:159], a[144:147], v[144:147]
    ds_read_b64_tr_b16 a[182:183], v9 offset:37504
    v_mfma_f32_16x16x32_bf16 v[148:151], a[156:159], a[148:151], v[148:151]
    v_mfma_f32_16x16x32_bf16 v[148:151], a[152:155], a[132:135], v[148:151]
    s_waitcnt lgkmcnt(8)
    v_mfma_f32_16x16x32_bf16 a[4:7], a[160:163], a[132:135], a[4:7]
    ds_read_b64_tr_b16 a[152:153], v9 offset:6304
    v_mfma_f32_16x16x32_bf16 a[4:7], a[164:167], a[148:151], a[4:7]
    ds_read_b64_tr_b16 a[154:155], v9 offset:9888
    v_mfma_f32_16x16x32_bf16 a[0:3], a[164:167], a[144:147], a[0:3]
    s_add_u32 s57, s57, 40960
    v_mfma_f32_16x16x32_bf16 a[0:3], a[160:163], a[128:131], a[0:3]
    s_cmp_eq_u32 s57, s60
    s_cselect_b32 s57, 0, s57
    v_mfma_f32_16x16x32_bf16 v[252:255], a[160:163], a[124:127], v[252:255]
    ds_read_b64_tr_b16 a[156:157], v9 offset:26784
    v_mfma_f32_16x16x32_bf16 v[252:255], a[164:167], a[140:143], v[252:255]
    ds_read_b64_tr_b16 a[158:159], v9 offset:30368
    v_mfma_f32_16x16x32_bf16 v[248:251], a[164:167], a[136:139], v[248:251]
    s_sub_u32 s63, s63, 3604480
    v_mfma_f32_16x16x32_bf16 v[248:251], a[160:163], a[120:123], v[248:251]
    s_cmp_eq_u32 s58, 2
    s_cselect_b32 s63, s64, s63
    s_waitcnt lgkmcnt(8)
    v_mfma_f32_16x16x32_bf16 v[152:155], a[168:171], a[120:123], v[152:155]
    ds_read_b64_tr_b16 a[160:161], v9 offset:13472
    v_mfma_f32_16x16x32_bf16 v[152:155], a[172:175], a[136:139], v[152:155]
    ds_read_b64_tr_b16 a[162:163], v9 offset:17056
    v_mfma_f32_16x16x32_bf16 v[156:159], a[172:175], a[140:143], v[156:159]
    s_cmp_eq_u32 s58, 3
    s_cselect_b32 s63, s66, s63
    v_mfma_f32_16x16x32_bf16 v[156:159], a[168:171], a[124:127], v[156:159]
    s_cmp_eq_u32 s58, 4
    s_cselect_b32 s40, s8, s40
    s_cselect_b32 s41, s9, s41
    s_cselect_b32 s42, 0x400000, s42
    v_mfma_f32_16x16x32_bf16 v[160:163], a[168:171], a[128:131], v[160:163]
    ds_read_b64_tr_b16 a[164:165], v9 offset:33952
    v_mfma_f32_16x16x32_bf16 v[160:163], a[172:175], a[144:147], v[160:163]
    ds_read_b64_tr_b16 a[166:167], v9 offset:37536
    v_mfma_f32_16x16x32_bf16 v[164:167], a[172:175], a[148:151], v[164:167]
    s_add_u32 s88, s88, 786432
    v_mfma_f32_16x16x32_bf16 v[164:167], a[168:171], a[132:135], v[164:167]
    s_add_u32 s89, s89, 917504
    s_waitcnt lgkmcnt(8)
    v_mfma_f32_16x16x32_bf16 a[20:23], a[176:179], a[132:135], a[20:23]
    ds_read_b64_tr_b16 a[168:169], v9 offset:6336
    v_mfma_f32_16x16x32_bf16 a[20:23], a[180:183], a[148:151], a[20:23]
    ds_read_b64_tr_b16 a[170:171], v9 offset:9920
    v_mfma_f32_16x16x32_bf16 a[16:19], a[180:183], a[144:147], a[16:19]
    s_add_u32 s58, s58, 1
    v_mfma_f32_16x16x32_bf16 a[16:19], a[176:179], a[128:131], a[16:19]
    v_mfma_f32_16x16x32_bf16 a[12:15], a[176:179], a[124:127], a[12:15]
    ds_read_b64_tr_b16 a[172:173], v9 offset:26816
    v_mfma_f32_16x16x32_bf16 a[12:15], a[180:183], a[140:143], a[12:15]
    ds_read_b64_tr_b16 a[174:175], v9 offset:30400
    v_mfma_f32_16x16x32_bf16 a[8:11], a[180:183], a[136:139], a[8:11]
    v_mfma_f32_16x16x32_bf16 a[8:11], a[176:179], a[120:123], a[8:11]
    s_waitcnt lgkmcnt(8)
    v_mfma_f32_16x16x32_bf16 v[168:171], a[152:155], a[120:123], v[168:171]
    ds_read_b64_tr_b16 a[176:177], v9 offset:13504
    v_mfma_f32_16x16x32_bf16 v[168:171], a[156:159], a[136:139], v[168:171]
    ds_read_b64_tr_b16 a[178:179], v9 offset:17088
    v_mfma_f32_16x16x32_bf16 v[172:175], a[156:159], a[140:143], v[172:175]
    v_mfma_f32_16x16x32_bf16 v[172:175], a[152:155], a[124:127], v[172:175]
    v_mfma_f32_16x16x32_bf16 v[176:179], a[152:155], a[128:131], v[176:179]
    ds_read_b64_tr_b16 a[180:181], v9 offset:33984
    v_mfma_f32_16x16x32_bf16 v[176:179], a[156:159], a[144:147], v[176:179]
    ds_read_b64_tr_b16 a[182:183], v9 offset:37568
    v_mfma_f32_16x16x32_bf16 v[180:183], a[156:159], a[148:151], v[180:183]
    v_add_u32 v7, s57, v10
    v_add_u32 v8, s57, v11
    v_mfma_f32_16x16x32_bf16 v[180:183], a[152:155], a[132:135], v[180:183]
    v_add_u32 v9, s57, v12
    s_waitcnt vmcnt(13) lgkmcnt(8)
    s_barrier
    v_mfma_f32_16x16x32_bf16 a[36:39], a[160:163], a[132:135], a[36:39]
    ds_read_b64_tr_b16 a[152:153], v9 offset:6144
    v_mfma_f32_16x16x32_bf16 a[36:39], a[164:167], a[148:151], a[36:39]
    ds_read_b64_tr_b16 a[154:155], v9 offset:9728
    v_mfma_f32_16x16x32_bf16 a[32:35], a[164:167], a[144:147], a[32:35]
    v_mfma_f32_16x16x32_bf16 a[32:35], a[160:163], a[128:131], a[32:35]
    v_mfma_f32_16x16x32_bf16 a[28:31], a[160:163], a[124:127], a[28:31]
    ds_read_b64_tr_b16 a[156:157], v9 offset:26624
    s_add_u32 s56, s56, s59
    s_add_u32 s52, s52, s54
    s_add_u32 s53, s53, s55
    v_mfma_f32_16x16x32_bf16 a[28:31], a[164:167], a[140:143], a[28:31]
    ds_read_b64_tr_b16 a[158:159], v9 offset:30208
    s_cmp_eq_u32 s56, s61
    s_cselect_b32 s56, s62, s56
    s_add_u32 m0, s56, 0x400
    v_mfma_f32_16x16x32_bf16 a[24:27], a[164:167], a[136:139], a[24:27]
    buffer_load_dwordx4 v2, s[20:23], s52 offen lds
    v_mfma_f32_16x16x32_bf16 a[24:27], a[160:163], a[120:123], a[24:27]
    s_waitcnt lgkmcnt(8)
    v_mfma_f32_16x16x32_bf16 v[184:187], a[168:171], a[120:123], v[184:187]
    ds_read_b64_tr_b16 a[160:161], v9 offset:13312
    v_mfma_f32_16x16x32_bf16 v[184:187], a[172:175], a[136:139], v[184:187]
    ds_read_b64_tr_b16 a[162:163], v9 offset:16896
    s_add_u32 m0, s56, 0x800
    v_mfma_f32_16x16x32_bf16 v[188:191], a[172:175], a[140:143], v[188:191]
    buffer_load_dwordx4 v3, s[24:27], s53 offen lds
    v_mfma_f32_16x16x32_bf16 v[188:191], a[168:171], a[124:127], v[188:191]
    v_mfma_f32_16x16x32_bf16 v[192:195], a[168:171], a[128:131], v[192:195]
    ds_read_b64_tr_b16 a[164:165], v9 offset:33792
    v_mfma_f32_16x16x32_bf16 v[192:195], a[172:175], a[144:147], v[192:195]
    ds_read_b64_tr_b16 a[166:167], v9 offset:37376
    s_add_u32 m0, s56, 0xc00
    v_mfma_f32_16x16x32_bf16 v[196:199], a[172:175], a[148:151], v[196:199]
    buffer_load_dwordx4 v4, s[28:31], s53 offen lds
    v_mfma_f32_16x16x32_bf16 v[196:199], a[168:171], a[132:135], v[196:199]
    s_waitcnt lgkmcnt(8)
    v_mfma_f32_16x16x32_bf16 a[52:55], a[176:179], a[132:135], a[52:55]
    ds_read_b64_tr_b16 a[168:169], v9 offset:6176
    v_mfma_f32_16x16x32_bf16 a[52:55], a[180:183], a[148:151], a[52:55]
    ds_read_b64_tr_b16 a[170:171], v9 offset:9760
    s_add_u32 m0, s56, 0x1000
    v_mfma_f32_16x16x32_bf16 a[48:51], a[180:183], a[144:147], a[48:51]
    buffer_load_dwordx4 v5, s[32:35], s53 offen lds
    v_mfma_f32_16x16x32_bf16 a[48:51], a[176:179], a[128:131], a[48:51]
    v_mfma_f32_16x16x32_bf16 a[44:47], a[176:179], a[124:127], a[44:47]
    ds_read_b64_tr_b16 a[172:173], v9 offset:26656
    v_mfma_f32_16x16x32_bf16 a[44:47], a[180:183], a[140:143], a[44:47]
    ds_read_b64_tr_b16 a[174:175], v9 offset:30240
    s_add_u32 m0, s56, 0x1400
    v_mfma_f32_16x16x32_bf16 a[40:43], a[180:183], a[136:139], a[40:43]
    buffer_load_dwordx4 v6, s[36:39], s53 offen lds
    v_mfma_f32_16x16x32_bf16 a[40:43], a[176:179], a[120:123], a[40:43]
    s_cmp_lt_u32 s58, 7
    s_cbranch_scc1 M_loop1
    s_waitcnt vmcnt(10) lgkmcnt(8)
    v_mfma_f32_16x16x32_bf16 v[88:91], a[152:155], a[88:91], v[88:91]
    ds_read_b64_tr_b16 a[176:177], v9 offset:13344
    v_mfma_f32_16x16x32_bf16 v[88:91], a[156:159], a[104:107], v[88:91]
    ds_read_b64_tr_b16 a[178:179], v9 offset:16928
    v_mfma_f32_16x16x32_bf16 v[92:95], a[156:159], a[108:111], v[92:95]
    s_add_u32 s56, s56, s59
    s_add_u32 s52, s52, s54
    s_add_u32 s53, s53, s55
    s_cmp_eq_u32 s56, s61
    s_cselect_b32 s56, s62, s56
    s_add_u32 m0, s56, 0x400
    s_nop 0
    buffer_load_dwordx4 v2, s[20:23], s52 offen lds
    v_mfma_f32_16x16x32_bf16 v[92:95], a[152:155], a[92:95], v[92:95]
    v_mfma_f32_16x16x32_bf16 v[96:99], a[152:155], a[96:99], v[96:99]
    ds_read_b64_tr_b16 a[180:181], v9 offset:33824
    v_mfma_f32_16x16x32_bf16 v[96:99], a[156:159], a[112:115], v[96:99]
    ds_read_b64_tr_b16 a[182:183], v9 offset:37408
    v_mfma_f32_16x16x32_bf16 v[100:103], a[156:159], a[116:119], v[100:103]
    s_add_u32 m0, s56, 0x800
    s_nop 0
    buffer_load_dwordx4 v3, s[24:27], s53 offen lds
    v_mfma_f32_16x16x32_bf16 v[100:103], a[152:155], a[100:103], v[100:103]
    s_waitcnt lgkmcnt(8)
    v_mfma_f32_16x16x32_bf16 v[212:215], a[160:163], a[100:103], v[212:215]
    ds_read_b64_tr_b16 a[152:153], v7 offset:2048
    v_mfma_f32_16x16x32_bf16 v[212:215], a[164:167], a[116:119], v[212:215]
    ds_read_b64_tr_b16 a[154:155], v7 offset:3072
    v_mfma_f32_16x16x32_bf16 v[208:211], a[164:167], a[112:115], v[208:211]
    s_add_u32 m0, s56, 0xc00
    s_nop 0
    buffer_load_dwordx4 v4, s[28:31], s53 offen lds
    v_mfma_f32_16x16x32_bf16 v[208:211], a[160:163], a[96:99], v[208:211]
    v_mfma_f32_16x16x32_bf16 v[204:207], a[160:163], a[92:95], v[204:207]
    ds_read_b64_tr_b16 a[156:157], v7 offset:22528
    v_mfma_f32_16x16x32_bf16 v[204:207], a[164:167], a[108:111], v[204:207]
    ds_read_b64_tr_b16 a[158:159], v7 offset:23552
    v_mfma_f32_16x16x32_bf16 v[200:203], a[164:167], a[104:107], v[200:203]
    s_add_u32 m0, s56, 0x1000
    s_nop 0
    buffer_load_dwordx4 v5, s[32:35], s53 offen lds
    v_mfma_f32_16x16x32_bf16 v[200:203], a[160:163], a[88:91], v[200:203]
    s_waitcnt lgkmcnt(8)
    v_mfma_f32_16x16x32_bf16 v[104:107], a[168:171], a[88:91], v[104:107]
    ds_read_b64_tr_b16 a[160:161], v8 offset:2048
    v_mfma_f32_16x16x32_bf16 v[104:107], a[172:175], a[104:107], v[104:107]
    ds_read_b64_tr_b16 a[162:163], v8 offset:3072
    v_mfma_f32_16x16x32_bf16 v[108:111], a[172:175], a[108:111], v[108:111]
    s_add_u32 m0, s56, 0x1400
    s_nop 0
    buffer_load_dwordx4 v6, s[36:39], s53 offen lds
    v_mfma_f32_16x16x32_bf16 v[108:111], a[168:171], a[92:95], v[108:111]
    v_mfma_f32_16x16x32_bf16 v[112:115], a[168:171], a[96:99], v[112:115]
    ds_read_b64_tr_b16 a[164:165], v8 offset:22528
    v_mfma_f32_16x16x32_bf16 v[112:115], a[172:175], a[112:115], v[112:115]
    ds_read_b64_tr_b16 a[166:167], v8 offset:23552
    v_mfma_f32_16x16x32_bf16 v[116:119], a[172:175], a[116:119], v[116:119]
    s_nop 0
    buffer_load_dwordx4 a[120:123], v1, s[16:19], s51 offen offset:0 sc1
    v_mfma_f32_16x16x32_bf16 v[116:119], a[168:171], a[100:103], v[116:119]
    s_waitcnt lgkmcnt(8)
    v_mfma_f32_16x16x32_bf16 v[228:231], a[176:179], a[100:103], v[228:231]
    ds_read_b64_tr_b16 a[168:169], v7 offset:4096
    v_mfma_f32_16x16x32_bf16 v[228:231], a[180:183], a[116:119], v[228:231]
    ds_read_b64_tr_b16 a[170:171], v7 offset:5120
    v_mfma_f32_16x16x32_bf16 v[224:227], a[180:183], a[112:115], v[224:227]
    s_nop 0
    buffer_load_dwordx4 a[124:127], v1, s[16:19], s51 offen offset:1024 sc1
    v_mfma_f32_16x16x32_bf16 v[224:227], a[176:179], a[96:99], v[224:227]
    v_mfma_f32_16x16x32_bf16 v[220:223], a[176:179], a[92:95], v[220:223]
    ds_read_b64_tr_b16 a[172:173], v7 offset:24576
    v_mfma_f32_16x16x32_bf16 v[220:223], a[180:183], a[108:111], v[220:223]
    ds_read_b64_tr_b16 a[174:175], v7 offset:25600
    v_mfma_f32_16x16x32_bf16 v[216:219], a[180:183], a[104:107], v[216:219]
    s_nop 0
    buffer_load_dwordx4 a[128:131], v1, s[16:19], s51 offen offset:2048 sc1
    v_mfma_f32_16x16x32_bf16 v[216:219], a[176:179], a[88:91], v[216:219]
    s_waitcnt lgkmcnt(8)
    v_mfma_f32_16x16x32_bf16 v[24:27], a[88:91], a[152:155], v[24:27]
    ds_read_b64_tr_b16 a[176:177], v8 offset:4096
    v_mfma_f32_16x16x32_bf16 v[24:27], a[104:107], a[156:159], v[24:27]
    ds_read_b64_tr_b16 a[178:179], v8 offset:5120
    v_mfma_f32_16x16x32_bf16 v[28:31], a[108:111], a[156:159], v[28:31]
    s_nop 0
    buffer_load_dwordx4 a[132:135], v1, s[16:19], s51 offen offset:3072 sc1
    s_add_u32 s51, s51, 0x20000
    v_mfma_f32_16x16x32_bf16 v[28:31], a[92:95], a[152:155], v[28:31]
    v_mfma_f32_16x16x32_bf16 v[32:35], a[96:99], a[152:155], v[32:35]
    ds_read_b64_tr_b16 a[180:181], v8 offset:24576
    v_mfma_f32_16x16x32_bf16 v[32:35], a[112:115], a[156:159], v[32:35]
    ds_read_b64_tr_b16 a[182:183], v8 offset:25600
    v_mfma_f32_16x16x32_bf16 v[36:39], a[116:119], a[156:159], v[36:39]
    s_nop 0
    buffer_load_dwordx4 a[136:139], v1, s[16:19], s51 offen offset:0 sc1
    v_mfma_f32_16x16x32_bf16 v[36:39], a[100:103], a[152:155], v[36:39]
    s_waitcnt lgkmcnt(8)
    v_mfma_f32_16x16x32_bf16 v[52:55], a[100:103], a[160:163], v[52:55]
    ds_read_b64_tr_b16 a[152:153], v7 offset:0
    v_mfma_f32_16x16x32_bf16 v[52:55], a[116:119], a[164:167], v[52:55]
    ds_read_b64_tr_b16 a[154:155], v7 offset:1024
    v_mfma_f32_16x16x32_bf16 v[48:51], a[112:115], a[164:167], v[48:51]
    s_nop 0
    buffer_load_dwordx4 a[140:143], v1, s[16:19], s51 offen offset:1024 sc1
    v_mfma_f32_16x16x32_bf16 v[48:51], a[96:99], a[160:163], v[48:51]
    v_mfma_f32_16x16x32_bf16 v[44:47], a[92:95], a[160:163], v[44:47]
    ds_read_b64_tr_b16 a[156:157], v7 offset:20480
    v_mfma_f32_16x16x32_bf16 v[44:47], a[108:111], a[164:167], v[44:47]
    ds_read_b64_tr_b16 a[158:159], v7 offset:21504
    v_mfma_f32_16x16x32_bf16 v[40:43], a[104:107], a[164:167], v[40:43]
    s_nop 0
    buffer_load_dwordx4 a[144:147], v1, s[16:19], s51 offen offset:2048 sc1
    v_mfma_f32_16x16x32_bf16 v[40:43], a[88:91], a[160:163], v[40:43]
    s_waitcnt lgkmcnt(8)
    v_mfma_f32_16x16x32_bf16 v[56:59], a[88:91], a[168:171], v[56:59]
    ds_read_b64_tr_b16 a[160:161], v8 offset:0
    v_mfma_f32_16x16x32_bf16 v[56:59], a[104:107], a[172:175], v[56:59]
    ds_read_b64_tr_b16 a[162:163], v8 offset:1024
    v_mfma_f32_16x16x32_bf16 v[60:63], a[108:111], a[172:175], v[60:63]
    s_nop 0
    buffer_load_dwordx4 a[148:151], v1, s[16:19], s51 offen offset:3072 sc1
    s_add_u32 s51, s51, 0x20000
    v_mfma_f32_16x16x32_bf16 v[60:63], a[92:95], a[168:171], v[60:63]
    v_mfma_f32_16x16x32_bf16 v[64:67], a[96:99], a[168:171], v[64:67]
    ds_read_b64_tr_b16 a[164:165], v8 offset:20480
    v_mfma_f32_16x16x32_bf16 v[64:67], a[112:115], a[172:175], v[64:67]
    ds_read_b64_tr_b16 a[166:167], v8 offset:21504
    v_mfma_f32_16x16x32_bf16 v[68:71], a[116:119], a[172:175], v[68:71]
    s_add_u32 s20, s14, 0x400000
    s_addc_u32 s21, s15, 0
    s_mov_b32 s22, 0x1200000
    s_mov_b32 s23, 0x00020000
    v_mfma_f32_16x16x32_bf16 v[68:71], a[100:103], a[168:171], v[68:71]
    s_waitcnt lgkmcnt(8)
    v_mfma_f32_16x16x32_bf16 v[84:87], a[100:103], a[176:179], v[84:87]
    ds_read_b64_tr_b16 a[168:169], v9 offset:6208
    v_mfma_f32_16x16x32_bf16 v[84:87], a[116:119], a[180:183], v[84:87]
    ds_read_b64_tr_b16 a[170:171], v9 offset:9792
    v_mfma_f32_16x16x32_bf16 v[80:83], a[112:115], a[180:183], v[80:83]
    v_and_b32 v14, 7, v0
    v_and_b32 v15, 15, v0
    v_mfma_f32_16x16x32_bf16 v[80:83], a[96:99], a[176:179], v[80:83]
    v_lshlrev_b32 v15, 4, v15
    v_mfma_f32_16x16x32_bf16 v[76:79], a[92:95], a[176:179], v[76:79]
    ds_read_b64_tr_b16 a[172:173], v9 offset:26688
    v_mfma_f32_16x16x32_bf16 v[76:79], a[108:111], a[180:183], v[76:79]
    ds_read_b64_tr_b16 a[174:175], v9 offset:30272
    v_mfma_f32_16x16x32_bf16 v[72:75], a[104:107], a[180:183], v[72:75]
    v_add_u32 v15, s69, v15
    v_bfe_u32 v20, v0, 4, 1
    v_mfma_f32_16x16x32_bf16 v[72:75], a[88:91], a[176:179], v[72:75]
    v_xor_b32 v15, v15, v20
    s_waitcnt vmcnt(8) lgkmcnt(8)
    s_barrier
    v_mfma_f32_16x16x32_bf16 a[56:59], a[152:155], a[88:91], a[56:59]
    ds_read_b64_tr_b16 a[176:177], v12 offset:6144
    v_mfma_f32_16x16x32_bf16 a[56:59], a[156:159], a[104:107], a[56:59]
    ds_read_b64_tr_b16 a[178:179], v12 offset:9728
    v_mfma_f32_16x16x32_bf16 a[60:63], a[156:159], a[108:111], a[60:63]
    v_cmp_gt_u32 vcc, 32, v0
    s_and_b32 s67, s2, 0xc7
    v_mfma_f32_16x16x32_bf16 a[60:63], a[152:155], a[92:95], a[60:63]
    v_lshlrev_b32 v14, 3, v14
    v_mfma_f32_16x16x32_bf16 a[64:67], a[152:155], a[96:99], a[64:67]
    ds_read_b64_tr_b16 a[180:181], v12 offset:26624
    v_mfma_f32_16x16x32_bf16 a[64:67], a[156:159], a[112:115], a[64:67]
    ds_read_b64_tr_b16 a[182:183], v12 offset:30208
    v_mfma_f32_16x16x32_bf16 a[68:71], a[156:159], a[116:119], a[68:71]
    v_cndmask_b32 v20, v15, v17, vcc
    v_add_u32 v14, s67, v14
    v_mfma_f32_16x16x32_bf16 a[68:71], a[152:155], a[100:103], a[68:71]
    s_mov_b32 s67, 0x70000000
    s_waitcnt lgkmcnt(8)
    v_mfma_f32_16x16x32_bf16 a[84:87], a[160:163], a[100:103], a[84:87]
    ds_read_b64_tr_b16 a[152:153], v12 offset:13312
    v_mfma_f32_16x16x32_bf16 a[84:87], a[164:167], a[116:119], a[84:87]
    ds_read_b64_tr_b16 a[154:155], v12 offset:16896
    v_mfma_f32_16x16x32_bf16 a[80:83], a[164:167], a[112:115], a[80:83]
    v_cndmask_b32 v21, v14, v17, vcc
    v_and_b32 v14, 7, v17
    v_mfma_f32_16x16x32_bf16 a[80:83], a[160:163], a[96:99], a[80:83]
    v_lshrrev_b32 v17, 3, v17
    v_mfma_f32_16x16x32_bf16 a[76:79], a[160:163], a[92:95], a[76:79]
    ds_read_b64_tr_b16 a[156:157], v12 offset:33792
    v_mfma_f32_16x16x32_bf16 a[76:79], a[164:167], a[108:111], a[76:79]
    ds_read_b64_tr_b16 a[158:159], v12 offset:37376
    v_mfma_f32_16x16x32_bf16 a[72:75], a[164:167], a[104:107], a[72:75]
    v_mul_u32_u24 v17, 128, v17
    v_lshl_add_u32 v17, v14, 4, v17
    v_mfma_f32_16x16x32_bf16 a[72:75], a[160:163], a[88:91], a[72:75]
    v_and_b32 v14, 7, v20
    s_waitcnt lgkmcnt(8)
    v_mfma_f32_16x16x32_bf16 v[120:123], a[168:171], a[88:91], v[120:123]
    ds_read_b64_tr_b16 a[160:161], v12 offset:6176
    v_mfma_f32_16x16x32_bf16 v[120:123], a[172:175], a[104:107], v[120:123]
    ds_read_b64_tr_b16 a[162:163], v12 offset:9760
    v_mfma_f32_16x16x32_bf16 v[124:127], a[172:175], a[108:111], v[124:127]
    v_lshrrev_b32 v20, 3, v20
    v_mul_u32_u24 v20, 128, v20
    v_mfma_f32_16x16x32_bf16 v[124:127], a[168:171], a[92:95], v[124:127]
    v_lshl_add_u32 v20, v14, 4, v20
    v_mfma_f32_16x16x32_bf16 v[128:131], a[168:171], a[96:99], v[128:131]
    ds_read_b64_tr_b16 a[164:165], v12 offset:26656
    v_mfma_f32_16x16x32_bf16 v[128:131], a[172:175], a[112:115], v[128:131]
    ds_read_b64_tr_b16 a[166:167], v12 offset:30240
    v_mfma_f32_16x16x32_bf16 v[132:135], a[172:175], a[116:119], v[132:135]
    v_and_b32 v14, 7, v21
    v_lshrrev_b32 v21, 3, v21
    v_mfma_f32_16x16x32_bf16 v[132:135], a[168:171], a[100:103], v[132:135]
    v_mul_u32_u24 v21, 128, v21
    v_lshl_add_u32 v21, v14, 4, v21
    s_waitcnt vmcnt(0) lgkmcnt(8)
    v_mfma_f32_16x16x32_bf16 v[100:103], a[176:179], a[132:135], v[100:103]
    ds_read_b64_tr_b16 a[168:169], v12 offset:13344
    v_mfma_f32_16x16x32_bf16 v[100:103], a[180:183], a[148:151], v[100:103]
    ds_read_b64_tr_b16 a[170:171], v12 offset:16928
    v_mfma_f32_16x16x32_bf16 v[96:99], a[180:183], a[144:147], v[96:99]
    s_mov_b32 s36, 0xbfb8aa3b
    s_mov_b32 s37, 0xbfb8aa3b
    v_mfma_f32_16x16x32_bf16 v[96:99], a[176:179], a[128:131], v[96:99]
    s_mov_b32 s38, 0x3fb8aa3b
    v_mfma_f32_16x16x32_bf16 v[92:95], a[176:179], a[124:127], v[92:95]
    ds_read_b64_tr_b16 a[172:173], v12 offset:33824
    v_mfma_f32_16x16x32_bf16 v[92:95], a[180:183], a[140:143], v[92:95]
    ds_read_b64_tr_b16 a[174:175], v12 offset:37408
    v_mfma_f32_16x16x32_bf16 v[88:91], a[180:183], a[136:139], v[88:91]
    s_mov_b32 s39, 0x3fb8aa3b
    s_mov_b32 s40, 0x358637bd
    v_mfma_f32_16x16x32_bf16 v[88:91], a[176:179], a[120:123], v[88:91]
    s_lshl_b32 s41, s49, 17
    s_waitcnt lgkmcnt(8)
    v_mfma_f32_16x16x32_bf16 v[200:203], a[152:155], a[120:123], v[200:203]
    ds_read_b64_tr_b16 a[176:177], v9 offset:13376
    v_mfma_f32_16x16x32_bf16 v[200:203], a[156:159], a[136:139], v[200:203]
    ds_read_b64_tr_b16 a[178:179], v9 offset:16960
    v_mfma_f32_16x16x32_bf16 v[204:207], a[156:159], a[140:143], v[204:207]
    s_lshr_b32 s42, s49, 1
    s_add_u32 s42, s42, 96
    v_mfma_f32_16x16x32_bf16 v[204:207], a[152:155], a[124:127], v[204:207]
    s_lshl_b32 s42, s42, 17
    s_and_b32 s64, s49, 1
    v_mfma_f32_16x16x32_bf16 v[208:211], a[152:155], a[128:131], v[208:211]
    ds_read_b64_tr_b16 a[180:181], v9 offset:33856
    v_mfma_f32_16x16x32_bf16 v[208:211], a[156:159], a[144:147], v[208:211]
    ds_read_b64_tr_b16 a[182:183], v9 offset:37440
    v_mfma_f32_16x16x32_bf16 v[212:215], a[156:159], a[148:151], v[212:215]
    s_lshl_b32 s64, s64, 9
    s_add_u32 s42, s42, s64
    v_mfma_f32_16x16x32_bf16 v[212:215], a[152:155], a[132:135], v[212:215]
    s_lshl_b32 s64, s48, 4
    s_waitcnt lgkmcnt(8)
    v_mfma_f32_16x16x32_bf16 v[116:119], a[160:163], a[132:135], v[116:119]
    ds_read_b64_tr_b16 a[152:153], v9 offset:6240
    v_mfma_f32_16x16x32_bf16 v[116:119], a[164:167], a[148:151], v[116:119]
    ds_read_b64_tr_b16 a[154:155], v9 offset:9824
    v_mfma_f32_16x16x32_bf16 v[112:115], a[164:167], a[144:147], v[112:115]
    s_add_u32 s64, s64, s69
    s_lshl_b32 s64, s64, 12
    v_mfma_f32_16x16x32_bf16 v[112:115], a[160:163], a[128:131], v[112:115]
    v_add_u32 v6, s64, v13
    s_lshl_b32 s62, s48, 12
    v_mfma_f32_16x16x32_bf16 v[108:111], a[160:163], a[124:127], v[108:111]
    ds_read_b64_tr_b16 a[156:157], v9 offset:26720
    v_mfma_f32_16x16x32_bf16 v[108:111], a[164:167], a[140:143], v[108:111]
    ds_read_b64_tr_b16 a[158:159], v9 offset:30304
    v_mfma_f32_16x16x32_bf16 v[104:107], a[164:167], a[136:139], v[104:107]
    s_cmp_eq_u32 s48, 0
    s_cbranch_scc0 M_npw
    buffer_load_dwordx2 v[18:19], v20, s[92:95], 0 offen sc1
M_npw:
    v_mfma_f32_16x16x32_bf16 v[104:107], a[160:163], a[120:123], v[104:107]
    s_waitcnt lgkmcnt(8)
    v_mfma_f32_16x16x32_bf16 v[216:219], a[168:171], a[120:123], v[216:219]
    ds_read_b64_tr_b16 a[160:161], v9 offset:13408
    v_mfma_f32_16x16x32_bf16 v[216:219], a[172:175], a[136:139], v[216:219]
    ds_read_b64_tr_b16 a[162:163], v9 offset:16992
    v_mfma_f32_16x16x32_bf16 v[220:223], a[172:175], a[140:143], v[220:223]
    v_mfma_f32_16x16x32_bf16 v[220:223], a[168:171], a[124:127], v[220:223]
    v_mfma_f32_16x16x32_bf16 v[224:227], a[168:171], a[128:131], v[224:227]
    ds_read_b64_tr_b16 a[164:165], v9 offset:33888
    v_mfma_f32_16x16x32_bf16 v[224:227], a[172:175], a[144:147], v[224:227]
    ds_read_b64_tr_b16 a[166:167], v9 offset:37472
    v_mfma_f32_16x16x32_bf16 v[228:231], a[172:175], a[148:151], v[228:231]
    v_mfma_f32_16x16x32_bf16 v[228:231], a[168:171], a[132:135], v[228:231]
    s_waitcnt lgkmcnt(8)
    v_mfma_f32_16x16x32_bf16 v[244:247], a[176:179], a[100:103], v[244:247]
    ds_read_b64_tr_b16 a[168:169], v9 offset:6272
    v_mfma_f32_16x16x32_bf16 v[244:247], a[180:183], a[116:119], v[244:247]
    ds_read_b64_tr_b16 a[170:171], v9 offset:9856
    v_mfma_f32_16x16x32_bf16 v[240:243], a[180:183], a[112:115], v[240:243]
    v_mfma_f32_16x16x32_bf16 v[240:243], a[176:179], a[96:99], v[240:243]
    v_mfma_f32_16x16x32_bf16 v[236:239], a[176:179], a[92:95], v[236:239]
    ds_read_b64_tr_b16 a[172:173], v9 offset:26752
    v_mfma_f32_16x16x32_bf16 v[236:239], a[180:183], a[108:111], v[236:239]
    ds_read_b64_tr_b16 a[174:175], v9 offset:30336
    v_mfma_f32_16x16x32_bf16 v[232:235], a[180:183], a[104:107], v[232:235]
    v_mul_f32 v2, s36, v88
    v_mul_f32 v3, s36, v89
    v_mfma_f32_16x16x32_bf16 v[232:235], a[176:179], a[88:91], v[232:235]
    v_mul_f32 v4, s36, v90
    v_mul_f32 v5, s36, v91
    s_waitcnt lgkmcnt(8)
    v_mfma_f32_16x16x32_bf16 v[136:139], a[152:155], a[88:91], v[136:139]
    ds_read_b64_tr_b16 a[176:177], v9 offset:13440
    v_mfma_f32_16x16x32_bf16 v[136:139], a[156:159], a[104:107], v[136:139]
    ds_read_b64_tr_b16 a[178:179], v9 offset:17024
    v_mfma_f32_16x16x32_bf16 v[140:143], a[156:159], a[108:111], v[140:143]
    v_exp_f32 v2, v2
    v_exp_f32 v3, v3
    v_exp_f32 v4, v4
    v_mfma_f32_16x16x32_bf16 v[140:143], a[152:155], a[92:95], v[140:143]
    v_exp_f32 v5, v5
    v_mul_f32 v88, v200, v88
    v_mfma_f32_16x16x32_bf16 v[144:147], a[152:155], a[96:99], v[144:147]
    ds_read_b64_tr_b16 a[180:181], v9 offset:33920
    v_mfma_f32_16x16x32_bf16 v[144:147], a[156:159], a[112:115], v[144:147]
    ds_read_b64_tr_b16 a[182:183], v9 offset:37504
    v_mfma_f32_16x16x32_bf16 v[148:151], a[156:159], a[116:119], v[148:151]
    v_mul_f32 v89, v201, v89
    v_mul_f32 v90, v202, v90
    v_mul_f32 v91, v203, v91
    v_mfma_f32_16x16x32_bf16 v[148:151], a[152:155], a[100:103], v[148:151]
    v_add_f32 v2, 1.0, v2
    v_add_f32 v3, 1.0, v3
    s_waitcnt lgkmcnt(8)
    v_mfma_f32_16x16x32_bf16 a[4:7], a[160:163], a[100:103], a[4:7]
    ds_read_b64_tr_b16 a[152:153], v9 offset:6304
    v_mfma_f32_16x16x32_bf16 a[4:7], a[164:167], a[116:119], a[4:7]
    ds_read_b64_tr_b16 a[154:155], v9 offset:9888
    v_mfma_f32_16x16x32_bf16 a[0:3], a[164:167], a[112:115], a[0:3]
    v_add_f32 v4, 1.0, v4
    v_add_f32 v5, 1.0, v5
    v_rcp_f32 v2, v2
    v_mfma_f32_16x16x32_bf16 a[0:3], a[160:163], a[96:99], a[0:3]
    v_rcp_f32 v3, v3
    v_rcp_f32 v4, v4
    v_mfma_f32_16x16x32_bf16 v[252:255], a[160:163], a[92:95], v[252:255]
    ds_read_b64_tr_b16 a[156:157], v9 offset:26784
    v_mfma_f32_16x16x32_bf16 v[252:255], a[164:167], a[108:111], v[252:255]
    ds_read_b64_tr_b16 a[158:159], v9 offset:30368
    v_mfma_f32_16x16x32_bf16 v[248:251], a[164:167], a[104:107], v[248:251]
    v_rcp_f32 v5, v5
    v_mul_f32 v88, v2, v88
    v_mul_f32 v89, v3, v89
    v_mfma_f32_16x16x32_bf16 v[248:251], a[160:163], a[88:91], v[248:251]
    v_mul_f32 v90, v4, v90
    v_mul_f32 v91, v5, v91
    s_waitcnt lgkmcnt(8)
    v_mfma_f32_16x16x32_bf16 v[152:155], a[168:171], a[88:91], v[152:155]
    ds_read_b64_tr_b16 a[160:161], v9 offset:13472
    v_mfma_f32_16x16x32_bf16 v[152:155], a[172:175], a[104:107], v[152:155]
    ds_read_b64_tr_b16 a[162:163], v9 offset:17056
    v_mfma_f32_16x16x32_bf16 v[156:159], a[172:175], a[108:111], v[156:159]
    v_cvt_pk_bf16_f32 v88, v88, v89
    v_cvt_pk_bf16_f32 v89, v90, v91
    v_mul_f32 v2, s36, v104
    v_mfma_f32_16x16x32_bf16 v[156:159], a[168:171], a[92:95], v[156:159]
    v_mul_f32 v3, s36, v105
    v_mul_f32 v4, s36, v106
    v_mfma_f32_16x16x32_bf16 v[160:163], a[168:171], a[96:99], v[160:163]
    ds_read_b64_tr_b16 a[164:165], v9 offset:33952
    v_mfma_f32_16x16x32_bf16 v[160:163], a[172:175], a[112:115], v[160:163]
    ds_read_b64_tr_b16 a[166:167], v9 offset:37536
    v_mfma_f32_16x16x32_bf16 v[164:167], a[172:175], a[116:119], v[164:167]
    v_mul_f32 v5, s36, v107
    v_exp_f32 v2, v2
    v_mfma_f32_16x16x32_bf16 v[164:167], a[168:171], a[100:103], v[164:167]
    v_exp_f32 v3, v3
    v_exp_f32 v4, v4
    s_waitcnt lgkmcnt(8)
    v_mfma_f32_16x16x32_bf16 a[20:23], a[176:179], a[100:103], a[20:23]
    ds_read_b64_tr_b16 a[168:169], v9 offset:6336
    v_mfma_f32_16x16x32_bf16 a[20:23], a[180:183], a[116:119], a[20:23]
    ds_read_b64_tr_b16 a[170:171], v9 offset:9920
    v_mfma_f32_16x16x32_bf16 a[16:19], a[180:183], a[112:115], a[16:19]
    v_exp_f32 v5, v5
    v_mul_f32 v104, v216, v104
    v_mul_f32 v105, v217, v105
    v_mfma_f32_16x16x32_bf16 a[16:19], a[176:179], a[96:99], a[16:19]
    v_mul_f32 v106, v218, v106
    v_mul_f32 v107, v219, v107
    v_mfma_f32_16x16x32_bf16 a[12:15], a[176:179], a[92:95], a[12:15]
    ds_read_b64_tr_b16 a[172:173], v9 offset:26816
    v_mfma_f32_16x16x32_bf16 a[12:15], a[180:183], a[108:111], a[12:15]
    ds_read_b64_tr_b16 a[174:175], v9 offset:30400
    v_mfma_f32_16x16x32_bf16 a[8:11], a[180:183], a[104:107], a[8:11]
    v_add_f32 v2, 1.0, v2
    v_add_f32 v3, 1.0, v3
    v_add_f32 v4, 1.0, v4
    v_mfma_f32_16x16x32_bf16 a[8:11], a[176:179], a[88:91], a[8:11]
    v_add_f32 v5, 1.0, v5
    v_rcp_f32 v2, v2
    s_waitcnt lgkmcnt(8)
    v_mfma_f32_16x16x32_bf16 v[168:171], a[152:155], a[88:91], v[168:171]
    ds_read_b64_tr_b16 a[176:177], v9 offset:13504
    v_mfma_f32_16x16x32_bf16 v[168:171], a[156:159], a[104:107], v[168:171]
    ds_read_b64_tr_b16 a[178:179], v9 offset:17088
    v_mfma_f32_16x16x32_bf16 v[172:175], a[156:159], a[108:111], v[172:175]
    v_rcp_f32 v3, v3
    v_rcp_f32 v4, v4
    v_rcp_f32 v5, v5
    v_mfma_f32_16x16x32_bf16 v[172:175], a[152:155], a[92:95], v[172:175]
    v_mul_f32 v104, v2, v104
    v_mul_f32 v105, v3, v105
    v_mfma_f32_16x16x32_bf16 v[176:179], a[152:155], a[96:99], v[176:179]
    ds_read_b64_tr_b16 a[180:181], v9 offset:33984
    v_mfma_f32_16x16x32_bf16 v[176:179], a[156:159], a[112:115], v[176:179]
    ds_read_b64_tr_b16 a[182:183], v9 offset:37568
    v_mfma_f32_16x16x32_bf16 v[180:183], a[156:159], a[116:119], v[180:183]
    v_mul_f32 v106, v4, v106
    v_mul_f32 v107, v5, v107
    v_cvt_pk_bf16_f32 v90, v104, v105
    v_mfma_f32_16x16x32_bf16 v[180:183], a[152:155], a[100:103], v[180:183]
    v_cvt_pk_bf16_f32 v91, v106, v107
    buffer_store_dwordx4 v[88:91], v1, s[20:23], s41 offen offset:0 sc1
    s_waitcnt lgkmcnt(8)
    v_mfma_f32_16x16x32_bf16 a[36:39], a[160:163], a[100:103], a[36:39]
    ds_read_b64_tr_b16 a[152:153], v10 offset:2048
    v_mfma_f32_16x16x32_bf16 a[36:39], a[164:167], a[116:119], a[36:39]
    ds_read_b64_tr_b16 a[154:155], v10 offset:3072
    v_mfma_f32_16x16x32_bf16 a[32:35], a[164:167], a[112:115], a[32:35]
    v_mul_f32 v2, s36, v92
    v_mul_f32 v3, s36, v93
    v_mul_f32 v4, s36, v94
    v_mfma_f32_16x16x32_bf16 a[32:35], a[160:163], a[96:99], a[32:35]
    v_mul_f32 v5, s36, v95
    v_exp_f32 v2, v2
    v_mfma_f32_16x16x32_bf16 a[28:31], a[160:163], a[92:95], a[28:31]
    ds_read_b64_tr_b16 a[156:157], v10 offset:22528
    v_mfma_f32_16x16x32_bf16 a[28:31], a[164:167], a[108:111], a[28:31]
    ds_read_b64_tr_b16 a[158:159], v10 offset:23552
    v_mfma_f32_16x16x32_bf16 a[24:27], a[164:167], a[104:107], a[24:27]
    v_exp_f32 v3, v3
    v_exp_f32 v4, v4
    v_mfma_f32_16x16x32_bf16 a[24:27], a[160:163], a[88:91], a[24:27]
    v_exp_f32 v5, v5
    v_mul_f32 v92, v204, v92
    s_waitcnt lgkmcnt(8)
    v_mfma_f32_16x16x32_bf16 v[184:187], a[168:171], a[88:91], v[184:187]
    ds_read_b64_tr_b16 a[160:161], v11 offset:2048
    v_mfma_f32_16x16x32_bf16 v[184:187], a[172:175], a[104:107], v[184:187]
    ds_read_b64_tr_b16 a[162:163], v11 offset:3072
    v_mfma_f32_16x16x32_bf16 v[188:191], a[172:175], a[108:111], v[188:191]
    v_mul_f32 v93, v205, v93
    v_mul_f32 v94, v206, v94
    v_mul_f32 v95, v207, v95
    v_mfma_f32_16x16x32_bf16 v[188:191], a[168:171], a[92:95], v[188:191]
    v_add_f32 v2, 1.0, v2
    v_add_f32 v3, 1.0, v3
    v_mfma_f32_16x16x32_bf16 v[192:195], a[168:171], a[96:99], v[192:195]
    ds_read_b64_tr_b16 a[164:165], v11 offset:22528
    v_mfma_f32_16x16x32_bf16 v[192:195], a[172:175], a[112:115], v[192:195]
    ds_read_b64_tr_b16 a[166:167], v11 offset:23552
    v_mfma_f32_16x16x32_bf16 v[196:199], a[172:175], a[116:119], v[196:199]
    v_add_f32 v4, 1.0, v4
    v_add_f32 v5, 1.0, v5
    v_rcp_f32 v2, v2
    v_mfma_f32_16x16x32_bf16 v[196:199], a[168:171], a[100:103], v[196:199]
    v_rcp_f32 v3, v3
    v_rcp_f32 v4, v4
    s_waitcnt lgkmcnt(8)
    v_mfma_f32_16x16x32_bf16 a[52:55], a[176:179], a[100:103], a[52:55]
    ds_read_b64_tr_b16 a[168:169], v10 offset:4096
    v_mfma_f32_16x16x32_bf16 a[52:55], a[180:183], a[116:119], a[52:55]
    ds_read_b64_tr_b16 a[170:171], v10 offset:5120
    v_mfma_f32_16x16x32_bf16 a[48:51], a[180:183], a[112:115], a[48:51]
    v_rcp_f32 v5, v5
    v_mul_f32 v92, v2, v92
    v_mul_f32 v93, v3, v93
    v_mfma_f32_16x16x32_bf16 a[48:51], a[176:179], a[96:99], a[48:51]
    v_mul_f32 v94, v4, v94
    v_mul_f32 v95, v5, v95
    v_mfma_f32_16x16x32_bf16 a[44:47], a[176:179], a[92:95], a[44:47]
    ds_read_b64_tr_b16 a[172:173], v10 offset:24576
    v_mfma_f32_16x16x32_bf16 a[44:47], a[180:183], a[108:111], a[44:47]
    ds_read_b64_tr_b16 a[174:175], v10 offset:25600
    v_mfma_f32_16x16x32_bf16 a[40:43], a[180:183], a[104:107], a[40:43]
    v_cvt_pk_bf16_f32 v92, v92, v93
    v_cvt_pk_bf16_f32 v93, v94, v95
    v_mul_f32 v2, s36, v108
    v_mfma_f32_16x16x32_bf16 a[40:43], a[176:179], a[88:91], a[40:43]
    v_mul_f32 v3, s36, v109
    v_mul_f32 v4, s36, v110
    s_waitcnt lgkmcnt(8)
    v_mfma_f32_16x16x32_bf16 v[24:27], a[120:123], a[152:155], v[24:27]
    ds_read_b64_tr_b16 a[176:177], v11 offset:4096
    v_mfma_f32_16x16x32_bf16 v[24:27], a[136:139], a[156:159], v[24:27]
    ds_read_b64_tr_b16 a[178:179], v11 offset:5120
    v_mfma_f32_16x16x32_bf16 v[28:31], a[140:143], a[156:159], v[28:31]
    v_mul_f32 v5, s36, v111
    v_exp_f32 v2, v2
    v_exp_f32 v3, v3
    v_mfma_f32_16x16x32_bf16 v[28:31], a[124:127], a[152:155], v[28:31]
    v_exp_f32 v4, v4
    v_exp_f32 v5, v5
    v_mfma_f32_16x16x32_bf16 v[32:35], a[128:131], a[152:155], v[32:35]
    ds_read_b64_tr_b16 a[180:181], v11 offset:24576
    v_mfma_f32_16x16x32_bf16 v[32:35], a[144:147], a[156:159], v[32:35]
    ds_read_b64_tr_b16 a[182:183], v11 offset:25600
    v_mfma_f32_16x16x32_bf16 v[36:39], a[148:151], a[156:159], v[36:39]
    v_mul_f32 v108, v220, v108
    v_mul_f32 v109, v221, v109
    v_mfma_f32_16x16x32_bf16 v[36:39], a[132:135], a[152:155], v[36:39]
    v_mul_f32 v110, v222, v110
    v_mul_f32 v111, v223, v111
    s_waitcnt lgkmcnt(8)
    v_mfma_f32_16x16x32_bf16 v[52:55], a[132:135], a[160:163], v[52:55]
    ds_read_b64_tr_b16 a[152:153], v10 offset:0
    v_mfma_f32_16x16x32_bf16 v[52:55], a[148:151], a[164:167], v[52:55]
    ds_read_b64_tr_b16 a[154:155], v10 offset:1024
    v_mfma_f32_16x16x32_bf16 v[48:51], a[144:147], a[164:167], v[48:51]
    v_add_f32 v2, 1.0, v2
    v_add_f32 v3, 1.0, v3
    v_add_f32 v4, 1.0, v4
    v_mfma_f32_16x16x32_bf16 v[48:51], a[128:131], a[160:163], v[48:51]
    v_add_f32 v5, 1.0, v5
    v_rcp_f32 v2, v2
    v_mfma_f32_16x16x32_bf16 v[44:47], a[124:127], a[160:163], v[44:47]
    ds_read_b64_tr_b16 a[156:157], v10 offset:20480
    v_mfma_f32_16x16x32_bf16 v[44:47], a[140:143], a[164:167], v[44:47]
    ds_read_b64_tr_b16 a[158:159], v10 offset:21504
    v_mfma_f32_16x16x32_bf16 v[40:43], a[136:139], a[164:167], v[40:43]
    v_rcp_f32 v3, v3
    v_rcp_f32 v4, v4
    v_rcp_f32 v5, v5
    v_mfma_f32_16x16x32_bf16 v[40:43], a[120:123], a[160:163], v[40:43]
    v_mul_f32 v108, v2, v108
    v_mul_f32 v109, v3, v109
    s_waitcnt lgkmcnt(8)
    v_mfma_f32_16x16x32_bf16 v[56:59], a[120:123], a[168:171], v[56:59]
    ds_read_b64_tr_b16 a[160:161], v11 offset:0
    v_mfma_f32_16x16x32_bf16 v[56:59], a[136:139], a[172:175], v[56:59]
    ds_read_b64_tr_b16 a[162:163], v11 offset:1024
    v_mfma_f32_16x16x32_bf16 v[60:63], a[140:143], a[172:175], v[60:63]
    v_mul_f32 v110, v4, v110
    v_mul_f32 v111, v5, v111
    v_cvt_pk_bf16_f32 v94, v108, v109
    v_mfma_f32_16x16x32_bf16 v[60:63], a[124:127], a[168:171], v[60:63]
    v_cvt_pk_bf16_f32 v95, v110, v111
    buffer_store_dwordx4 v[92:95], v1, s[20:23], s41 offen offset:1024 sc1
    v_mfma_f32_16x16x32_bf16 v[64:67], a[128:131], a[168:171], v[64:67]
    ds_read_b64_tr_b16 a[164:165], v11 offset:20480
    v_mfma_f32_16x16x32_bf16 v[64:67], a[144:147], a[172:175], v[64:67]
    ds_read_b64_tr_b16 a[166:167], v11 offset:21504
    v_mfma_f32_16x16x32_bf16 v[68:71], a[148:151], a[172:175], v[68:71]
    v_mul_f32 v2, s36, v96
    v_mul_f32 v3, s36, v97
    v_mul_f32 v4, s36, v98
    v_mfma_f32_16x16x32_bf16 v[68:71], a[132:135], a[168:171], v[68:71]
    v_mul_f32 v5, s36, v99
    v_exp_f32 v2, v2
    s_waitcnt lgkmcnt(8)
    v_mfma_f32_16x16x32_bf16 v[84:87], a[132:135], a[176:179], v[84:87]
    ds_read_b64_tr_b16 a[168:169], v12 offset:6208
    v_mfma_f32_16x16x32_bf16 v[84:87], a[148:151], a[180:183], v[84:87]
    ds_read_b64_tr_b16 a[170:171], v12 offset:9792
    v_mfma_f32_16x16x32_bf16 v[80:83], a[144:147], a[180:183], v[80:83]
    v_exp_f32 v3, v3
    v_exp_f32 v4, v4
    v_exp_f32 v5, v5
    v_mfma_f32_16x16x32_bf16 v[80:83], a[128:131], a[176:179], v[80:83]
    v_mul_f32 v96, v208, v96
    v_mul_f32 v97, v209, v97
    v_mfma_f32_16x16x32_bf16 v[76:79], a[124:127], a[176:179], v[76:79]
    ds_read_b64_tr_b16 a[172:173], v12 offset:26688
    v_mfma_f32_16x16x32_bf16 v[76:79], a[140:143], a[180:183], v[76:79]
    ds_read_b64_tr_b16 a[174:175], v12 offset:30272
    v_mfma_f32_16x16x32_bf16 v[72:75], a[136:139], a[180:183], v[72:75]
    v_mul_f32 v98, v210, v98
    v_mul_f32 v99, v211, v99
    v_add_f32 v2, 1.0, v2
    v_mfma_f32_16x16x32_bf16 v[72:75], a[120:123], a[176:179], v[72:75]
    v_add_f32 v3, 1.0, v3
    v_add_f32 v4, 1.0, v4
    s_waitcnt lgkmcnt(8)
    v_mfma_f32_16x16x32_bf16 a[56:59], a[152:155], a[120:123], a[56:59]
    ds_read_b64_tr_b16 a[176:177], v12 offset:13376
    v_mfma_f32_16x16x32_bf16 a[56:59], a[156:159], a[136:139], a[56:59]
    ds_read_b64_tr_b16 a[178:179], v12 offset:16960
    v_mfma_f32_16x16x32_bf16 a[60:63], a[156:159], a[140:143], a[60:63]
    v_add_f32 v5, 1.0, v5
    v_rcp_f32 v2, v2
    v_mfma_f32_16x16x32_bf16 a[60:63], a[152:155], a[124:127], a[60:63]
    v_rcp_f32 v3, v3
    v_rcp_f32 v4, v4
    v_mfma_f32_16x16x32_bf16 a[64:67], a[152:155], a[128:131], a[64:67]
    ds_read_b64_tr_b16 a[180:181], v12 offset:33856
    v_mfma_f32_16x16x32_bf16 a[64:67], a[156:159], a[144:147], a[64:67]
    ds_read_b64_tr_b16 a[182:183], v12 offset:37440
    v_mfma_f32_16x16x32_bf16 a[68:71], a[156:159], a[148:151], a[68:71]
    v_rcp_f32 v5, v5
    v_mul_f32 v96, v2, v96
    v_mul_f32 v97, v3, v97
    v_mfma_f32_16x16x32_bf16 a[68:71], a[152:155], a[132:135], a[68:71]
    v_mul_f32 v98, v4, v98
    v_mul_f32 v99, v5, v99
    s_waitcnt lgkmcnt(8)
    v_mfma_f32_16x16x32_bf16 a[84:87], a[160:163], a[132:135], a[84:87]
    ds_read_b64_tr_b16 a[152:153], v12 offset:6240
    v_mfma_f32_16x16x32_bf16 a[84:87], a[164:167], a[148:151], a[84:87]
    ds_read_b64_tr_b16 a[154:155], v12 offset:9824
    v_mfma_f32_16x16x32_bf16 a[80:83], a[164:167], a[144:147], a[80:83]
    v_cvt_pk_bf16_f32 v96, v96, v97
    v_cvt_pk_bf16_f32 v97, v98, v99
    v_mul_f32 v2, s36, v112
    v_mfma_f32_16x16x32_bf16 a[80:83], a[160:163], a[128:131], a[80:83]
    v_mul_f32 v3, s36, v113
    v_mul_f32 v4, s36, v114
    v_mfma_f32_16x16x32_bf16 a[76:79], a[160:163], a[124:127], a[76:79]
    ds_read_b64_tr_b16 a[156:157], v12 offset:26720
    v_mfma_f32_16x16x32_bf16 a[76:79], a[164:167], a[140:143], a[76:79]
    ds_read_b64_tr_b16 a[158:159], v12 offset:30304
    v_mfma_f32_16x16x32_bf16 a[72:75], a[164:167], a[136:139], a[72:75]
    v_mul_f32 v5, s36, v115
    v_exp_f32 v2, v2
    v_exp_f32 v3, v3
    v_mfma_f32_16x16x32_bf16 a[72:75], a[160:163], a[120:123], a[72:75]
    v_exp_f32 v4, v4
    v_exp_f32 v5, v5
    s_waitcnt lgkmcnt(8)
    v_mfma_f32_16x16x32_bf16 v[120:123], a[168:171], a[120:123], v[120:123]
    ds_read_b64_tr_b16 a[160:161], v12 offset:13408
    v_mfma_f32_16x16x32_bf16 v[120:123], a[172:175], a[136:139], v[120:123]
    ds_read_b64_tr_b16 a[162:163], v12 offset:16992
    v_mfma_f32_16x16x32_bf16 v[124:127], a[172:175], a[140:143], v[124:127]
    v_mul_f32 v112, v224, v112
    v_mul_f32 v113, v225, v113
    v_mul_f32 v114, v226, v114
    v_mfma_f32_16x16x32_bf16 v[124:127], a[168:171], a[124:127], v[124:127]
    v_mul_f32 v115, v227, v115
    v_add_f32 v2, 1.0, v2
    v_mfma_f32_16x16x32_bf16 v[128:131], a[168:171], a[128:131], v[128:131]
    ds_read_b64_tr_b16 a[164:165], v12 offset:33888
    v_mfma_f32_16x16x32_bf16 v[128:131], a[172:175], a[144:147], v[128:131]
    ds_read_b64_tr_b16 a[166:167], v12 offset:37472
    v_mfma_f32_16x16x32_bf16 v[132:135], a[172:175], a[148:151], v[132:135]
    v_add_f32 v3, 1.0, v3
    v_add_f32 v4, 1.0, v4
    v_add_f32 v5, 1.0, v5
    v_mfma_f32_16x16x32_bf16 v[132:135], a[168:171], a[132:135], v[132:135]
    v_rcp_f32 v2, v2
    v_rcp_f32 v3, v3
    s_waitcnt lgkmcnt(8)
    v_mfma_f32_16x16x32_bf16 v[244:247], a[176:179], a[132:135], v[244:247]
    ds_read_b64_tr_b16 a[168:169], v12 offset:6272
    v_mfma_f32_16x16x32_bf16 v[244:247], a[180:183], a[148:151], v[244:247]
    ds_read_b64_tr_b16 a[170:171], v12 offset:9856
    v_mfma_f32_16x16x32_bf16 v[240:243], a[180:183], a[144:147], v[240:243]
    v_rcp_f32 v4, v4
    v_rcp_f32 v5, v5
    v_mfma_f32_16x16x32_bf16 v[240:243], a[176:179], a[128:131], v[240:243]
    v_mul_f32 v112, v2, v112
    v_mul_f32 v113, v3, v113
    v_mfma_f32_16x16x32_bf16 v[236:239], a[176:179], a[124:127], v[236:239]
    ds_read_b64_tr_b16 a[172:173], v12 offset:26752
    v_mfma_f32_16x16x32_bf16 v[236:239], a[180:183], a[140:143], v[236:239]
    ds_read_b64_tr_b16 a[174:175], v12 offset:30336
    v_mfma_f32_16x16x32_bf16 v[232:235], a[180:183], a[136:139], v[232:235]
    v_mul_f32 v114, v4, v114
    v_mul_f32 v115, v5, v115
    v_cvt_pk_bf16_f32 v98, v112, v113
    v_mfma_f32_16x16x32_bf16 v[232:235], a[176:179], a[120:123], v[232:235]
    v_cvt_pk_bf16_f32 v99, v114, v115
    buffer_store_dwordx4 v[96:99], v1, s[20:23], s41 offen offset:2048 sc1
    s_waitcnt lgkmcnt(8)
    v_mfma_f32_16x16x32_bf16 v[136:139], a[152:155], a[120:123], v[136:139]
    ds_read_b64_tr_b16 a[176:177], v12 offset:13440
    v_mfma_f32_16x16x32_bf16 v[136:139], a[156:159], a[136:139], v[136:139]
    ds_read_b64_tr_b16 a[178:179], v12 offset:17024
    v_mfma_f32_16x16x32_bf16 v[140:143], a[156:159], a[140:143], v[140:143]
    v_mul_f32 v2, s36, v100
    v_mul_f32 v3, s36, v101
    v_mul_f32 v4, s36, v102
    v_mfma_f32_16x16x32_bf16 v[140:143], a[152:155], a[124:127], v[140:143]
    v_mul_f32 v5, s36, v103
    v_exp_f32 v2, v2
    v_mfma_f32_16x16x32_bf16 v[144:147], a[152:155], a[128:131], v[144:147]
    ds_read_b64_tr_b16 a[180:181], v12 offset:33920
    v_mfma_f32_16x16x32_bf16 v[144:147], a[156:159], a[144:147], v[144:147]
    ds_read_b64_tr_b16 a[182:183], v12 offset:37504
    v_mfma_f32_16x16x32_bf16 v[148:151], a[156:159], a[148:151], v[148:151]
    v_exp_f32 v3, v3
    v_exp_f32 v4, v4
    v_exp_f32 v5, v5
    v_mfma_f32_16x16x32_bf16 v[148:151], a[152:155], a[132:135], v[148:151]
    v_mul_f32 v100, v212, v100
    v_mul_f32 v101, v213, v101
    s_waitcnt lgkmcnt(8)
    v_mfma_f32_16x16x32_bf16 a[4:7], a[160:163], a[132:135], a[4:7]
    ds_read_b64_tr_b16 a[152:153], v12 offset:6304
    v_mfma_f32_16x16x32_bf16 a[4:7], a[164:167], a[148:151], a[4:7]
    ds_read_b64_tr_b16 a[154:155], v12 offset:9888
    v_mfma_f32_16x16x32_bf16 a[0:3], a[164:167], a[144:147], a[0:3]
    v_mul_f32 v102, v214, v102
    v_mul_f32 v103, v215, v103
    v_add_f32 v2, 1.0, v2
    v_mfma_f32_16x16x32_bf16 a[0:3], a[160:163], a[128:131], a[0:3]
    v_add_f32 v3, 1.0, v3
    v_add_f32 v4, 1.0, v4
    v_mfma_f32_16x16x32_bf16 v[252:255], a[160:163], a[124:127], v[252:255]
    ds_read_b64_tr_b16 a[156:157], v12 offset:26784
    v_mfma_f32_16x16x32_bf16 v[252:255], a[164:167], a[140:143], v[252:255]
    ds_read_b64_tr_b16 a[158:159], v12 offset:30368
    v_mfma_f32_16x16x32_bf16 v[248:251], a[164:167], a[136:139], v[248:251]
    v_add_f32 v5, 1.0, v5
    v_rcp_f32 v2, v2
    v_rcp_f32 v3, v3
    v_mfma_f32_16x16x32_bf16 v[248:251], a[160:163], a[120:123], v[248:251]
    v_rcp_f32 v4, v4
    v_rcp_f32 v5, v5
    s_waitcnt lgkmcnt(8)
    v_mfma_f32_16x16x32_bf16 v[152:155], a[168:171], a[120:123], v[152:155]
    ds_read_b64_tr_b16 a[160:161], v12 offset:13472
    v_mfma_f32_16x16x32_bf16 v[152:155], a[172:175], a[136:139], v[152:155]
    ds_read_b64_tr_b16 a[162:163], v12 offset:17056
    v_mfma_f32_16x16x32_bf16 v[156:159], a[172:175], a[140:143], v[156:159]
    v_mul_f32 v100, v2, v100
    v_mul_f32 v101, v3, v101
    v_mfma_f32_16x16x32_bf16 v[156:159], a[168:171], a[124:127], v[156:159]
    v_mul_f32 v102, v4, v102
    v_mul_f32 v103, v5, v103
    v_mfma_f32_16x16x32_bf16 v[160:163], a[168:171], a[128:131], v[160:163]
    ds_read_b64_tr_b16 a[164:165], v12 offset:33952
    v_mfma_f32_16x16x32_bf16 v[160:163], a[172:175], a[144:147], v[160:163]
    ds_read_b64_tr_b16 a[166:167], v12 offset:37536
    v_mfma_f32_16x16x32_bf16 v[164:167], a[172:175], a[148:151], v[164:167]
    v_cvt_pk_bf16_f32 v100, v100, v101
    v_cvt_pk_bf16_f32 v101, v102, v103
    v_mul_f32 v2, s36, v116
    v_mfma_f32_16x16x32_bf16 v[164:167], a[168:171], a[132:135], v[164:167]
    v_mul_f32 v3, s36, v117
    v_mul_f32 v4, s36, v118
    s_waitcnt lgkmcnt(8)
    v_mfma_f32_16x16x32_bf16 a[20:23], a[176:179], a[132:135], a[20:23]
    ds_read_b64_tr_b16 a[168:169], v12 offset:6336
    v_mfma_f32_16x16x32_bf16 a[20:23], a[180:183], a[148:151], a[20:23]
    ds_read_b64_tr_b16 a[170:171], v12 offset:9920
    v_mfma_f32_16x16x32_bf16 a[16:19], a[180:183], a[144:147], a[16:19]
    v_mul_f32 v5, s36, v119
    v_exp_f32 v2, v2
    v_exp_f32 v3, v3
    v_mfma_f32_16x16x32_bf16 a[16:19], a[176:179], a[128:131], a[16:19]
    v_exp_f32 v4, v4
    v_exp_f32 v5, v5
    v_mfma_f32_16x16x32_bf16 a[12:15], a[176:179], a[124:127], a[12:15]
    ds_read_b64_tr_b16 a[172:173], v12 offset:26816
    v_mfma_f32_16x16x32_bf16 a[12:15], a[180:183], a[140:143], a[12:15]
    ds_read_b64_tr_b16 a[174:175], v12 offset:30400
    v_mfma_f32_16x16x32_bf16 a[8:11], a[180:183], a[136:139], a[8:11]
    v_mul_f32 v116, v228, v116
    v_mul_f32 v117, v229, v117
    v_mul_f32 v118, v230, v118
    v_mfma_f32_16x16x32_bf16 a[8:11], a[176:179], a[120:123], a[8:11]
    v_mul_f32 v119, v231, v119
    v_add_f32 v2, 1.0, v2
    s_waitcnt lgkmcnt(8)
    v_mfma_f32_16x16x32_bf16 v[168:171], a[152:155], a[120:123], v[168:171]
    ds_read_b64_tr_b16 a[176:177], v12 offset:13504
    v_mfma_f32_16x16x32_bf16 v[168:171], a[156:159], a[136:139], v[168:171]
    ds_read_b64_tr_b16 a[178:179], v12 offset:17088
    v_mfma_f32_16x16x32_bf16 v[172:175], a[156:159], a[140:143], v[172:175]
    v_add_f32 v3, 1.0, v3
    v_add_f32 v4, 1.0, v4
    v_add_f32 v5, 1.0, v5
    v_mfma_f32_16x16x32_bf16 v[172:175], a[152:155], a[124:127], v[172:175]
    v_rcp_f32 v2, v2
    v_rcp_f32 v3, v3
    v_mfma_f32_16x16x32_bf16 v[176:179], a[152:155], a[128:131], v[176:179]
    ds_read_b64_tr_b16 a[180:181], v12 offset:33984
    v_mfma_f32_16x16x32_bf16 v[176:179], a[156:159], a[144:147], v[176:179]
    ds_read_b64_tr_b16 a[182:183], v12 offset:37568
    v_mfma_f32_16x16x32_bf16 v[180:183], a[156:159], a[148:151], v[180:183]
    v_rcp_f32 v4, v4
    v_rcp_f32 v5, v5
    v_mul_f32 v116, v2, v116
    v_mfma_f32_16x16x32_bf16 v[180:183], a[152:155], a[132:135], v[180:183]
    v_mul_f32 v117, v3, v117
    v_mul_f32 v118, v4, v118
    s_waitcnt lgkmcnt(8)
    v_mfma_f32_16x16x32_bf16 a[36:39], a[160:163], a[132:135], a[36:39]
    v_mfma_f32_16x16x32_bf16 a[36:39], a[164:167], a[148:151], a[36:39]
    v_mfma_f32_16x16x32_bf16 a[32:35], a[164:167], a[144:147], a[32:35]
    v_mul_f32 v119, v5, v119
    v_cvt_pk_bf16_f32 v102, v116, v117
    v_cvt_pk_bf16_f32 v103, v118, v119
    v_mfma_f32_16x16x32_bf16 a[32:35], a[160:163], a[128:131], a[32:35]
    buffer_store_dwordx4 v[100:103], v1, s[20:23], s41 offen offset:3072 sc1
    s_add_u32 s41, s41, 4194304
    v_mfma_f32_16x16x32_bf16 a[28:31], a[160:163], a[124:127], a[28:31]
    v_mfma_f32_16x16x32_bf16 a[28:31], a[164:167], a[140:143], a[28:31]
    v_mfma_f32_16x16x32_bf16 a[24:27], a[164:167], a[136:139], a[24:27]
    v_mfma_f32_16x16x32_bf16 a[24:27], a[160:163], a[120:123], a[24:27]
    s_waitcnt lgkmcnt(4)
    v_mfma_f32_16x16x32_bf16 v[184:187], a[168:171], a[120:123], v[184:187]
    v_mfma_f32_16x16x32_bf16 v[184:187], a[172:175], a[136:139], v[184:187]
    v_mfma_f32_16x16x32_bf16 v[188:191], a[172:175], a[140:143], v[188:191]
    v_mfma_f32_16x16x32_bf16 v[188:191], a[168:171], a[124:127], v[188:191]
    v_mfma_f32_16x16x32_bf16 v[192:195], a[168:171], a[128:131], v[192:195]
    v_mfma_f32_16x16x32_bf16 v[192:195], a[172:175], a[144:147], v[192:195]
    v_mfma_f32_16x16x32_bf16 v[196:199], a[172:175], a[148:151], v[196:199]
    v_mfma_f32_16x16x32_bf16 v[196:199], a[168:171], a[132:135], v[196:199]
    s_waitcnt lgkmcnt(0)
    v_mfma_f32_16x16x32_bf16 a[52:55], a[176:179], a[132:135], a[52:55]
    v_mfma_f32_16x16x32_bf16 a[52:55], a[180:183], a[148:151], a[52:55]
    v_mfma_f32_16x16x32_bf16 a[48:51], a[180:183], a[144:147], a[48:51]
    v_mfma_f32_16x16x32_bf16 a[48:51], a[176:179], a[128:131], a[48:51]
    v_mfma_f32_16x16x32_bf16 a[44:47], a[176:179], a[124:127], a[44:47]
    v_mfma_f32_16x16x32_bf16 a[44:47], a[180:183], a[140:143], a[44:47]
    v_mfma_f32_16x16x32_bf16 a[40:43], a[180:183], a[136:139], a[40:43]
    v_mfma_f32_16x16x32_bf16 a[40:43], a[176:179], a[120:123], a[40:43]
    s_load_dwordx2 s[80:81], s[0:1], 56
    s_lshl_b32 s64, s68, 13
    s_lshl_b32 s67, s48, 11
    s_add_u32 s64, s64, s67
    v_add_u32 v2, s64, v13
    v_add_u32 v3, 0x20000, v2
    v_add_u32 v4, 0x40000, v2
    v_add_u32 v5, 0x60000, v2
    s_and_b32 s64, s69, 1
    s_lshl_b32 s67, s64, 18
    v_add_u32 v7, s67, v2
    v_add_u32 v8, s67, v3
    s_lshl_b32 s64, s64, 1
    s_lshr_b32 s67, s48, 1
    s_add_u32 s64, s64, s67
    s_lshl_b32 s64, s64, 4
    s_and_b32 s67, s48, 1
    s_xor_b32 s67, s67, s69
    s_add_u32 s64, s64, s67
    s_lshl_b32 s64, s64, 12
    v_add_u32 v9, s64, v13
    s_lshr_b32 s64, s2, 3
    s_lshr_b32 s67, s2, 6
    s_add_u32 s64, s64, s67
    s_and_b32 s64, s64, 3
    s_lshl_b32 s64, s64, 3
    s_or_b32 s47, s64, 0x80000
    s_add_u32 s24, s14, 0x1600000
    s_addc_u32 s25, s15, 0
    s_mov_b32 s26, 0x180000
    s_mov_b32 s27, 0x00020000
    s_cmp_eq_u32 s48, 0
    s_cbranch_scc0 M_wtc
    s_waitcnt vmcnt(4)
    s_mov_b32 s91, 0
M_pc4:
    v_xor_b32 v14, s12, v18
    v_bfe_u32 v15, v19, 1, 1
    v_xor_b32 v15, 1, v15
    v_or_b32 v14, v14, v15
    v_cmp_ne_u32 vcc, 0, v14
    s_nop 3
    s_and_b32 s13, vcc_hi, 0xffffffff
    s_cmp_eq_u32 s13, 0
    s_cbranch_scc1 M_pc4_ok
    s_add_u32 s91, s91, 1
    s_cmp_ge_u32 s91, 0x40000
    s_cbranch_scc1 M_pc4_ok
    s_sleep 8
    buffer_load_dwordx2 v[18:19], v20, s[92:95], 0 offen sc1
    s_waitcnt vmcnt(0)
    s_branch M_pc4
M_pc4_ok:
M_wtc:
    s_barrier
    s_mov_b32 s44, 0x0
    s_add_u32 m0, s62, 0x0
    s_nop 0
    buffer_load_dwordx4 v9, s[72:75], s44 offen offset:0 sc1 lds
    v_pk_mul_f32 v[200:201], v[120:121], s[36:37]
    v_pk_mul_f32 v[202:203], v[122:123], s[36:37]
    v_exp_f32 v200, v200
    v_exp_f32 v201, v201
    v_exp_f32 v202, v202
    v_exp_f32 v203, v203
    buffer_load_dwordx4 v9, s[72:75], s44 offen offset:1024 sc1 lds
    v_pk_mul_f32 v[120:121], v[120:121], v[232:233]
    v_pk_mul_f32 v[122:123], v[122:123], v[234:235]
    v_pk_add_f32 v[200:201], v[200:201], 1.0 op_sel_hi:[1,0]
    v_pk_add_f32 v[202:203], v[202:203], 1.0 op_sel_hi:[1,0]
    v_rcp_f32 v200, v200
    v_rcp_f32 v201, v201
    v_rcp_f32 v202, v202
    buffer_load_dwordx4 v9, s[72:75], s44 offen offset:2048 sc1 lds
    v_rcp_f32 v203, v203
    v_pk_mul_f32 v[120:121], v[120:121], v[200:201]
    v_pk_mul_f32 v[122:123], v[122:123], v[202:203]
    v_cvt_pk_bf16_f32 v120, v120, v121
    v_cvt_pk_bf16_f32 v121, v122, v123
    v_pk_mul_f32 v[200:201], v[136:137], s[36:37]
    s_waitcnt vmcnt(3)
    s_barrier
    s_cmp_eq_u32 s48, 0
    s_cbranch_scc0 M_fs5
    v_mov_b32 v14, s12
    v_mov_b32 v15, 7
    s_mov_b64 exec, 1
    buffer_store_dwordx2 v[14:15], off, s[92:95], s90 sc1
    s_mov_b64 exec, -1
M_fs5:
    v_pk_mul_f32 v[202:203], v[138:139], s[36:37]
    v_exp_f32 v200, v200
    v_exp_f32 v201, v201
    v_exp_f32 v202, v202
    v_exp_f32 v203, v203
    v_pk_mul_f32 v[136:137], v[136:137], v[248:249]
    v_pk_mul_f32 v[138:139], v[138:139], v[250:251]
    buffer_load_dwordx4 v9, s[72:75], s44 offen offset:3072 sc1 lds
    v_pk_add_f32 v[200:201], v[200:201], 1.0 op_sel_hi:[1,0]
    v_pk_add_f32 v[202:203], v[202:203], 1.0 op_sel_hi:[1,0]
    v_rcp_f32 v200, v200
    v_rcp_f32 v201, v201
    v_rcp_f32 v202, v202
    v_rcp_f32 v203, v203
    s_mov_b32 s44, 0x40000
    s_add_u32 m0, s62, 0x4000
    s_nop 0
    buffer_load_dwordx4 v9, s[72:75], s44 offen offset:0 sc1 lds
    v_pk_mul_f32 v[136:137], v[136:137], v[200:201]
    v_pk_mul_f32 v[138:139], v[138:139], v[202:203]
    v_cvt_pk_bf16_f32 v122, v136, v137
    v_cvt_pk_bf16_f32 v123, v138, v139
    buffer_store_dwordx4 v[120:123], v1, s[20:23], s41 offen offset:0 sc1
    v_pk_mul_f32 v[200:201], v[124:125], s[36:37]
    v_pk_mul_f32 v[202:203], v[126:127], s[36:37]
    buffer_load_dwordx4 v9, s[72:75], s44 offen offset:1024 sc1 lds
    v_exp_f32 v200, v200
    v_exp_f32 v201, v201
    v_exp_f32 v202, v202
    v_exp_f32 v203, v203
    v_pk_mul_f32 v[124:125], v[124:125], v[236:237]
    v_pk_mul_f32 v[126:127], v[126:127], v[238:239]
    buffer_load_dwordx4 v9, s[72:75], s44 offen offset:2048 sc1 lds
    v_pk_add_f32 v[200:201], v[200:201], 1.0 op_sel_hi:[1,0]
    v_pk_add_f32 v[202:203], v[202:203], 1.0 op_sel_hi:[1,0]
    v_rcp_f32 v200, v200
    v_rcp_f32 v201, v201
    v_rcp_f32 v202, v202
    v_rcp_f32 v203, v203
    v_pk_mul_f32 v[124:125], v[124:125], v[200:201]
    buffer_load_dwordx4 v9, s[72:75], s44 offen offset:3072 sc1 lds
    v_pk_mul_f32 v[126:127], v[126:127], v[202:203]
    v_cvt_pk_bf16_f32 v124, v124, v125
    v_cvt_pk_bf16_f32 v125, v126, v127
    v_pk_mul_f32 v[200:201], v[140:141], s[36:37]
    v_pk_mul_f32 v[202:203], v[142:143], s[36:37]
    v_exp_f32 v200, v200
    s_mov_b32 s44, 0x80000
    s_add_u32 m0, s62, 0x8000
    s_nop 0
    buffer_load_dwordx4 v9, s[72:75], s44 offen offset:0 sc1 lds
    v_exp_f32 v201, v201
    v_exp_f32 v202, v202
    v_exp_f32 v203, v203
    v_pk_mul_f32 v[140:141], v[140:141], v[252:253]
    v_pk_mul_f32 v[142:143], v[142:143], v[254:255]
    v_pk_add_f32 v[200:201], v[200:201], 1.0 op_sel_hi:[1,0]
    v_pk_add_f32 v[202:203], v[202:203], 1.0 op_sel_hi:[1,0]
    buffer_load_dwordx4 v9, s[72:75], s44 offen offset:1024 sc1 lds
    v_rcp_f32 v200, v200
    v_rcp_f32 v201, v201
    v_rcp_f32 v202, v202
    v_rcp_f32 v203, v203
    v_pk_mul_f32 v[140:141], v[140:141], v[200:201]
    v_pk_mul_f32 v[142:143], v[142:143], v[202:203]
    buffer_load_dwordx4 v9, s[72:75], s44 offen offset:2048 sc1 lds
    v_cvt_pk_bf16_f32 v126, v140, v141
    v_cvt_pk_bf16_f32 v127, v142, v143
    buffer_store_dwordx4 v[124:127], v1, s[20:23], s41 offen offset:1024 sc1
    v_pk_mul_f32 v[200:201], v[128:129], s[36:37]
    v_pk_mul_f32 v[202:203], v[130:131], s[36:37]
    v_exp_f32 v200, v200
    v_exp_f32 v201, v201
    buffer_load_dwordx4 v9, s[72:75], s44 offen offset:3072 sc1 lds
    v_exp_f32 v202, v202
    v_exp_f32 v203, v203
    v_pk_mul_f32 v[128:129], v[128:129], v[240:241]
    v_pk_mul_f32 v[130:131], v[130:131], v[242:243]
    v_pk_add_f32 v[200:201], v[200:201], 1.0 op_sel_hi:[1,0]
    v_pk_add_f32 v[202:203], v[202:203], 1.0 op_sel_hi:[1,0]
    v_rcp_f32 v200, v200
    s_mov_b32 s44, 0xc0000
    s_add_u32 m0, s62, 0xc000
    s_nop 0
    buffer_load_dwordx4 v9, s[72:75], s44 offen offset:0 sc1 lds
    v_rcp_f32 v201, v201
    v_rcp_f32 v202, v202
    v_rcp_f32 v203, v203
    v_pk_mul_f32 v[128:129], v[128:129], v[200:201]
    v_pk_mul_f32 v[130:131], v[130:131], v[202:203]
    v_cvt_pk_bf16_f32 v128, v128, v129
    buffer_load_dwordx4 v9, s[72:75], s44 offen offset:1024 sc1 lds
    v_cvt_pk_bf16_f32 v129, v130, v131
    v_accvgpr_read_b32 v204, a0
    v_accvgpr_read_b32 v205, a1
    v_accvgpr_read_b32 v206, a2
    v_accvgpr_read_b32 v207, a3
    v_pk_mul_f32 v[200:201], v[144:145], s[36:37]
    v_pk_mul_f32 v[202:203], v[146:147], s[36:37]
    buffer_load_dwordx4 v9, s[72:75], s44 offen offset:2048 sc1 lds
    v_exp_f32 v200, v200
    v_exp_f32 v201, v201
    v_exp_f32 v202, v202
    v_exp_f32 v203, v203
    v_pk_mul_f32 v[144:145], v[144:145], v[204:205]
    v_pk_mul_f32 v[146:147], v[146:147], v[206:207]
    buffer_load_dwordx4 v9, s[72:75], s44 offen offset:3072 sc1 lds
    v_pk_add_f32 v[200:201], v[200:201], 1.0 op_sel_hi:[1,0]
    v_pk_add_f32 v[202:203], v[202:203], 1.0 op_sel_hi:[1,0]
    v_rcp_f32 v200, v200
    v_rcp_f32 v201, v201
    v_rcp_f32 v202, v202
    v_rcp_f32 v203, v203
    v_pk_mul_f32 v[144:145], v[144:145], v[200:201]
    s_mov_b32 s44, 0x100000
    s_add_u32 m0, s62, 0x10000
    s_nop 0
    buffer_load_dwordx4 v9, s[72:75], s44 offen offset:0 sc1 lds
    v_pk_mul_f32 v[146:147], v[146:147], v[202:203]
    v_cvt_pk_bf16_f32 v130, v144, v145
    v_cvt_pk_bf16_f32 v131, v146, v147
    buffer_store_dwordx4 v[128:131], v1, s[20:23], s41 offen offset:2048 sc1
    v_pk_mul_f32 v[200:201], v[132:133], s[36:37]
    v_pk_mul_f32 v[202:203], v[134:135], s[36:37]
    buffer_load_dwordx4 v9, s[72:75], s44 offen offset:1024 sc1 lds
    v_exp_f32 v200, v200
    v_exp_f32 v201, v201
    v_exp_f32 v202, v202
    v_exp_f32 v203, v203
    v_pk_mul_f32 v[132:133], v[132:133], v[244:245]
    v_pk_mul_f32 v[134:135], v[134:135], v[246:247]
    v_pk_add_f32 v[200:201], v[200:201], 1.0 op_sel_hi:[1,0]
    buffer_load_dwordx4 v9, s[72:75], s44 offen offset:2048 sc1 lds
    v_pk_add_f32 v[202:203], v[202:203], 1.0 op_sel_hi:[1,0]
    v_rcp_f32 v200, v200
    v_rcp_f32 v201, v201
    v_rcp_f32 v202, v202
    v_rcp_f32 v203, v203
    v_pk_mul_f32 v[132:133], v[132:133], v[200:201]
    s_cmp_eq_u32 s48, 0
    s_cbranch_scc0 M_np0
    buffer_load_dwordx2 v[18:19], v17, s[92:95], 0 offen sc1
M_np0:
    v_pk_mul_f32 v[134:135], v[134:135], v[202:203]
    v_cvt_pk_bf16_f32 v132, v132, v133
    v_cvt_pk_bf16_f32 v133, v134, v135
    v_accvgpr_read_b32 v204, a4
    v_accvgpr_read_b32 v205, a5
    v_accvgpr_read_b32 v206, a6
    v_accvgpr_read_b32 v207, a7
    buffer_load_dwordx4 v9, s[72:75], s44 offen offset:3072 sc1 lds
    v_pk_mul_f32 v[200:201], v[148:149], s[36:37]
    v_pk_mul_f32 v[202:203], v[150:151], s[36:37]
    v_exp_f32 v200, v200
    v_exp_f32 v201, v201
    v_exp_f32 v202, v202
    v_exp_f32 v203, v203
    s_mov_b32 s44, 0x140000
    s_add_u32 m0, s62, 0x14000
    s_nop 0
    buffer_load_dwordx4 v9, s[72:75], s44 offen offset:0 sc1 lds
    v_pk_mul_f32 v[148:149], v[148:149], v[204:205]
    v_pk_mul_f32 v[150:151], v[150:151], v[206:207]
    v_pk_add_f32 v[200:201], v[200:201], 1.0 op_sel_hi:[1,0]
    v_pk_add_f32 v[202:203], v[202:203], 1.0 op_sel_hi:[1,0]
    v_rcp_f32 v200, v200
    v_rcp_f32 v201, v201
    v_rcp_f32 v202, v202
    buffer_load_dwordx4 v9, s[72:75], s44 offen offset:1024 sc1 lds
    v_rcp_f32 v203, v203
    v_pk_mul_f32 v[148:149], v[148:149], v[200:201]
    v_pk_mul_f32 v[150:151], v[150:151], v[202:203]
    v_cvt_pk_bf16_f32 v134, v148, v149
    v_cvt_pk_bf16_f32 v135, v150, v151
    buffer_store_dwordx4 v[132:135], v1, s[20:23], s41 offen offset:3072 sc1
    s_add_u32 s41, s41, 4194304
    s_waitcnt lgkmcnt(0)
    s_mov_b32 s32, s80
    s_mov_b32 s33, s81
    s_mov_b32 s34, 0x400000
    s_mov_b32 s35, 0x00020000
    s_cmp_eq_u32 s48, 0
    s_cbranch_scc0 M_gate
    s_waitcnt vmcnt(4)
    s_mov_b32 s91, 0
M_pc6:
    v_xor_b32 v14, s12, v18
    v_bfe_u32 v15, v19, 2, 1
    v_xor_b32 v15, 1, v15
    v_or_b32 v14, v14, v15
    v_cmp_ne_u32 vcc, 0, v14
    s_nop 3
    s_cmp_eq_u32 vcc_lo, 0
    s_cbranch_scc1 M_pc6_ok
    s_add_u32 s91, s91, 1
    s_cmp_ge_u32 s91, 0x40000
    s_cbranch_scc1 M_pc6_ok
    s_sleep 2
    buffer_load_dwordx2 v[18:19], v17, s[92:95], 0 offen sc1
    s_waitcnt vmcnt(0)
    s_branch M_pc6
M_pc6_ok:
M_gate:
    s_waitcnt vmcnt(22)
    s_barrier
    s_mov_b32 s43, 0x0
    buffer_load_dwordx4 a[144:147], v7, s[20:23], s43 offen offset:0 sc1
    s_nop 1
    v_pk_mov_b32 v[88:89], 0, 0
    v_pk_mov_b32 v[90:91], 0, 0
    v_pk_mov_b32 v[92:93], 0, 0
    v_pk_mov_b32 v[94:95], 0, 0
    v_pk_mov_b32 v[96:97], 0, 0
    v_pk_mov_b32 v[98:99], 0, 0
    v_pk_mov_b32 v[100:101], 0, 0
    v_pk_mov_b32 v[102:103], 0, 0
    v_pk_mov_b32 v[104:105], 0, 0
    v_pk_mov_b32 v[106:107], 0, 0
    v_pk_mov_b32 v[108:109], 0, 0
    buffer_load_dwordx4 a[148:151], v7, s[20:23], s43 offen offset:1024 sc1
    v_pk_mov_b32 v[110:111], 0, 0
    v_pk_mov_b32 v[112:113], 0, 0
    v_pk_mov_b32 v[114:115], 0, 0
    v_pk_mov_b32 v[116:117], 0, 0
    v_pk_mov_b32 v[118:119], 0, 0
    v_pk_mov_b32 v[120:121], 0, 0
    v_pk_mov_b32 v[122:123], 0, 0
    v_pk_mov_b32 v[124:125], 0, 0
    v_pk_mov_b32 v[126:127], 0, 0
    v_pk_mov_b32 v[128:129], 0, 0
    v_pk_mov_b32 v[130:131], 0, 0
    v_pk_mov_b32 v[132:133], 0, 0
    buffer_load_dwordx4 a[152:155], v8, s[20:23], s43 offen offset:0 sc1
    v_pk_mov_b32 v[134:135], 0, 0
    v_pk_mov_b32 v[136:137], 0, 0
    v_pk_mov_b32 v[138:139], 0, 0
    v_pk_mov_b32 v[140:141], 0, 0
    v_pk_mov_b32 v[142:143], 0, 0
    v_pk_mov_b32 v[144:145], 0, 0
    v_pk_mov_b32 v[146:147], 0, 0
    v_pk_mov_b32 v[148:149], 0, 0
    v_pk_mov_b32 v[150:151], 0, 0
    v_pk_mul_f32 v[200:201], v[24:25], s[38:39]
    v_pk_mul_f32 v[202:203], v[26:27], s[38:39]
    v_exp_f32_e64 v200, v200 clamp
    buffer_load_dwordx4 a[156:159], v8, s[20:23], s43 offen offset:1024 sc1
    v_exp_f32_e64 v201, v201 clamp
    v_exp_f32_e64 v202, v202 clamp
    v_exp_f32_e64 v203, v203 clamp
    v_max_f32 v24, s40, v24
    v_max_f32 v25, s40, v25
    v_max_f32 v26, s40, v26
    v_max_f32 v27, s40, v27
    v_pk_add_f32 v[24:25], v[24:25], v[200:201]
    v_pk_add_f32 v[26:27], v[26:27], v[202:203]
    v_cvt_pk_bf16_f32 v24, v24, v25
    v_cvt_pk_bf16_f32 v25, v26, v27
    v_pk_mul_f32 v[200:201], v[28:29], s[38:39]
    s_mov_b32 s43, 0x80000
    buffer_load_dwordx4 a[160:163], v7, s[20:23], s43 offen offset:0 sc1
    v_pk_mul_f32 v[202:203], v[30:31], s[38:39]
    v_exp_f32_e64 v200, v200 clamp
    v_exp_f32_e64 v201, v201 clamp
    v_exp_f32_e64 v202, v202 clamp
    v_exp_f32_e64 v203, v203 clamp
    v_max_f32 v28, s40, v28
    v_max_f32 v29, s40, v29
    v_max_f32 v30, s40, v30
    v_max_f32 v31, s40, v31
    v_pk_add_f32 v[28:29], v[28:29], v[200:201]
    v_pk_add_f32 v[30:31], v[30:31], v[202:203]
    v_cvt_pk_bf16_f32 v26, v28, v29
    buffer_load_dwordx4 a[164:167], v7, s[20:23], s43 offen offset:1024 sc1
    v_cvt_pk_bf16_f32 v27, v30, v31
    v_pk_mul_f32 v[200:201], v[32:33], s[38:39]
    v_pk_mul_f32 v[202:203], v[34:35], s[38:39]
    v_exp_f32_e64 v200, v200 clamp
    v_exp_f32_e64 v201, v201 clamp
    v_exp_f32_e64 v202, v202 clamp
    v_exp_f32_e64 v203, v203 clamp
    v_max_f32 v32, s40, v32
    v_max_f32 v33, s40, v33
    v_max_f32 v34, s40, v34
    v_max_f32 v35, s40, v35
    v_pk_add_f32 v[32:33], v[32:33], v[200:201]
    buffer_load_dwordx4 a[168:171], v8, s[20:23], s43 offen offset:0 sc1
    v_pk_add_f32 v[34:35], v[34:35], v[202:203]
    v_cvt_pk_bf16_f32 v32, v32, v33
    v_cvt_pk_bf16_f32 v33, v34, v35
    v_pk_mul_f32 v[200:201], v[36:37], s[38:39]
    v_pk_mul_f32 v[202:203], v[38:39], s[38:39]
    v_exp_f32_e64 v200, v200 clamp
    v_exp_f32_e64 v201, v201 clamp
    v_exp_f32_e64 v202, v202 clamp
    v_exp_f32_e64 v203, v203 clamp
    v_max_f32 v36, s40, v36
    v_max_f32 v37, s40, v37
    v_max_f32 v38, s40, v38
    buffer_load_dwordx4 a[172:175], v8, s[20:23], s43 offen offset:1024 sc1
    v_max_f32 v39, s40, v39
    v_pk_add_f32 v[36:37], v[36:37], v[200:201]
    v_pk_add_f32 v[38:39], v[38:39], v[202:203]
    v_cvt_pk_bf16_f32 v34, v36, v37
    v_cvt_pk_bf16_f32 v35, v38, v39
    v_pk_mul_f32 v[200:201], v[40:41], s[38:39]
    v_pk_mul_f32 v[202:203], v[42:43], s[38:39]
    v_exp_f32_e64 v200, v200 clamp
    v_exp_f32_e64 v201, v201 clamp
    v_exp_f32_e64 v202, v202 clamp
    v_exp_f32_e64 v203, v203 clamp
    v_max_f32 v40, s40, v40
    s_mov_b32 s43, 0x100000
    buffer_load_dwordx4 a[176:179], v7, s[20:23], s43 offen offset:0 sc1
    v_max_f32 v41, s40, v41
    v_max_f32 v42, s40, v42
    v_max_f32 v43, s40, v43
    v_pk_add_f32 v[40:41], v[40:41], v[200:201]
    v_pk_add_f32 v[42:43], v[42:43], v[202:203]
    v_cvt_pk_bf16_f32 v40, v40, v41
    v_cvt_pk_bf16_f32 v41, v42, v43
    v_pk_mul_f32 v[200:201], v[44:45], s[38:39]
    v_pk_mul_f32 v[202:203], v[46:47], s[38:39]
    v_exp_f32_e64 v200, v200 clamp
    v_exp_f32_e64 v201, v201 clamp
    v_exp_f32_e64 v202, v202 clamp
    buffer_load_dwordx4 a[180:183], v7, s[20:23], s43 offen offset:1024 sc1
    v_exp_f32_e64 v203, v203 clamp
    v_max_f32 v44, s40, v44
    v_max_f32 v45, s40, v45
    v_max_f32 v46, s40, v46
    v_max_f32 v47, s40, v47
    v_pk_add_f32 v[44:45], v[44:45], v[200:201]
    v_pk_add_f32 v[46:47], v[46:47], v[202:203]
    v_cvt_pk_bf16_f32 v42, v44, v45
    v_cvt_pk_bf16_f32 v43, v46, v47
    v_pk_mul_f32 v[200:201], v[48:49], s[38:39]
    v_pk_mul_f32 v[202:203], v[50:51], s[38:39]
    v_exp_f32_e64 v200, v200 clamp
    buffer_load_dwordx4 a[184:187], v8, s[20:23], s43 offen offset:0 sc1
    v_exp_f32_e64 v201, v201 clamp
    v_exp_f32_e64 v202, v202 clamp
    v_exp_f32_e64 v203, v203 clamp
    v_max_f32 v48, s40, v48
    v_max_f32 v49, s40, v49
    v_max_f32 v50, s40, v50
    v_max_f32 v51, s40, v51
    v_pk_add_f32 v[48:49], v[48:49], v[200:201]
    v_pk_add_f32 v[50:51], v[50:51], v[202:203]
    v_cvt_pk_bf16_f32 v48, v48, v49
    v_cvt_pk_bf16_f32 v49, v50, v51
    v_pk_mul_f32 v[200:201], v[52:53], s[38:39]
    buffer_load_dwordx4 a[188:191], v8, s[20:23], s43 offen offset:1024 sc1
    v_pk_mul_f32 v[202:203], v[54:55], s[38:39]
    v_exp_f32_e64 v200, v200 clamp
    v_exp_f32_e64 v201, v201 clamp
    v_exp_f32_e64 v202, v202 clamp
    v_exp_f32_e64 v203, v203 clamp
    v_max_f32 v52, s40, v52
    v_max_f32 v53, s40, v53
    v_max_f32 v54, s40, v54
    v_max_f32 v55, s40, v55
    v_pk_add_f32 v[52:53], v[52:53], v[200:201]
    v_pk_add_f32 v[54:55], v[54:55], v[202:203]
    v_cvt_pk_bf16_f32 v50, v52, v53
    v_cvt_pk_bf16_f32 v51, v54, v55
    ds_read_b128 a[112:115], v13 offset:0
    ds_read_b128 a[116:119], v13 offset:1024
    ds_read_b128 a[120:123], v13 offset:2048
    ds_read_b128 a[124:127], v13 offset:3072
    ds_read_b128 a[128:131], v13 offset:4096
    ds_read_b128 a[132:135], v13 offset:5120
    s_waitcnt vmcnt(10) lgkmcnt(4)
    v_mfma_f32_16x16x32_bf16 v[88:91], a[112:115], a[144:147], v[88:91]
    ds_read_b128 a[136:139], v13 offset:6144
    v_add_u32 v216, 0x10000, v13
    v_mfma_f32_16x16x32_bf16 v[104:107], a[112:115], a[148:151], v[104:107]
    s_mov_b32 s43, 0x180000
    buffer_load_dwordx4 a[192:195], v7, s[20:23], s43 offen offset:0 sc1
    v_mov_b32 v208, 0x3f803f80
    v_mfma_f32_16x16x32_bf16 v[108:111], a[116:119], a[148:151], v[108:111]
    ds_read_b128 a[140:143], v13 offset:7168
    v_mov_b32 v209, 0x3f803f80
    v_mfma_f32_16x16x32_bf16 v[92:95], a[116:119], a[144:147], v[92:95]
    buffer_load_dwordx4 a[196:199], v7, s[20:23], s43 offen offset:1024 sc1
    v_mov_b32 v210, 0x3f803f80
    s_waitcnt lgkmcnt(4)
    v_mfma_f32_16x16x32_bf16 v[96:99], a[120:123], a[144:147], v[96:99]
    ds_read_b128 a[112:115], v13 offset:8192
    v_mov_b32 v211, 0x3f803f80
    v_mfma_f32_16x16x32_bf16 v[112:115], a[120:123], a[148:151], v[112:115]
    v_cvt_pk_bf16_f32 v56, v56, v57
    v_mfma_f32_16x16x32_bf16 v[116:119], a[124:127], a[148:151], v[116:119]
    ds_read_b128 a[116:119], v13 offset:9216
    v_cvt_pk_bf16_f32 v57, v58, v59
    v_mfma_f32_16x16x32_bf16 v[100:103], a[124:127], a[144:147], v[100:103]
    v_cvt_pk_bf16_f32 v58, v60, v61
    v_cvt_pk_bf16_f32 v59, v62, v63
    s_waitcnt lgkmcnt(4)
    v_mfma_f32_16x16x32_bf16 v[120:123], a[128:131], a[144:147], v[120:123]
    ds_read_b128 a[120:123], v13 offset:10240
    v_cvt_pk_bf16_f32 v64, v64, v65
    v_mfma_f32_16x16x32_bf16 v[136:139], a[128:131], a[148:151], v[136:139]
    v_cvt_pk_bf16_f32 v65, v66, v67
    v_mfma_f32_16x16x32_bf16 v[140:143], a[132:135], a[148:151], v[140:143]
    ds_read_b128 a[124:127], v13 offset:11264
    v_cvt_pk_bf16_f32 v66, v68, v69
    v_mfma_f32_16x16x32_bf16 v[124:127], a[132:135], a[144:147], v[124:127]
    v_cvt_pk_bf16_f32 v67, v70, v71
    s_waitcnt lgkmcnt(4)
    v_mfma_f32_16x16x32_bf16 v[128:131], a[136:139], a[144:147], v[128:131]
    ds_read_b128 a[128:131], v13 offset:12288
    v_cvt_pk_bf16_f32 v72, v72, v73
    v_mfma_f32_16x16x32_bf16 v[144:147], a[136:139], a[148:151], v[144:147]
    v_cvt_pk_bf16_f32 v73, v74, v75
    v_cvt_pk_bf16_f32 v74, v76, v77
    v_mfma_f32_16x16x32_bf16 v[148:151], a[140:143], a[148:151], v[148:151]
    ds_read_b128 a[132:135], v13 offset:13312
    v_cvt_pk_bf16_f32 v75, v78, v79
    v_mfma_f32_16x16x32_bf16 v[132:135], a[140:143], a[144:147], v[132:135]
    v_cvt_pk_bf16_f32 v80, v80, v81
    s_waitcnt vmcnt(10) lgkmcnt(4)
    v_mfma_f32_16x16x32_bf16 v[88:91], a[112:115], a[152:155], v[88:91]
    ds_read_b128 a[136:139], v13 offset:14336
    v_cvt_pk_bf16_f32 v81, v82, v83
    v_mfma_f32_16x16x32_bf16 v[104:107], a[112:115], a[156:159], v[104:107]
    buffer_load_dwordx4 a[200:203], v8, s[20:23], s43 offen offset:0 sc1
    v_cvt_pk_bf16_f32 v82, v84, v85
    v_mfma_f32_16x16x32_bf16 v[108:111], a[116:119], a[156:159], v[108:111]
    ds_read_b128 a[140:143], v13 offset:15360
    v_cvt_pk_bf16_f32 v83, v86, v87
    v_mfma_f32_16x16x32_bf16 v[92:95], a[116:119], a[152:155], v[92:95]
    buffer_load_dwordx4 a[204:207], v8, s[20:23], s43 offen offset:1024 sc1
    s_mul_i32 s64, s48, 6144
    s_add_u32 s64, s64, 114688
    s_waitcnt lgkmcnt(4)
    s_barrier
    s_cmp_eq_u32 s48, 0
    s_cbranch_scc0 M_fs7
    v_mov_b32 v14, s12
    v_mov_b32 v15, 15
    s_mov_b64 exec, 1
    buffer_store_dwordx2 v[14:15], off, s[92:95], s90 sc1
    s_mov_b64 exec, -1
M_fs7:
    v_mfma_f32_16x16x32_bf16 v[96:99], a[120:123], a[152:155], v[96:99]
    ds_read_b128 a[112:115], v13 offset:16384
    v_add_u32 v11, s64, v13
    v_mfma_f32_16x16x32_bf16 v[112:115], a[120:123], a[156:159], v[112:115]
    s_lshl_b32 s64, s48, 10
    v_mfma_f32_16x16x32_bf16 v[116:119], a[124:127], a[156:159], v[116:119]
    ds_read_b128 a[116:119], v13 offset:17408
    v_mfma_f32_16x16x32_bf16 a[88:91], v[24:27], v[56:59], 0
    v_mfma_f32_16x16x32_bf16 v[100:103], a[124:127], a[152:155], v[100:103]
    buffer_load_dwordx4 v9, s[72:75], s44 offen offset:2048 sc1 lds
    v_mfma_f32_16x16x32_bf16 a[92:95], v[24:27], v[72:75], 0
    s_waitcnt lgkmcnt(4)
    v_mfma_f32_16x16x32_bf16 v[120:123], a[128:131], a[152:155], v[120:123]
    ds_read_b128 a[120:123], v13 offset:18432
    v_mfma_f32_16x16x32_bf16 a[96:99], v[24:27], v[208:211], 0
    v_mfma_f32_16x16x32_bf16 v[136:139], a[128:131], a[156:159], v[136:139]
    v_mfma_f32_16x16x32_bf16 a[100:103], v[40:43], v[56:59], 0
    v_mfma_f32_16x16x32_bf16 a[104:107], v[40:43], v[72:75], 0
    v_mfma_f32_16x16x32_bf16 v[140:143], a[132:135], a[156:159], v[140:143]
    ds_read_b128 a[124:127], v13 offset:19456
    v_mfma_f32_16x16x32_bf16 a[108:111], v[40:43], v[208:211], 0
    v_mfma_f32_16x16x32_bf16 v[124:127], a[132:135], a[152:155], v[124:127]
    v_mfma_f32_16x16x32_bf16 a[88:91], v[32:35], v[64:67], a[88:91]
    s_waitcnt lgkmcnt(4)
    v_mfma_f32_16x16x32_bf16 v[128:131], a[136:139], a[152:155], v[128:131]
    ds_read_b128 a[128:131], v13 offset:20480
    v_mfma_f32_16x16x32_bf16 a[92:95], v[32:35], v[80:83], a[92:95]
    v_mfma_f32_16x16x32_bf16 v[144:147], a[136:139], a[156:159], v[144:147]
    v_mfma_f32_16x16x32_bf16 a[96:99], v[32:35], v[208:211], a[96:99]
    v_mfma_f32_16x16x32_bf16 v[148:151], a[140:143], a[156:159], v[148:151]
    ds_read_b128 a[132:135], v13 offset:21504
    v_mfma_f32_16x16x32_bf16 a[100:103], v[48:51], v[64:67], a[100:103]
    v_mfma_f32_16x16x32_bf16 v[132:135], a[140:143], a[152:155], v[132:135]
    buffer_load_dwordx4 v9, s[72:75], s44 offen offset:3072 sc1 lds
    v_mfma_f32_16x16x32_bf16 a[104:107], v[48:51], v[80:83], a[104:107]
    v_mfma_f32_16x16x32_bf16 a[108:111], v[48:51], v[208:211], a[108:111]
    s_waitcnt vmcnt(12) lgkmcnt(4)
    v_mfma_f32_16x16x32_bf16 v[88:91], a[112:115], a[160:163], v[88:91]
    ds_read_b128 a[136:139], v13 offset:22528
    s_add_u32 s65, s64, 114688
    v_mfma_f32_16x16x32_bf16 v[104:107], a[112:115], a[164:167], v[104:107]
    s_mov_b32 s43, 0x200000
    buffer_load_dwordx4 a[208:211], v7, s[20:23], s43 offen offset:0 sc1
    v_add_u32 v12, s65, v13
    v_mfma_f32_16x16x32_bf16 v[108:111], a[116:119], a[164:167], v[108:111]
    ds_read_b128 a[140:143], v13 offset:23552
    s_lshl_b32 s65, s49, 3
    v_mfma_f32_16x16x32_bf16 v[92:95], a[116:119], a[160:163], v[92:95]
    buffer_load_dwordx4 a[212:215], v7, s[20:23], s43 offen offset:1024 sc1
    s_add_u32 s65, s65, s50
    s_waitcnt lgkmcnt(4)
    v_mfma_f32_16x16x32_bf16 v[96:99], a[120:123], a[160:163], v[96:99]
    ds_read_b128 a[112:115], v13 offset:24576
    s_mul_i32 s65, s65, 6144
    v_mfma_f32_16x16x32_bf16 v[112:115], a[120:123], a[164:167], v[112:115]
    v_add_u32 v22, s64, v13
    s_add_u32 s66, s65, 4096
    v_mfma_f32_16x16x32_bf16 v[116:119], a[124:127], a[164:167], v[116:119]
    ds_read_b128 a[116:119], v13 offset:25600
    s_cmp_lt_u32 s48, 2
    s_cselect_b32 s66, s66, 0x70000000
    v_mfma_f32_16x16x32_bf16 v[100:103], a[124:127], a[160:163], v[100:103]
    s_mov_b32 s44, 0x180000
    s_add_u32 m0, s62, 0x18000
    s_nop 0
    buffer_load_dwordx4 v9, s[72:75], s44 offen offset:0 sc1 lds
    ds_write_b128 v11, a[88:91] offset:0
    s_waitcnt lgkmcnt(5)
    v_mfma_f32_16x16x32_bf16 v[120:123], a[128:131], a[160:163], v[120:123]
    ds_read_b128 a[120:123], v13 offset:26624
    ds_write_b128 v11, a[92:95] offset:1024
    v_mfma_f32_16x16x32_bf16 v[136:139], a[128:131], a[164:167], v[136:139]
    ds_write_b128 v11, a[96:99] offset:2048
    v_mfma_f32_16x16x32_bf16 v[140:143], a[132:135], a[164:167], v[140:143]
    ds_read_b128 a[124:127], v13 offset:27648
    ds_write_b128 v11, a[100:103] offset:3072
    v_mfma_f32_16x16x32_bf16 v[124:127], a[132:135], a[160:163], v[124:127]
    ds_write_b128 v11, a[104:107] offset:4096
    ds_write_b128 v11, a[108:111] offset:5120
    s_waitcnt lgkmcnt(10)
    v_mfma_f32_16x16x32_bf16 v[128:131], a[136:139], a[160:163], v[128:131]
    ds_read_b128 a[128:131], v13 offset:28672
    v_mfma_f32_16x16x32_bf16 v[144:147], a[136:139], a[164:167], v[144:147]
    v_and_b32 v212, 15, v0
    v_mfma_f32_16x16x32_bf16 v[148:151], a[140:143], a[164:167], v[148:151]
    ds_read_b128 a[132:135], v13 offset:29696
    v_mfma_f32_16x16x32_bf16 v[132:135], a[140:143], a[160:163], v[132:135]
    buffer_load_dwordx4 v9, s[72:75], s44 offen offset:1024 sc1 lds
    v_lshlrev_b32 v214, 4, v212
    s_waitcnt vmcnt(14) lgkmcnt(10)
    v_mfma_f32_16x16x32_bf16 v[88:91], a[112:115], a[168:171], v[88:91]
    ds_read_b128 a[136:139], v13 offset:30720
    v_bfe_u32 v213, v0, 4, 1
    v_mfma_f32_16x16x32_bf16 v[104:107], a[112:115], a[172:175], v[104:107]
    buffer_load_dwordx4 a[216:219], v8, s[20:23], s43 offen offset:0 sc1
    v_lshl_add_u32 v214, v213, 10, v214
    v_mfma_f32_16x16x32_bf16 v[108:111], a[116:119], a[172:175], v[108:111]
    ds_read_b128 a[140:143], v13 offset:31744
    v_mfma_f32_16x16x32_bf16 v[92:95], a[116:119], a[168:171], v[92:95]
    buffer_load_dwordx4 a[220:223], v8, s[20:23], s43 offen offset:1024 sc1
    v_lshrrev_b32 v213, 5, v0
    s_waitcnt lgkmcnt(4)
    s_barrier
    v_mfma_f32_16x16x32_bf16 v[96:99], a[120:123], a[168:171], v[96:99]
    ds_read_b128 a[112:115], v13 offset:32768
    ds_read_b128 v[24:27], v12 offset:0
    v_mfma_f32_16x16x32_bf16 v[112:115], a[120:123], a[172:175], v[112:115]
    v_lshl_add_u32 v214, v213, 8, v214
    v_mfma_f32_16x16x32_bf16 v[116:119], a[124:127], a[172:175], v[116:119]
    ds_read_b128 a[116:119], v13 offset:33792
    ds_read_b128 v[28:31], v12 offset:6144
    v_mfma_f32_16x16x32_bf16 v[100:103], a[124:127], a[168:171], v[100:103]
    buffer_load_dwordx4 v9, s[72:75], s44 offen offset:2048 sc1 lds
    v_sub_u32 v231, v1, v13
    v_add_u32 v231, v231, v214
    s_waitcnt lgkmcnt(6)
    v_mfma_f32_16x16x32_bf16 v[120:123], a[128:131], a[168:171], v[120:123]
    ds_read_b128 a[120:123], v13 offset:34816
    v_mfma_f32_16x16x32_bf16 v[136:139], a[128:131], a[172:175], v[136:139]
    ds_read_b128 v[32:35], v12 offset:12288
    v_mfma_f32_16x16x32_bf16 v[140:143], a[132:135], a[172:175], v[140:143]
    ds_read_b128 a[124:127], v13 offset:35840
    v_mfma_f32_16x16x32_bf16 v[124:127], a[132:135], a[168:171], v[124:127]
    ds_read_b128 v[36:39], v12 offset:18432
    s_waitcnt lgkmcnt(8)
    v_mfma_f32_16x16x32_bf16 v[128:131], a[136:139], a[168:171], v[128:131]
    ds_read_b128 a[128:131], v13 offset:36864
    v_mfma_f32_16x16x32_bf16 v[144:147], a[136:139], a[172:175], v[144:147]
    ds_read_b128 v[40:43], v12 offset:4096
    v_mfma_f32_16x16x32_bf16 v[148:151], a[140:143], a[172:175], v[148:151]
    ds_read_b128 a[132:135], v13 offset:37888
    v_mfma_f32_16x16x32_bf16 v[132:135], a[140:143], a[168:171], v[132:135]
    buffer_load_dwordx4 v9, s[72:75], s44 offen offset:3072 sc1 lds
    ds_read_b128 v[44:47], v12 offset:10240
    s_waitcnt vmcnt(16) lgkmcnt(9)
    v_mfma_f32_16x16x32_bf16 v[88:91], a[112:115], a[176:179], v[88:91]
    ds_read_b128 a[136:139], v13 offset:38912
    v_mfma_f32_16x16x32_bf16 v[104:107], a[112:115], a[180:183], v[104:107]
    s_mov_b32 s43, 0x280000
    buffer_load_dwordx4 a[224:227], v7, s[20:23], s43 offen offset:0 sc1
    ds_read_b128 v[48:51], v12 offset:16384
    v_mfma_f32_16x16x32_bf16 v[108:111], a[116:119], a[180:183], v[108:111]
    ds_read_b128 a[140:143], v13 offset:39936
    v_mfma_f32_16x16x32_bf16 v[92:95], a[116:119], a[176:179], v[92:95]
    buffer_load_dwordx4 a[228:231], v7, s[20:23], s43 offen offset:1024 sc1
    ds_read_b128 v[52:55], v12 offset:22528
    s_waitcnt lgkmcnt(9)
    v_mfma_f32_16x16x32_bf16 v[96:99], a[120:123], a[176:179], v[96:99]
    ds_read_b128 a[112:115], v13 offset:40960
    v_mfma_f32_16x16x32_bf16 v[112:115], a[120:123], a[180:183], v[112:115]
    v_mfma_f32_16x16x32_bf16 v[116:119], a[124:127], a[180:183], v[116:119]
    ds_read_b128 a[116:119], v13 offset:41984
    v_mfma_f32_16x16x32_bf16 v[100:103], a[124:127], a[176:179], v[100:103]
    s_waitcnt lgkmcnt(7)
    v_mfma_f32_16x16x32_bf16 v[120:123], a[128:131], a[176:179], v[120:123]
    ds_read_b128 a[120:123], v13 offset:43008
    v_mfma_f32_16x16x32_bf16 v[136:139], a[128:131], a[180:183], v[136:139]
    v_mfma_f32_16x16x32_bf16 v[140:143], a[132:135], a[180:183], v[140:143]
    ds_read_b128 a[124:127], v13 offset:44032
    v_mfma_f32_16x16x32_bf16 v[124:127], a[132:135], a[176:179], v[124:127]
    s_waitcnt lgkmcnt(5)
    v_mfma_f32_16x16x32_bf16 v[128:131], a[136:139], a[176:179], v[128:131]
    ds_read_b128 a[128:131], v13 offset:45056
    s_waitcnt lgkmcnt(5)
    v_mfma_f32_16x16x32_bf16 v[144:147], a[136:139], a[180:183], v[144:147]
    v_add_f32 v24, v28, v24
    v_add_f32 v25, v29, v25
    v_mfma_f32_16x16x32_bf16 v[148:151], a[140:143], a[180:183], v[148:151]
    ds_read_b128 a[132:135], v13 offset:46080
    v_add_f32 v26, v30, v26
    v_add_f32 v27, v31, v27
    v_add_f32 v32, v36, v32
    v_mfma_f32_16x16x32_bf16 v[132:135], a[140:143], a[176:179], v[132:135]
    v_add_f32 v33, v37, v33
    v_add_f32 v34, v38, v34
    v_add_f32 v35, v39, v35
    s_waitcnt vmcnt(16) lgkmcnt(4)
    v_mfma_f32_16x16x32_bf16 v[88:91], a[112:115], a[184:187], v[88:91]
    ds_read_b128 a[136:139], v13 offset:47104
    v_add_f32 v24, v32, v24
    v_add_f32 v25, v33, v25
    v_mfma_f32_16x16x32_bf16 v[104:107], a[112:115], a[188:191], v[104:107]
    buffer_load_dwordx4 a[232:235], v8, s[20:23], s43 offen offset:0 sc1
    v_add_f32 v26, v34, v26
    v_add_f32 v27, v35, v27
    v_mfma_f32_16x16x32_bf16 v[108:111], a[116:119], a[188:191], v[108:111]
    ds_read_b128 a[140:143], v13 offset:48128
    buffer_store_dwordx4 v[24:27], v22, s[24:27], s65 offen sc1
    v_add_f32 v40, v44, v40
    v_mfma_f32_16x16x32_bf16 v[92:95], a[116:119], a[184:187], v[92:95]
    buffer_load_dwordx4 a[236:239], v8, s[20:23], s43 offen offset:1024 sc1
    v_add_f32 v41, v45, v41
    v_add_f32 v42, v46, v42
    v_add_f32 v43, v47, v43
    s_waitcnt lgkmcnt(4)
    s_barrier
    v_mfma_f32_16x16x32_bf16 v[96:99], a[120:123], a[184:187], v[96:99]
    ds_read_b128 a[112:115], v13 offset:49152
    v_add_f32 v48, v52, v48
    v_add_f32 v49, v53, v49
    v_mfma_f32_16x16x32_bf16 v[112:115], a[120:123], a[188:191], v[112:115]
    v_add_f32 v50, v54, v50
    v_add_f32 v51, v55, v51
    v_mfma_f32_16x16x32_bf16 v[116:119], a[124:127], a[188:191], v[116:119]
    ds_read_b128 a[116:119], v13 offset:50176
    v_add_f32 v40, v48, v40
    v_add_f32 v41, v49, v41
    v_mfma_f32_16x16x32_bf16 v[100:103], a[124:127], a[184:187], v[100:103]
    s_mov_b32 s44, 0x1c0000
    s_add_u32 m0, s62, 0x0
    s_nop 0
    buffer_load_dwordx4 v9, s[72:75], s44 offen offset:0 sc1 lds
    v_add_f32 v42, v50, v42
    v_add_f32 v43, v51, v43
    buffer_store_dwordx4 v[40:43], v22, s[24:27], s66 offen sc1
    s_waitcnt lgkmcnt(4)
    v_mfma_f32_16x16x32_bf16 v[120:123], a[128:131], a[184:187], v[120:123]
    ds_read_b128 a[120:123], v13 offset:51200
    v_accvgpr_read_b32 v204, a8
    v_accvgpr_read_b32 v205, a9
    v_mfma_f32_16x16x32_bf16 v[136:139], a[128:131], a[188:191], v[136:139]
    v_accvgpr_read_b32 v206, a10
    v_accvgpr_read_b32 v207, a11
    v_mfma_f32_16x16x32_bf16 v[140:143], a[132:135], a[188:191], v[140:143]
    ds_read_b128 a[124:127], v13 offset:52224
    v_mul_f32 v200, s36, v152
    v_mul_f32 v201, s36, v153
    v_mul_f32 v202, s36, v154
    v_mfma_f32_16x16x32_bf16 v[124:127], a[132:135], a[184:187], v[124:127]
    v_mul_f32 v203, s36, v155
    v_exp_f32 v200, v200
    v_exp_f32 v201, v201
    s_waitcnt lgkmcnt(4)
    v_mfma_f32_16x16x32_bf16 v[128:131], a[136:139], a[184:187], v[128:131]
    ds_read_b128 a[128:131], v13 offset:53248
    v_exp_f32 v202, v202
    v_exp_f32 v203, v203
    v_mul_f32 v152, v204, v152
    v_mfma_f32_16x16x32_bf16 v[144:147], a[136:139], a[188:191], v[144:147]
    v_mul_f32 v153, v205, v153
    v_mul_f32 v154, v206, v154
    v_mul_f32 v155, v207, v155
    v_mfma_f32_16x16x32_bf16 v[148:151], a[140:143], a[188:191], v[148:151]
    ds_read_b128 a[132:135], v13 offset:54272
    v_add_f32 v200, 1.0, v200
    v_add_f32 v201, 1.0, v201
    v_add_f32 v202, 1.0, v202
    v_mfma_f32_16x16x32_bf16 v[132:135], a[140:143], a[184:187], v[132:135]
    buffer_load_dwordx4 v9, s[72:75], s44 offen offset:1024 sc1 lds
    v_add_f32 v203, 1.0, v203
    v_rcp_f32 v200, v200
    v_rcp_f32 v201, v201
    s_waitcnt vmcnt(20) lgkmcnt(4)
    v_mfma_f32_16x16x32_bf16 v[88:91], a[112:115], a[192:195], v[88:91]
    ds_read_b128 a[136:139], v13 offset:55296
    v_rcp_f32 v202, v202
    v_rcp_f32 v203, v203
    v_mul_f32 v152, v200, v152
    v_mfma_f32_16x16x32_bf16 v[104:107], a[112:115], a[196:199], v[104:107]
    s_mov_b32 s43, 0x300000
    buffer_load_dwordx4 a[240:243], v7, s[20:23], s43 offen offset:0 sc1
    v_mul_f32 v153, v201, v153
    v_mul_f32 v154, v202, v154
    v_mul_f32 v155, v203, v155
    v_mfma_f32_16x16x32_bf16 v[108:111], a[116:119], a[196:199], v[108:111]
    ds_read_b128 a[140:143], v13 offset:56320
    v_cvt_pk_bf16_f32 v152, v152, v153
    v_cvt_pk_bf16_f32 v153, v154, v155
    v_mfma_f32_16x16x32_bf16 v[92:95], a[116:119], a[192:195], v[92:95]
    buffer_load_dwordx4 a[244:247], v7, s[20:23], s43 offen offset:1024 sc1
    v_accvgpr_read_b32 v204, a24
    v_accvgpr_read_b32 v205, a25
    s_waitcnt lgkmcnt(4)
    v_mfma_f32_16x16x32_bf16 v[96:99], a[120:123], a[192:195], v[96:99]
    ds_read_b128 a[112:115], v13 offset:57344
    v_accvgpr_read_b32 v206, a26
    v_accvgpr_read_b32 v207, a27
    v_mul_f32 v200, s36, v168
    v_mfma_f32_16x16x32_bf16 v[112:115], a[120:123], a[196:199], v[112:115]
    v_mul_f32 v201, s36, v169
    v_mul_f32 v202, s36, v170
    v_mul_f32 v203, s36, v171
    v_mfma_f32_16x16x32_bf16 v[116:119], a[124:127], a[196:199], v[116:119]
    ds_read_b128 a[116:119], v13 offset:58368
    v_exp_f32 v200, v200
    v_exp_f32 v201, v201
    v_mfma_f32_16x16x32_bf16 v[100:103], a[124:127], a[192:195], v[100:103]
    buffer_load_dwordx4 v9, s[72:75], s44 offen offset:2048 sc1 lds
    v_exp_f32 v202, v202
    v_exp_f32 v203, v203
    s_waitcnt lgkmcnt(4)
    v_mfma_f32_16x16x32_bf16 v[120:123], a[128:131], a[192:195], v[120:123]
    ds_read_b128 a[120:123], v13 offset:59392
    v_mul_f32 v168, v204, v168
    v_mul_f32 v169, v205, v169
    v_mul_f32 v170, v206, v170
    v_mul_f32 v171, v207, v171
    v_mfma_f32_16x16x32_bf16 v[136:139], a[128:131], a[196:199], v[136:139]
    v_add_f32 v200, 1.0, v200
    v_add_f32 v201, 1.0, v201
    v_add_f32 v202, 1.0, v202
    v_add_f32 v203, 1.0, v203
    v_rcp_f32 v200, v200
    v_mfma_f32_16x16x32_bf16 v[140:143], a[132:135], a[196:199], v[140:143]
    ds_read_b128 a[124:127], v13 offset:60416
    v_rcp_f32 v201, v201
    v_rcp_f32 v202, v202
    v_mfma_f32_16x16x32_bf16 v[124:127], a[132:135], a[192:195], v[124:127]
    v_rcp_f32 v203, v203
    v_mul_f32 v168, v200, v168
    v_mul_f32 v169, v201, v169
    s_waitcnt lgkmcnt(4)
    v_mfma_f32_16x16x32_bf16 v[128:131], a[136:139], a[192:195], v[128:131]
    ds_read_b128 a[128:131], v13 offset:61440
    v_mul_f32 v170, v202, v170
    v_mul_f32 v171, v203, v171
    v_mfma_f32_16x16x32_bf16 v[144:147], a[136:139], a[196:199], v[144:147]
    s_cmp_eq_u32 s48, 0
    s_cbranch_scc0 M_np73
    buffer_load_dwordx2 v[18:19], v17, s[92:95], 0 offen sc1
M_np73:
    v_cvt_pk_bf16_f32 v154, v168, v169
    v_cvt_pk_bf16_f32 v155, v170, v171
    buffer_store_dwordx4 v[152:155], v1, s[20:23], s41 offen offset:0 sc1
    v_mfma_f32_16x16x32_bf16 v[148:151], a[140:143], a[196:199], v[148:151]
    ds_read_b128 a[132:135], v13 offset:62464
    v_accvgpr_read_b32 v204, a12
    v_accvgpr_read_b32 v205, a13
    v_mfma_f32_16x16x32_bf16 v[132:135], a[140:143], a[192:195], v[132:135]
    buffer_load_dwordx4 v9, s[72:75], s44 offen offset:3072 sc1 lds
    v_accvgpr_read_b32 v206, a14
    v_accvgpr_read_b32 v207, a15
    s_waitcnt vmcnt(23) lgkmcnt(4)
    v_mfma_f32_16x16x32_bf16 v[88:91], a[112:115], a[200:203], v[88:91]
    ds_read_b128 a[136:139], v13 offset:63488
    v_mul_f32 v200, s36, v156
    v_mul_f32 v201, s36, v157
    v_mul_f32 v202, s36, v158
    v_mfma_f32_16x16x32_bf16 v[104:107], a[112:115], a[204:207], v[104:107]
    buffer_load_dwordx4 a[248:251], v8, s[20:23], s43 offen offset:0 sc1
    v_mul_f32 v203, s36, v159
    v_exp_f32 v200, v200
    v_exp_f32 v201, v201
    v_mfma_f32_16x16x32_bf16 v[108:111], a[116:119], a[204:207], v[108:111]
    ds_read_b128 a[140:143], v13 offset:64512
    v_exp_f32 v202, v202
    v_exp_f32 v203, v203
    v_mul_f32 v156, v204, v156
    v_mfma_f32_16x16x32_bf16 v[92:95], a[116:119], a[200:203], v[92:95]
    buffer_load_dwordx4 a[252:255], v8, s[20:23], s43 offen offset:1024 sc1
    v_mul_f32 v157, v205, v157
    v_mul_f32 v158, v206, v158
    v_mul_f32 v159, v207, v159
    s_waitcnt lgkmcnt(4)
    v_mfma_f32_16x16x32_bf16 v[96:99], a[120:123], a[200:203], v[96:99]
    ds_read_b128 a[112:115], v216 offset:0
    v_add_f32 v200, 1.0, v200
    v_add_f32 v201, 1.0, v201
    v_add_f32 v202, 1.0, v202
    v_mfma_f32_16x16x32_bf16 v[112:115], a[120:123], a[204:207], v[112:115]
    v_add_f32 v203, 1.0, v203
    v_rcp_f32 v200, v200
    v_rcp_f32 v201, v201
    v_mfma_f32_16x16x32_bf16 v[116:119], a[124:127], a[204:207], v[116:119]
    ds_read_b128 a[116:119], v216 offset:1024
    v_rcp_f32 v202, v202
    v_rcp_f32 v203, v203
    v_mul_f32 v156, v200, v156
    v_mfma_f32_16x16x32_bf16 v[100:103], a[124:127], a[200:203], v[100:103]
    s_mov_b32 s44, 0x200000
    s_add_u32 m0, s62, 0x4000
    s_nop 0
    buffer_load_dwordx4 v9, s[72:75], s44 offen offset:0 sc1 lds
    v_mul_f32 v157, v201, v157
    v_mul_f32 v158, v202, v158
    v_mul_f32 v159, v203, v159
    s_waitcnt lgkmcnt(4)
    v_mfma_f32_16x16x32_bf16 v[120:123], a[128:131], a[200:203], v[120:123]
    ds_read_b128 a[120:123], v216 offset:2048
    v_cvt_pk_bf16_f32 v156, v156, v157
    v_cvt_pk_bf16_f32 v157, v158, v159
    v_mfma_f32_16x16x32_bf16 v[136:139], a[128:131], a[204:207], v[136:139]
    v_accvgpr_read_b32 v204, a28
    v_accvgpr_read_b32 v205, a29
    v_mfma_f32_16x16x32_bf16 v[140:143], a[132:135], a[204:207], v[140:143]
    ds_read_b128 a[124:127], v216 offset:3072
    v_accvgpr_read_b32 v206, a30
    v_accvgpr_read_b32 v207, a31
    v_mul_f32 v200, s36, v172
    v_mfma_f32_16x16x32_bf16 v[124:127], a[132:135], a[200:203], v[124:127]
    v_mul_f32 v201, s36, v173
    v_mul_f32 v202, s36, v174
    v_mul_f32 v203, s36, v175
    v_exp_f32 v200, v200
    s_waitcnt lgkmcnt(4)
    v_mfma_f32_16x16x32_bf16 v[128:131], a[136:139], a[200:203], v[128:131]
    ds_read_b128 a[128:131], v216 offset:4096
    v_exp_f32 v201, v201
    v_exp_f32 v202, v202
    v_mfma_f32_16x16x32_bf16 v[144:147], a[136:139], a[204:207], v[144:147]
    v_exp_f32 v203, v203
    v_mul_f32 v172, v204, v172
    v_mul_f32 v173, v205, v173
    v_mfma_f32_16x16x32_bf16 v[148:151], a[140:143], a[204:207], v[148:151]
    ds_read_b128 a[132:135], v216 offset:5120
    v_mul_f32 v174, v206, v174
    v_mul_f32 v175, v207, v175
    v_add_f32 v200, 1.0, v200
    v_mfma_f32_16x16x32_bf16 v[132:135], a[140:143], a[200:203], v[132:135]
    buffer_load_dwordx4 v9, s[72:75], s44 offen offset:1024 sc1 lds
    v_add_f32 v201, 1.0, v201
    v_add_f32 v202, 1.0, v202
    v_add_f32 v203, 1.0, v203
    v_rcp_f32 v200, v200
    s_waitcnt vmcnt(23) lgkmcnt(4)
    v_mfma_f32_16x16x32_bf16 v[88:91], a[112:115], a[208:211], v[88:91]
    ds_read_b128 a[136:139], v216 offset:6144
    v_rcp_f32 v201, v201
    v_rcp_f32 v202, v202
    v_mfma_f32_16x16x32_bf16 v[104:107], a[112:115], a[212:215], v[104:107]
    s_mov_b32 s43, 0x380000
    buffer_load_dwordx4 a[144:147], v7, s[20:23], s43 offen offset:0 sc1
    v_rcp_f32 v203, v203
    v_mul_f32 v172, v200, v172
    v_mul_f32 v173, v201, v173
    v_mfma_f32_16x16x32_bf16 v[108:111], a[116:119], a[212:215], v[108:111]
    ds_read_b128 a[140:143], v216 offset:7168
    v_mul_f32 v174, v202, v174
    v_mul_f32 v175, v203, v175
    v_mfma_f32_16x16x32_bf16 v[92:95], a[116:119], a[208:211], v[92:95]
    buffer_load_dwordx4 a[148:151], v7, s[20:23], s43 offen offset:1024 sc1
    v_cvt_pk_bf16_f32 v158, v172, v173
    v_cvt_pk_bf16_f32 v159, v174, v175
    buffer_store_dwordx4 v[156:159], v1, s[20:23], s41 offen offset:1024 sc1
    s_waitcnt lgkmcnt(4)
    v_mfma_f32_16x16x32_bf16 v[96:99], a[120:123], a[208:211], v[96:99]
    ds_read_b128 a[112:115], v216 offset:8192
    v_accvgpr_read_b32 v204, a16
    v_accvgpr_read_b32 v205, a17
    v_mfma_f32_16x16x32_bf16 v[112:115], a[120:123], a[212:215], v[112:115]
    v_accvgpr_read_b32 v206, a18
    v_accvgpr_read_b32 v207, a19
    v_mfma_f32_16x16x32_bf16 v[116:119], a[124:127], a[212:215], v[116:119]
    ds_read_b128 a[116:119], v216 offset:9216
    v_mul_f32 v200, s36, v160
    v_mul_f32 v201, s36, v161
    v_mul_f32 v202, s36, v162
    v_mfma_f32_16x16x32_bf16 v[100:103], a[124:127], a[208:211], v[100:103]
    buffer_load_dwordx4 v9, s[72:75], s44 offen offset:2048 sc1 lds
    v_mul_f32 v203, s36, v163
    v_exp_f32 v200, v200
    v_exp_f32 v201, v201
    s_waitcnt lgkmcnt(4)
    v_mfma_f32_16x16x32_bf16 v[120:123], a[128:131], a[208:211], v[120:123]
    ds_read_b128 a[120:123], v216 offset:10240
    v_exp_f32 v202, v202
    v_exp_f32 v203, v203
    v_mul_f32 v160, v204, v160
    v_mfma_f32_16x16x32_bf16 v[136:139], a[128:131], a[212:215], v[136:139]
    v_mul_f32 v161, v205, v161
    v_mul_f32 v162, v206, v162
    v_mul_f32 v163, v207, v163
    v_mfma_f32_16x16x32_bf16 v[140:143], a[132:135], a[212:215], v[140:143]
    ds_read_b128 a[124:127], v216 offset:11264
    v_add_f32 v200, 1.0, v200
    v_add_f32 v201, 1.0, v201
    v_add_f32 v202, 1.0, v202
    v_mfma_f32_16x16x32_bf16 v[124:127], a[132:135], a[208:211], v[124:127]
    v_add_f32 v203, 1.0, v203
    v_rcp_f32 v200, v200
    v_rcp_f32 v201, v201
    s_waitcnt lgkmcnt(4)
    v_mfma_f32_16x16x32_bf16 v[128:131], a[136:139], a[208:211], v[128:131]
    ds_read_b128 a[128:131], v216 offset:12288
    v_rcp_f32 v202, v202
    v_rcp_f32 v203, v203
    v_mul_f32 v160, v200, v160
    v_mfma_f32_16x16x32_bf16 v[144:147], a[136:139], a[212:215], v[144:147]
    v_mul_f32 v161, v201, v161
    v_mul_f32 v162, v202, v162
    v_mul_f32 v163, v203, v163
    v_cvt_pk_bf16_f32 v160, v160, v161
    v_mfma_f32_16x16x32_bf16 v[148:151], a[140:143], a[212:215], v[148:151]
    ds_read_b128 a[132:135], v216 offset:13312
    v_cvt_pk_bf16_f32 v161, v162, v163
    v_accvgpr_read_b32 v204, a32
    v_mfma_f32_16x16x32_bf16 v[132:135], a[140:143], a[208:211], v[132:135]
    buffer_load_dwordx4 v9, s[72:75], s44 offen offset:3072 sc1 lds
    v_accvgpr_read_b32 v205, a33
    v_accvgpr_read_b32 v206, a34
    s_waitcnt vmcnt(24) lgkmcnt(4)
    v_mfma_f32_16x16x32_bf16 v[88:91], a[112:115], a[216:219], v[88:91]
    ds_read_b128 a[136:139], v216 offset:14336
    v_accvgpr_read_b32 v207, a35
    v_mul_f32 v200, s36, v176
    v_mul_f32 v201, s36, v177
    v_mfma_f32_16x16x32_bf16 v[104:107], a[112:115], a[220:223], v[104:107]
    buffer_load_dwordx4 a[152:155], v8, s[20:23], s43 offen offset:0 sc1
    v_mul_f32 v202, s36, v178
    v_mul_f32 v203, s36, v179
    v_exp_f32 v200, v200
    v_mfma_f32_16x16x32_bf16 v[108:111], a[116:119], a[220:223], v[108:111]
    ds_read_b128 a[140:143], v216 offset:15360
    v_exp_f32 v201, v201
    v_exp_f32 v202, v202
    v_mfma_f32_16x16x32_bf16 v[92:95], a[116:119], a[216:219], v[92:95]
    buffer_load_dwordx4 a[156:159], v8, s[20:23], s43 offen offset:1024 sc1
    v_exp_f32 v203, v203
    v_mul_f32 v176, v204, v176
    v_mul_f32 v177, v205, v177
    s_cmp_eq_u32 s48, 0
    s_cbranch_scc0 M_nc73
    s_waitcnt vmcnt(13)
    s_mov_b32 s91, 0
M_pc8:
    v_xor_b32 v14, s12, v18
    v_bfe_u32 v15, v19, 3, 1
    v_xor_b32 v15, 1, v15
    v_or_b32 v14, v14, v15
    v_cmp_ne_u32 vcc, 0, v14
    s_nop 3
    s_cmp_eq_u32 vcc_lo, 0
    s_cbranch_scc1 M_pc8_ok
    s_add_u32 s91, s91, 1
    s_cmp_ge_u32 s91, 0x40000
    s_cbranch_scc1 M_pc8_ok
    s_sleep 8
    buffer_load_dwordx2 v[18:19], v17, s[92:95], 0 offen sc1
    s_waitcnt vmcnt(0)
    s_branch M_pc8
M_pc8_ok:
M_nc73:
    s_waitcnt vmcnt(24) lgkmcnt(4)
    s_barrier
    v_mfma_f32_16x16x32_bf16 v[96:99], a[120:123], a[216:219], v[96:99]
    ds_read_b128 a[112:115], v216 offset:16384
    v_mul_f32 v178, v206, v178
    v_mul_f32 v179, v207, v179
    v_add_f32 v200, 1.0, v200
    v_mfma_f32_16x16x32_bf16 v[112:115], a[120:123], a[220:223], v[112:115]
    v_add_f32 v201, 1.0, v201
    v_add_f32 v202, 1.0, v202
    v_add_f32 v203, 1.0, v203
    v_rcp_f32 v200, v200
    v_mfma_f32_16x16x32_bf16 v[116:119], a[124:127], a[220:223], v[116:119]
    ds_read_b128 a[116:119], v216 offset:17408
    v_rcp_f32 v201, v201
    v_rcp_f32 v202, v202
    v_mfma_f32_16x16x32_bf16 v[100:103], a[124:127], a[216:219], v[100:103]
    s_mov_b32 s44, 0x240000
    s_add_u32 m0, s62, 0x8000
    s_nop 0
    buffer_load_dwordx4 v9, s[72:75], s44 offen offset:0 sc1 lds
    v_rcp_f32 v203, v203
    v_mul_f32 v176, v200, v176
    v_mul_f32 v177, v201, v177
    s_waitcnt lgkmcnt(4)
    v_mfma_f32_16x16x32_bf16 v[120:123], a[128:131], a[216:219], v[120:123]
    ds_read_b128 a[120:123], v216 offset:18432
    v_mul_f32 v178, v202, v178
    v_mul_f32 v179, v203, v179
    v_mfma_f32_16x16x32_bf16 v[136:139], a[128:131], a[220:223], v[136:139]
    v_cvt_pk_bf16_f32 v162, v176, v177
    v_cvt_pk_bf16_f32 v163, v178, v179
    buffer_store_dwordx4 v[160:163], v1, s[20:23], s41 offen offset:2048 sc1
    v_mfma_f32_16x16x32_bf16 v[140:143], a[132:135], a[220:223], v[140:143]
    ds_read_b128 a[124:127], v216 offset:19456
    v_accvgpr_read_b32 v204, a20
    v_accvgpr_read_b32 v205, a21
    v_mfma_f32_16x16x32_bf16 v[124:127], a[132:135], a[216:219], v[124:127]
    v_accvgpr_read_b32 v206, a22
    v_accvgpr_read_b32 v207, a23
    s_waitcnt lgkmcnt(4)
    v_mfma_f32_16x16x32_bf16 v[128:131], a[136:139], a[216:219], v[128:131]
    ds_read_b128 a[128:131], v216 offset:20480
    v_mul_f32 v200, s36, v164
    v_mul_f32 v201, s36, v165
    v_mul_f32 v202, s36, v166
    v_mfma_f32_16x16x32_bf16 v[144:147], a[136:139], a[220:223], v[144:147]
    v_mul_f32 v203, s36, v167
    v_exp_f32 v200, v200
    v_exp_f32 v201, v201
    v_mfma_f32_16x16x32_bf16 v[148:151], a[140:143], a[220:223], v[148:151]
    ds_read_b128 a[132:135], v216 offset:21504
    v_exp_f32 v202, v202
    v_exp_f32 v203, v203
    v_mul_f32 v164, v204, v164
    v_mul_f32 v165, v205, v165
    v_mfma_f32_16x16x32_bf16 v[132:135], a[140:143], a[216:219], v[132:135]
    buffer_load_dwordx4 v9, s[72:75], s44 offen offset:1024 sc1 lds
    v_mul_f32 v166, v206, v166
    v_mul_f32 v167, v207, v167
    v_add_f32 v200, 1.0, v200
    v_add_f32 v201, 1.0, v201
    s_waitcnt vmcnt(25) lgkmcnt(4)
    v_mfma_f32_16x16x32_bf16 v[88:91], a[112:115], a[224:227], v[88:91]
    ds_read_b128 a[136:139], v216 offset:22528
    v_add_f32 v202, 1.0, v202
    v_add_f32 v203, 1.0, v203
    v_mfma_f32_16x16x32_bf16 v[104:107], a[112:115], a[228:231], v[104:107]
    s_mov_b32 s43, 0x400000
    buffer_load_dwordx4 a[160:163], v7, s[20:23], s43 offen offset:0 sc1
    v_rcp_f32 v200, v200
    v_rcp_f32 v201, v201
    v_rcp_f32 v202, v202
    v_mfma_f32_16x16x32_bf16 v[108:111], a[116:119], a[228:231], v[108:111]
    ds_read_b128 a[140:143], v216 offset:23552
    v_rcp_f32 v203, v203
    v_mul_f32 v164, v200, v164
    v_mul_f32 v165, v201, v165
    v_mfma_f32_16x16x32_bf16 v[92:95], a[116:119], a[224:227], v[92:95]
    buffer_load_dwordx4 a[164:167], v7, s[20:23], s43 offen offset:1024 sc1
    v_mul_f32 v166, v202, v166
    v_mul_f32 v167, v203, v167
    v_cvt_pk_bf16_f32 v164, v164, v165
    s_waitcnt lgkmcnt(4)
    v_mfma_f32_16x16x32_bf16 v[96:99], a[120:123], a[224:227], v[96:99]
    ds_read_b128 a[112:115], v216 offset:24576
    v_cvt_pk_bf16_f32 v165, v166, v167
    v_accvgpr_read_b32 v204, a36
    v_mfma_f32_16x16x32_bf16 v[112:115], a[120:123], a[228:231], v[112:115]
    v_accvgpr_read_b32 v205, a37
    v_accvgpr_read_b32 v206, a38
    v_mfma_f32_16x16x32_bf16 v[116:119], a[124:127], a[228:231], v[116:119]
    ds_read_b128 a[116:119], v216 offset:25600
    v_accvgpr_read_b32 v207, a39
    v_mul_f32 v200, s36, v180
    v_mul_f32 v201, s36, v181
    v_mfma_f32_16x16x32_bf16 v[100:103], a[124:127], a[224:227], v[100:103]
    buffer_load_dwordx4 v9, s[72:75], s44 offen offset:2048 sc1 lds
    v_mul_f32 v202, s36, v182
    v_mul_f32 v203, s36, v183
    v_exp_f32 v200, v200
    s_waitcnt lgkmcnt(4)
    v_mfma_f32_16x16x32_bf16 v[120:123], a[128:131], a[224:227], v[120:123]
    ds_read_b128 a[120:123], v216 offset:26624
    v_exp_f32 v201, v201
    v_exp_f32 v202, v202
    v_mfma_f32_16x16x32_bf16 v[136:139], a[128:131], a[228:231], v[136:139]
    v_exp_f32 v203, v203
    v_mul_f32 v180, v204, v180
    v_mul_f32 v181, v205, v181
    v_mfma_f32_16x16x32_bf16 v[140:143], a[132:135], a[228:231], v[140:143]
    ds_read_b128 a[124:127], v216 offset:27648
    v_mul_f32 v182, v206, v182
    v_mul_f32 v183, v207, v183
    v_add_f32 v200, 1.0, v200
    v_mfma_f32_16x16x32_bf16 v[124:127], a[132:135], a[224:227], v[124:127]
    v_add_f32 v201, 1.0, v201
    v_add_f32 v202, 1.0, v202
    v_add_f32 v203, 1.0, v203
    v_rcp_f32 v200, v200
    s_waitcnt lgkmcnt(4)
    v_mfma_f32_16x16x32_bf16 v[128:131], a[136:139], a[224:227], v[128:131]
    ds_read_b128 a[128:131], v216 offset:28672
    v_rcp_f32 v201, v201
    v_rcp_f32 v202, v202
    v_mfma_f32_16x16x32_bf16 v[144:147], a[136:139], a[228:231], v[144:147]
    v_rcp_f32 v203, v203
    v_mul_f32 v180, v200, v180
    v_mul_f32 v181, v201, v181
    v_mfma_f32_16x16x32_bf16 v[148:151], a[140:143], a[228:231], v[148:151]
    ds_read_b128 a[132:135], v216 offset:29696
    v_mul_f32 v182, v202, v182
    v_mul_f32 v183, v203, v183
    v_cvt_pk_bf16_f32 v166, v180, v181
    v_mfma_f32_16x16x32_bf16 v[132:135], a[140:143], a[224:227], v[132:135]
    buffer_load_dwordx4 v9, s[72:75], s44 offen offset:3072 sc1 lds
    v_cvt_pk_bf16_f32 v167, v182, v183
    buffer_store_dwordx4 v[164:167], v1, s[20:23], s41 offen offset:3072 sc1
    s_add_u32 s41, s41, 4194304
    s_waitcnt vmcnt(27) lgkmcnt(4)
    v_mfma_f32_16x16x32_bf16 v[88:91], a[112:115], a[232:235], v[88:91]
    ds_read_b128 a[136:139], v216 offset:30720
    v_accvgpr_read_b32 v204, a40
    v_accvgpr_read_b32 v205, a41
    v_mfma_f32_16x16x32_bf16 v[104:107], a[112:115], a[236:239], v[104:107]
    buffer_load_dwordx4 a[168:171], v8, s[20:23], s43 offen offset:0 sc1
    v_accvgpr_read_b32 v206, a42
    v_accvgpr_read_b32 v207, a43
    v_mfma_f32_16x16x32_bf16 v[108:111], a[116:119], a[236:239], v[108:111]
    ds_read_b128 a[140:143], v216 offset:31744
    v_mul_f32 v200, s36, v184
    v_mul_f32 v201, s36, v185
    v_mul_f32 v202, s36, v186
    v_mfma_f32_16x16x32_bf16 v[92:95], a[116:119], a[232:235], v[92:95]
    buffer_load_dwordx4 a[172:175], v8, s[20:23], s43 offen offset:1024 sc1
    v_mul_f32 v203, s36, v187
    v_exp_f32 v200, v200
    v_exp_f32 v201, v201
    s_waitcnt lgkmcnt(4)
    v_mfma_f32_16x16x32_bf16 v[96:99], a[120:123], a[232:235], v[96:99]
    ds_read_b128 a[112:115], v216 offset:32768
    v_exp_f32 v202, v202
    v_exp_f32 v203, v203
    v_mul_f32 v184, v204, v184
    v_mfma_f32_16x16x32_bf16 v[112:115], a[120:123], a[236:239], v[112:115]
    v_mul_f32 v185, v205, v185
    v_mul_f32 v186, v206, v186
    v_mul_f32 v187, v207, v187
    v_mfma_f32_16x16x32_bf16 v[116:119], a[124:127], a[236:239], v[116:119]
    ds_read_b128 a[116:119], v216 offset:33792
    v_add_f32 v200, 1.0, v200
    v_add_f32 v201, 1.0, v201
    v_add_f32 v202, 1.0, v202
    v_mfma_f32_16x16x32_bf16 v[100:103], a[124:127], a[232:235], v[100:103]
    s_mov_b32 s44, 0x280000
    s_add_u32 m0, s62, 0xc000
    s_nop 0
    buffer_load_dwordx4 v9, s[72:75], s44 offen offset:0 sc1 lds
    v_add_f32 v203, 1.0, v203
    v_rcp_f32 v200, v200
    v_rcp_f32 v201, v201
    s_waitcnt lgkmcnt(4)
    v_mfma_f32_16x16x32_bf16 v[120:123], a[128:131], a[232:235], v[120:123]
    ds_read_b128 a[120:123], v216 offset:34816
    v_rcp_f32 v202, v202
    v_rcp_f32 v203, v203
    v_mul_f32 v184, v200, v184
    v_mfma_f32_16x16x32_bf16 v[136:139], a[128:131], a[236:239], v[136:139]
    v_mul_f32 v185, v201, v185
    v_mul_f32 v186, v202, v186
    v_mul_f32 v187, v203, v187
    v_mfma_f32_16x16x32_bf16 v[140:143], a[132:135], a[236:239], v[140:143]
    ds_read_b128 a[124:127], v216 offset:35840
    v_cvt_pk_bf16_f32 v184, v184, v185
    v_cvt_pk_bf16_f32 v185, v186, v187
    v_mfma_f32_16x16x32_bf16 v[124:127], a[132:135], a[232:235], v[124:127]
    v_accvgpr_read_b32 v204, a44
    v_accvgpr_read_b32 v205, a45
    s_waitcnt lgkmcnt(4)
    v_mfma_f32_16x16x32_bf16 v[128:131], a[136:139], a[232:235], v[128:131]
    ds_read_b128 a[128:131], v216 offset:36864
    v_accvgpr_read_b32 v206, a46
    v_accvgpr_read_b32 v207, a47
    v_mul_f32 v200, s36, v188
    v_mfma_f32_16x16x32_bf16 v[144:147], a[136:139], a[236:239], v[144:147]
    v_mul_f32 v201, s36, v189
    v_mul_f32 v202, s36, v190
    v_mul_f32 v203, s36, v191
    v_mfma_f32_16x16x32_bf16 v[148:151], a[140:143], a[236:239], v[148:151]
    ds_read_b128 a[132:135], v216 offset:37888
    v_exp_f32 v200, v200
    v_exp_f32 v201, v201
    v_mfma_f32_16x16x32_bf16 v[132:135], a[140:143], a[232:235], v[132:135]
    buffer_load_dwordx4 v9, s[72:75], s44 offen offset:1024 sc1 lds
    v_exp_f32 v202, v202
    v_exp_f32 v203, v203
    s_waitcnt vmcnt(26) lgkmcnt(4)
    v_mfma_f32_16x16x32_bf16 v[88:91], a[112:115], a[240:243], v[88:91]
    ds_read_b128 a[136:139], v216 offset:38912
    v_mul_f32 v188, v204, v188
    v_mul_f32 v189, v205, v189
    v_mul_f32 v190, v206, v190
    v_mul_f32 v191, v207, v191
    v_mfma_f32_16x16x32_bf16 v[104:107], a[112:115], a[244:247], v[104:107]
    s_mov_b32 s43, 0x480000
    buffer_load_dwordx4 a[176:179], v7, s[20:23], s43 offen offset:0 sc1
    v_add_f32 v200, 1.0, v200
    v_add_f32 v201, 1.0, v201
    v_add_f32 v202, 1.0, v202
    v_add_f32 v203, 1.0, v203
    v_mfma_f32_16x16x32_bf16 v[108:111], a[116:119], a[244:247], v[108:111]
    ds_read_b128 a[140:143], v216 offset:39936
    v_rcp_f32 v200, v200
    v_rcp_f32 v201, v201
    v_mfma_f32_16x16x32_bf16 v[92:95], a[116:119], a[240:243], v[92:95]
    buffer_load_dwordx4 a[180:183], v7, s[20:23], s43 offen offset:1024 sc1
    v_rcp_f32 v202, v202
    v_rcp_f32 v203, v203
    s_waitcnt lgkmcnt(4)
    v_mfma_f32_16x16x32_bf16 v[96:99], a[120:123], a[240:243], v[96:99]
    ds_read_b128 a[112:115], v216 offset:40960
    v_mul_f32 v188, v200, v188
    v_mul_f32 v189, v201, v189
    v_mul_f32 v190, v202, v190
    v_mfma_f32_16x16x32_bf16 v[112:115], a[120:123], a[244:247], v[112:115]
    v_mul_f32 v191, v203, v191
    v_cvt_pk_bf16_f32 v186, v188, v189
    v_cvt_pk_bf16_f32 v187, v190, v191
    v_mfma_f32_16x16x32_bf16 v[116:119], a[124:127], a[244:247], v[116:119]
    ds_read_b128 a[116:119], v216 offset:41984
    s_nop 1
    v_permlane16_swap_b32 v184, v186
    v_mfma_f32_16x16x32_bf16 v[100:103], a[124:127], a[240:243], v[100:103]
    buffer_load_dwordx4 v9, s[72:75], s44 offen offset:2048 sc1 lds
    v_permlane16_swap_b32 v185, v187
    buffer_store_dwordx4 v[184:187], v231, s[20:23], s42 offen offset:0 sc1
    s_waitcnt lgkmcnt(4)
    v_mfma_f32_16x16x32_bf16 v[120:123], a[128:131], a[240:243], v[120:123]
    ds_read_b128 a[120:123], v216 offset:43008
    v_accvgpr_read_b32 v204, a48
    v_accvgpr_read_b32 v205, a49
    v_mfma_f32_16x16x32_bf16 v[136:139], a[128:131], a[244:247], v[136:139]
    v_accvgpr_read_b32 v206, a50
    v_accvgpr_read_b32 v207, a51
    v_mfma_f32_16x16x32_bf16 v[140:143], a[132:135], a[244:247], v[140:143]
    ds_read_b128 a[124:127], v216 offset:44032
    v_mul_f32 v200, s36, v192
    v_mul_f32 v201, s36, v193
    v_mul_f32 v202, s36, v194
    v_mfma_f32_16x16x32_bf16 v[124:127], a[132:135], a[240:243], v[124:127]
    v_mul_f32 v203, s36, v195
    v_exp_f32 v200, v200
    v_exp_f32 v201, v201
    s_waitcnt lgkmcnt(4)
    v_mfma_f32_16x16x32_bf16 v[128:131], a[136:139], a[240:243], v[128:131]
    ds_read_b128 a[128:131], v216 offset:45056
    v_exp_f32 v202, v202
    v_exp_f32 v203, v203
    v_mul_f32 v192, v204, v192
    v_mfma_f32_16x16x32_bf16 v[144:147], a[136:139], a[244:247], v[144:147]
    v_mul_f32 v193, v205, v193
    v_mul_f32 v194, v206, v194
    v_mul_f32 v195, v207, v195
    v_mfma_f32_16x16x32_bf16 v[148:151], a[140:143], a[244:247], v[148:151]
    ds_read_b128 a[132:135], v216 offset:46080
    v_add_f32 v200, 1.0, v200
    v_add_f32 v201, 1.0, v201
    v_add_f32 v202, 1.0, v202
    v_mfma_f32_16x16x32_bf16 v[132:135], a[140:143], a[240:243], v[132:135]
    buffer_load_dwordx4 v9, s[72:75], s44 offen offset:3072 sc1 lds
    v_add_f32 v203, 1.0, v203
    v_rcp_f32 v200, v200
    v_rcp_f32 v201, v201
    s_waitcnt vmcnt(26) lgkmcnt(4)
    v_mfma_f32_16x16x32_bf16 v[88:91], a[112:115], a[248:251], v[88:91]
    ds_read_b128 a[136:139], v216 offset:47104
    v_rcp_f32 v202, v202
    v_rcp_f32 v203, v203
    v_mul_f32 v192, v200, v192
    v_mfma_f32_16x16x32_bf16 v[104:107], a[112:115], a[252:255], v[104:107]
    buffer_load_dwordx4 a[184:187], v8, s[20:23], s43 offen offset:0 sc1
    v_mul_f32 v193, v201, v193
    v_mul_f32 v194, v202, v194
    v_mul_f32 v195, v203, v195
    v_mfma_f32_16x16x32_bf16 v[108:111], a[116:119], a[252:255], v[108:111]
    ds_read_b128 a[140:143], v216 offset:48128
    v_cvt_pk_bf16_f32 v192, v192, v193
    v_cvt_pk_bf16_f32 v193, v194, v195
    v_mfma_f32_16x16x32_bf16 v[92:95], a[116:119], a[248:251], v[92:95]
    buffer_load_dwordx4 a[188:191], v8, s[20:23], s43 offen offset:1024 sc1
    v_accvgpr_read_b32 v204, a52
    v_accvgpr_read_b32 v205, a53
    s_waitcnt vmcnt(11) lgkmcnt(4)
    s_barrier
    s_cmp_eq_u32 s48, 0
    s_cbranch_scc0 M_fs9
    v_mov_b32 v14, s12
    v_mov_b32 v15, 47
    s_mov_b64 exec, 1
    buffer_store_dwordx2 v[14:15], off, s[92:95], s90 sc1
    s_mov_b64 exec, -1
M_fs9:
    v_mfma_f32_16x16x32_bf16 v[96:99], a[120:123], a[248:251], v[96:99]
    ds_read_b128 a[112:115], v13 offset:0
    v_accvgpr_read_b32 v206, a54
    v_accvgpr_read_b32 v207, a55
    v_mul_f32 v200, s36, v196
    v_mfma_f32_16x16x32_bf16 v[112:115], a[120:123], a[252:255], v[112:115]
    v_mul_f32 v201, s36, v197
    v_mul_f32 v202, s36, v198
    v_mul_f32 v203, s36, v199
    v_mfma_f32_16x16x32_bf16 v[116:119], a[124:127], a[252:255], v[116:119]
    ds_read_b128 a[116:119], v13 offset:1024
    v_exp_f32 v200, v200
    v_exp_f32 v201, v201
    v_mfma_f32_16x16x32_bf16 v[100:103], a[124:127], a[248:251], v[100:103]
    s_mov_b32 s44, 0x2c0000
    s_add_u32 m0, s62, 0x10000
    s_nop 0
    buffer_load_dwordx4 v9, s[72:75], s44 offen offset:0 sc1 lds
    v_exp_f32 v202, v202
    v_exp_f32 v203, v203
    s_waitcnt lgkmcnt(4)
    v_mfma_f32_16x16x32_bf16 v[120:123], a[128:131], a[248:251], v[120:123]
    ds_read_b128 a[120:123], v13 offset:2048
    v_mul_f32 v196, v204, v196
    v_mul_f32 v197, v205, v197
    v_mul_f32 v198, v206, v198
    v_mul_f32 v199, v207, v199
    v_mfma_f32_16x16x32_bf16 v[136:139], a[128:131], a[252:255], v[136:139]
    v_add_f32 v200, 1.0, v200
    v_add_f32 v201, 1.0, v201
    v_add_f32 v202, 1.0, v202
    v_add_f32 v203, 1.0, v203
    v_mfma_f32_16x16x32_bf16 v[140:143], a[132:135], a[252:255], v[140:143]
    ds_read_b128 a[124:127], v13 offset:3072
    v_rcp_f32 v200, v200
    v_rcp_f32 v201, v201
    v_mfma_f32_16x16x32_bf16 v[124:127], a[132:135], a[248:251], v[124:127]
    v_rcp_f32 v202, v202
    v_rcp_f32 v203, v203
    s_waitcnt lgkmcnt(4)
    v_mfma_f32_16x16x32_bf16 v[128:131], a[136:139], a[248:251], v[128:131]
    ds_read_b128 a[128:131], v13 offset:4096
    v_mul_f32 v196, v200, v196
    v_mul_f32 v197, v201, v197
    v_mul_f32 v198, v202, v198
    v_mfma_f32_16x16x32_bf16 v[144:147], a[136:139], a[252:255], v[144:147]
    v_mul_f32 v199, v203, v199
    v_cvt_pk_bf16_f32 v194, v196, v197
    v_cvt_pk_bf16_f32 v195, v198, v199
    v_mfma_f32_16x16x32_bf16 v[148:151], a[140:143], a[252:255], v[148:151]
    ds_read_b128 a[132:135], v13 offset:5120
    s_nop 1
    v_permlane16_swap_b32 v192, v194
    v_mfma_f32_16x16x32_bf16 v[132:135], a[140:143], a[248:251], v[132:135]
    buffer_load_dwordx4 v9, s[72:75], s44 offen offset:1024 sc1 lds
    v_permlane16_swap_b32 v193, v195
    buffer_store_dwordx4 v[192:195], v231, s[20:23], s42 offen offset:2048 sc1
    s_waitcnt lgkmcnt(4)
    v_mfma_f32_16x16x32_bf16 v[88:91], a[112:115], a[144:147], v[88:91]
    ds_read_b128 a[136:139], v13 offset:6144
    v_mfma_f32_16x16x32_bf16 v[104:107], a[112:115], a[148:151], v[104:107]
    s_mov_b32 s43, 0x500000
    buffer_load_dwordx4 a[192:195], v7, s[20:23], s43 offen offset:0 sc1
    v_mfma_f32_16x16x32_bf16 v[108:111], a[116:119], a[148:151], v[108:111]
    ds_read_b128 a[140:143], v13 offset:7168
    v_mfma_f32_16x16x32_bf16 v[92:95], a[116:119], a[144:147], v[92:95]
    buffer_load_dwordx4 a[196:199], v7, s[20:23], s43 offen offset:1024 sc1
    s_waitcnt lgkmcnt(4)
    v_mfma_f32_16x16x32_bf16 v[96:99], a[120:123], a[144:147], v[96:99]
    ds_read_b128 a[112:115], v13 offset:8192
    v_mfma_f32_16x16x32_bf16 v[112:115], a[120:123], a[148:151], v[112:115]
    v_mfma_f32_16x16x32_bf16 v[116:119], a[124:127], a[148:151], v[116:119]
    ds_read_b128 a[116:119], v13 offset:9216
    v_mfma_f32_16x16x32_bf16 v[100:103], a[124:127], a[144:147], v[100:103]
    buffer_load_dwordx4 v9, s[72:75], s44 offen offset:2048 sc1 lds
    s_waitcnt lgkmcnt(4)
    v_mfma_f32_16x16x32_bf16 v[120:123], a[128:131], a[144:147], v[120:123]
    ds_read_b128 a[120:123], v13 offset:10240
    v_mfma_f32_16x16x32_bf16 v[136:139], a[128:131], a[148:151], v[136:139]
    v_mfma_f32_16x16x32_bf16 v[140:143], a[132:135], a[148:151], v[140:143]
    ds_read_b128 a[124:127], v13 offset:11264
    v_mfma_f32_16x16x32_bf16 v[124:127], a[132:135], a[144:147], v[124:127]
    s_waitcnt lgkmcnt(4)
    v_mfma_f32_16x16x32_bf16 v[128:131], a[136:139], a[144:147], v[128:131]
    ds_read_b128 a[128:131], v13 offset:12288
    v_mfma_f32_16x16x32_bf16 v[144:147], a[136:139], a[148:151], v[144:147]
    v_mfma_f32_16x16x32_bf16 v[148:151], a[140:143], a[148:151], v[148:151]
    ds_read_b128 a[132:135], v13 offset:13312
    v_mfma_f32_16x16x32_bf16 v[132:135], a[140:143], a[144:147], v[132:135]
    buffer_load_dwordx4 v9, s[72:75], s44 offen offset:3072 sc1 lds
    s_waitcnt lgkmcnt(4)
    v_mfma_f32_16x16x32_bf16 v[88:91], a[112:115], a[152:155], v[88:91]
    ds_read_b128 a[136:139], v13 offset:14336
    v_mfma_f32_16x16x32_bf16 v[104:107], a[112:115], a[156:159], v[104:107]
    buffer_load_dwordx4 a[200:203], v8, s[20:23], s43 offen offset:0 sc1
    v_mfma_f32_16x16x32_bf16 v[108:111], a[116:119], a[156:159], v[108:111]
    ds_read_b128 a[140:143], v13 offset:15360
    v_mfma_f32_16x16x32_bf16 v[92:95], a[116:119], a[152:155], v[92:95]
    buffer_load_dwordx4 a[204:207], v8, s[20:23], s43 offen offset:1024 sc1
    s_waitcnt lgkmcnt(4)
    v_mfma_f32_16x16x32_bf16 v[96:99], a[120:123], a[152:155], v[96:99]
    ds_read_b128 a[112:115], v13 offset:16384
    v_mfma_f32_16x16x32_bf16 v[112:115], a[120:123], a[156:159], v[112:115]
    v_mfma_f32_16x16x32_bf16 v[116:119], a[124:127], a[156:159], v[116:119]
    ds_read_b128 a[116:119], v13 offset:17408
    v_mfma_f32_16x16x32_bf16 v[100:103], a[124:127], a[152:155], v[100:103]
    s_mov_b32 s44, 0x300000
    s_add_u32 m0, s62, 0x14000
    s_nop 0
    buffer_load_dwordx4 v9, s[72:75], s44 offen offset:0 sc1 lds
    s_waitcnt lgkmcnt(4)
    v_mfma_f32_16x16x32_bf16 v[120:123], a[128:131], a[152:155], v[120:123]
    ds_read_b128 a[120:123], v13 offset:18432
    v_mfma_f32_16x16x32_bf16 v[136:139], a[128:131], a[156:159], v[136:139]
    v_mfma_f32_16x16x32_bf16 v[140:143], a[132:135], a[156:159], v[140:143]
    ds_read_b128 a[124:127], v13 offset:19456
    v_mfma_f32_16x16x32_bf16 v[124:127], a[132:135], a[152:155], v[124:127]
    s_waitcnt lgkmcnt(4)
    v_mfma_f32_16x16x32_bf16 v[128:131], a[136:139], a[152:155], v[128:131]
    ds_read_b128 a[128:131], v13 offset:20480
    v_mfma_f32_16x16x32_bf16 v[144:147], a[136:139], a[156:159], v[144:147]
    v_mfma_f32_16x16x32_bf16 v[148:151], a[140:143], a[156:159], v[148:151]
    ds_read_b128 a[132:135], v13 offset:21504
    v_mfma_f32_16x16x32_bf16 v[132:135], a[140:143], a[152:155], v[132:135]
    buffer_load_dwordx4 v9, s[72:75], s44 offen offset:1024 sc1 lds
    s_waitcnt lgkmcnt(4)
    v_mfma_f32_16x16x32_bf16 v[88:91], a[112:115], a[160:163], v[88:91]
    ds_read_b128 a[136:139], v13 offset:22528
    v_mfma_f32_16x16x32_bf16 v[104:107], a[112:115], a[164:167], v[104:107]
    s_mov_b32 s43, 0x580000
    buffer_load_dwordx4 a[208:211], v7, s[20:23], s43 offen offset:0 sc1
    v_and_b32 v212, 15, v0
    v_mfma_f32_16x16x32_bf16 v[108:111], a[116:119], a[164:167], v[108:111]
    ds_read_b128 a[140:143], v13 offset:23552
    v_lshrrev_b32 v213, 4, v0
    v_mfma_f32_16x16x32_bf16 v[92:95], a[116:119], a[160:163], v[92:95]
    buffer_load_dwordx4 a[212:215], v7, s[20:23], s43 offen offset:1024 sc1
    v_and_b32 v214, 7, v0
    s_waitcnt lgkmcnt(4)
    v_mfma_f32_16x16x32_bf16 v[96:99], a[120:123], a[160:163], v[96:99]
    ds_read_b128 a[112:115], v13 offset:24576
    v_mfma_f32_16x16x32_bf16 v[112:115], a[120:123], a[164:167], v[112:115]
    v_xor_b32 v213, v213, v214
    v_mfma_f32_16x16x32_bf16 v[116:119], a[124:127], a[164:167], v[116:119]
    ds_read_b128 a[116:119], v13 offset:25600
    v_lshlrev_b32 v213, 4, v213
    v_mfma_f32_16x16x32_bf16 v[100:103], a[124:127], a[160:163], v[100:103]
    buffer_load_dwordx4 v9, s[72:75], s44 offen offset:2048 sc1 lds
    v_lshl_add_u32 v217, v212, 7, v213
    s_waitcnt lgkmcnt(4)
    v_mfma_f32_16x16x32_bf16 v[120:123], a[128:131], a[160:163], v[120:123]
    ds_read_b128 a[120:123], v13 offset:26624
    v_mfma_f32_16x16x32_bf16 v[136:139], a[128:131], a[164:167], v[136:139]
    v_lshrrev_b32 v212, 3, v0
    v_mfma_f32_16x16x32_bf16 v[140:143], a[132:135], a[164:167], v[140:143]
    ds_read_b128 a[124:127], v13 offset:27648
    v_xor_b32 v214, v214, v212
    v_mfma_f32_16x16x32_bf16 v[124:127], a[132:135], a[160:163], v[124:127]
    v_lshlrev_b32 v212, 11, v212
    s_waitcnt lgkmcnt(4)
    v_mfma_f32_16x16x32_bf16 v[128:131], a[136:139], a[160:163], v[128:131]
    ds_read_b128 a[128:131], v13 offset:28672
    v_mfma_f32_16x16x32_bf16 v[144:147], a[136:139], a[164:167], v[144:147]
    v_lshl_add_u32 v224, v214, 4, v212
    v_mfma_f32_16x16x32_bf16 v[148:151], a[140:143], a[164:167], v[148:151]
    ds_read_b128 a[132:135], v13 offset:29696
    s_lshl_b32 s64, s68, 18
    v_mfma_f32_16x16x32_bf16 v[132:135], a[140:143], a[160:163], v[132:135]
    buffer_load_dwordx4 v9, s[72:75], s44 offen offset:3072 sc1 lds
    s_lshl_b32 s67, s48, 16
    s_waitcnt vmcnt(24) lgkmcnt(4)
    v_mfma_f32_16x16x32_bf16 v[88:91], a[112:115], a[168:171], v[88:91]
    ds_read_b128 a[136:139], v13 offset:30720
    v_mfma_f32_16x16x32_bf16 v[104:107], a[112:115], a[172:175], v[104:107]
    buffer_load_dwordx4 a[216:219], v8, s[20:23], s43 offen offset:0 sc1
    s_add_u32 s64, s64, s67
    v_mfma_f32_16x16x32_bf16 v[108:111], a[116:119], a[172:175], v[108:111]
    ds_read_b128 a[140:143], v13 offset:31744
    s_lshl_b32 s67, s69, 7
    v_mfma_f32_16x16x32_bf16 v[92:95], a[116:119], a[168:171], v[92:95]
    buffer_load_dwordx4 a[220:223], v8, s[20:23], s43 offen offset:1024 sc1
    s_add_u32 s64, s64, s67
    s_waitcnt vmcnt(14) lgkmcnt(4)
    s_barrier
    s_cmp_eq_u32 s48, 0
    s_cbranch_scc0 M_fs10
    v_mov_b32 v14, s12
    v_mov_b32 v15, 63
    s_mov_b64 exec, 1
    buffer_store_dwordx2 v[14:15], off, s[92:95], s90 sc1
    s_mov_b64 exec, -1
M_fs10:
    v_mfma_f32_16x16x32_bf16 v[96:99], a[120:123], a[168:171], v[96:99]
    ds_read_b128 a[112:115], v13 offset:32768
    v_mfma_f32_16x16x32_bf16 v[112:115], a[120:123], a[172:175], v[112:115]
    v_add_u32 v224, s64, v224
    v_mfma_f32_16x16x32_bf16 v[116:119], a[124:127], a[172:175], v[116:119]
    ds_read_b128 a[116:119], v13 offset:33792
    s_add_u32 s64, s62, 146432
    v_mfma_f32_16x16x32_bf16 v[100:103], a[124:127], a[168:171], v[100:103]
    s_mov_b32 s44, 0x340000
    s_add_u32 m0, s62, 0x18000
    s_nop 0
    buffer_load_dwordx4 v9, s[72:75], s44 offen offset:0 sc1 lds
    v_add_u32 v217, s64, v217
    s_waitcnt lgkmcnt(4)
    v_mfma_f32_16x16x32_bf16 v[120:123], a[128:131], a[168:171], v[120:123]
    ds_read_b128 a[120:123], v13 offset:34816
    v_mfma_f32_16x16x32_bf16 v[136:139], a[128:131], a[172:175], v[136:139]
    v_xor_b32 v218, 64, v217
    v_mfma_f32_16x16x32_bf16 v[140:143], a[132:135], a[172:175], v[140:143]
    ds_read_b128 a[124:127], v13 offset:35840
    v_add_u32 v219, s64, v13
    v_mfma_f32_16x16x32_bf16 v[124:127], a[132:135], a[168:171], v[124:127]
    s_lshr_b32 s64, s48, 1
    s_waitcnt lgkmcnt(4)
    v_mfma_f32_16x16x32_bf16 v[128:131], a[136:139], a[168:171], v[128:131]
    ds_read_b128 a[128:131], v13 offset:36864
    v_mfma_f32_16x16x32_bf16 v[144:147], a[136:139], a[172:175], v[144:147]
    s_add_u32 s64, s64, s48
    v_mfma_f32_16x16x32_bf16 v[148:151], a[140:143], a[172:175], v[148:151]
    ds_read_b128 a[132:135], v13 offset:37888
    s_lshl_b32 s64, s64, 10
    v_mfma_f32_16x16x32_bf16 v[132:135], a[140:143], a[168:171], v[132:135]
    buffer_load_dwordx4 v9, s[72:75], s44 offen offset:1024 sc1 lds
    s_mul_i32 s67, s49, 49152
    s_waitcnt lgkmcnt(4)
    v_mfma_f32_16x16x32_bf16 v[88:91], a[112:115], a[176:179], v[88:91]
    ds_read_b128 a[136:139], v13 offset:38912
    v_mfma_f32_16x16x32_bf16 v[104:107], a[112:115], a[180:183], v[104:107]
    s_mov_b32 s43, 0x600000
    buffer_load_dwordx4 a[224:227], v7, s[20:23], s43 offen offset:0 sc1
    s_add_u32 s64, s64, s67
    v_mfma_f32_16x16x32_bf16 v[108:111], a[116:119], a[180:183], v[108:111]
    ds_read_b128 a[140:143], v13 offset:39936
    v_add_u32 v225, s64, v13
    v_mfma_f32_16x16x32_bf16 v[92:95], a[116:119], a[176:179], v[92:95]
    buffer_load_dwordx4 a[228:231], v7, s[20:23], s43 offen offset:1024 sc1
    v_and_b32 v212, 7, v0
    s_waitcnt lgkmcnt(4)
    v_mfma_f32_16x16x32_bf16 v[96:99], a[120:123], a[176:179], v[96:99]
    ds_read_b128 a[112:115], v13 offset:40960
    v_mfma_f32_16x16x32_bf16 v[112:115], a[120:123], a[180:183], v[112:115]
    v_mul_u32_u24 v226, 6144, v212
    v_mfma_f32_16x16x32_bf16 v[116:119], a[124:127], a[180:183], v[116:119]
    ds_read_b128 a[116:119], v13 offset:41984
    v_bfe_u32 v212, v0, 3, 2
    v_mfma_f32_16x16x32_bf16 v[100:103], a[124:127], a[176:179], v[100:103]
    buffer_load_dwordx4 v9, s[72:75], s44 offen offset:2048 sc1 lds
    v_lshl_add_u32 v226, v212, 8, v226
    s_waitcnt lgkmcnt(4)
    v_mfma_f32_16x16x32_bf16 v[120:123], a[128:131], a[176:179], v[120:123]
    ds_read_b128 a[120:123], v13 offset:43008
    v_mfma_f32_16x16x32_bf16 v[136:139], a[128:131], a[180:183], v[136:139]
    v_lshrrev_b32 v212, 5, v0
    v_mfma_f32_16x16x32_bf16 v[140:143], a[132:135], a[180:183], v[140:143]
    ds_read_b128 a[124:127], v13 offset:44032
    v_mul_u32_u24 v212, 3072, v212
    v_mfma_f32_16x16x32_bf16 v[124:127], a[132:135], a[176:179], v[124:127]
    v_add3_u32 v226, v226, v212, s67
    s_waitcnt lgkmcnt(4)
    v_mfma_f32_16x16x32_bf16 v[128:131], a[136:139], a[176:179], v[128:131]
    ds_read_b128 a[128:131], v13 offset:45056
    v_mfma_f32_16x16x32_bf16 v[144:147], a[136:139], a[180:183], v[144:147]
    s_and_b32 s64, s48, 1
    v_mfma_f32_16x16x32_bf16 v[148:151], a[140:143], a[180:183], v[148:151]
    ds_read_b128 a[132:135], v13 offset:46080
    s_lshl_b32 s64, s64, 10
    v_mfma_f32_16x16x32_bf16 v[132:135], a[140:143], a[176:179], v[132:135]
    buffer_load_dwordx4 v9, s[72:75], s44 offen offset:3072 sc1 lds
    s_lshr_b32 s67, s48, 1
    s_waitcnt lgkmcnt(4)
    v_mfma_f32_16x16x32_bf16 v[88:91], a[112:115], a[184:187], v[88:91]
    ds_read_b128 a[136:139], v13 offset:47104
    v_mfma_f32_16x16x32_bf16 v[104:107], a[112:115], a[188:191], v[104:107]
    buffer_load_dwordx4 a[232:235], v8, s[20:23], s43 offen offset:0 sc1
    s_lshl_b32 s67, s67, 3
    v_mfma_f32_16x16x32_bf16 v[108:111], a[116:119], a[188:191], v[108:111]
    ds_read_b128 a[140:143], v13 offset:48128
    s_add_u32 s64, s64, s67
    v_mfma_f32_16x16x32_bf16 v[92:95], a[116:119], a[184:187], v[92:95]
    buffer_load_dwordx4 a[236:239], v8, s[20:23], s43 offen offset:1024 sc1
    s_add_u32 s64, s64, 141312
    s_waitcnt lgkmcnt(4)
    v_mfma_f32_16x16x32_bf16 v[96:99], a[120:123], a[184:187], v[96:99]
    ds_read_b128 a[112:115], v13 offset:49152
    v_mfma_f32_16x16x32_bf16 v[112:115], a[120:123], a[188:191], v[112:115]
    v_add_u32 v227, s64, v13
    v_mfma_f32_16x16x32_bf16 v[116:119], a[124:127], a[188:191], v[116:119]
    ds_read_b128 a[116:119], v13 offset:50176
    v_bfe_u32 v212, v0, 3, 2
    v_mfma_f32_16x16x32_bf16 v[100:103], a[124:127], a[184:187], v[100:103]
    s_mov_b32 s44, 0x380000
    s_add_u32 m0, s62, 0x0
    s_nop 0
    buffer_load_dwordx4 v9, s[72:75], s44 offen offset:0 sc1 lds
    v_lshlrev_b32 v212, 4, v212
    s_waitcnt lgkmcnt(4)
    v_mfma_f32_16x16x32_bf16 v[120:123], a[128:131], a[184:187], v[120:123]
    ds_read_b128 a[120:123], v13 offset:51200
    v_mfma_f32_16x16x32_bf16 v[136:139], a[128:131], a[188:191], v[136:139]
    v_lshrrev_b32 v213, 5, v0
    v_mfma_f32_16x16x32_bf16 v[140:143], a[132:135], a[188:191], v[140:143]
    ds_read_b128 a[124:127], v13 offset:52224
    v_lshl_add_u32 v212, v213, 3, v212
    v_mfma_f32_16x16x32_bf16 v[124:127], a[132:135], a[184:187], v[124:127]
    v_add_u32 v228, 143360, v212
    s_waitcnt lgkmcnt(4)
    v_mfma_f32_16x16x32_bf16 v[128:131], a[136:139], a[184:187], v[128:131]
    ds_read_b128 a[128:131], v13 offset:53248
    v_mfma_f32_16x16x32_bf16 v[144:147], a[136:139], a[188:191], v[144:147]
    v_and_b32 v212, 48, v0
    v_mfma_f32_16x16x32_bf16 v[148:151], a[140:143], a[188:191], v[148:151]
    ds_read_b128 a[132:135], v13 offset:54272
    v_add_u32 v229, 143360, v212
    v_mfma_f32_16x16x32_bf16 v[132:135], a[140:143], a[184:187], v[132:135]
    buffer_load_dwordx4 v9, s[72:75], s44 offen offset:1024 sc1 lds
    v_add_u32 v230, 141312, v13
    s_waitcnt vmcnt(22) lgkmcnt(4)
    v_mfma_f32_16x16x32_bf16 v[88:91], a[112:115], a[192:195], v[88:91]
    ds_read_b128 a[136:139], v13 offset:55296
    v_mfma_f32_16x16x32_bf16 v[104:107], a[112:115], a[196:199], v[104:107]
    s_mov_b32 s43, 0x680000
    buffer_load_dwordx4 a[240:243], v7, s[20:23], s43 offen offset:0 sc1
    v_accvgpr_read_b32 v200, a56
    v_mfma_f32_16x16x32_bf16 v[108:111], a[116:119], a[196:199], v[108:111]
    ds_read_b128 a[140:143], v13 offset:56320
    v_accvgpr_read_b32 v201, a57
    v_mfma_f32_16x16x32_bf16 v[92:95], a[116:119], a[192:195], v[92:95]
    buffer_load_dwordx4 a[244:247], v7, s[20:23], s43 offen offset:1024 sc1
    v_accvgpr_read_b32 v202, a58
    s_waitcnt lgkmcnt(4)
    v_mfma_f32_16x16x32_bf16 v[96:99], a[120:123], a[192:195], v[96:99]
    ds_read_b128 a[112:115], v13 offset:57344
    v_accvgpr_read_b32 v203, a59
    v_mfma_f32_16x16x32_bf16 v[112:115], a[120:123], a[196:199], v[112:115]
    v_mul_f32 v204, s38, v200
    v_mul_f32 v205, s38, v201
    v_mfma_f32_16x16x32_bf16 v[116:119], a[124:127], a[196:199], v[116:119]
    ds_read_b128 a[116:119], v13 offset:58368
    v_mul_f32 v206, s38, v202
    v_mfma_f32_16x16x32_bf16 v[100:103], a[124:127], a[192:195], v[100:103]
    buffer_load_dwordx4 v9, s[72:75], s44 offen offset:2048 sc1 lds
    v_mul_f32 v207, s38, v203
    v_exp_f32_e64 v204, v204 clamp
    s_waitcnt lgkmcnt(4)
    v_mfma_f32_16x16x32_bf16 v[120:123], a[128:131], a[192:195], v[120:123]
    ds_read_b128 a[120:123], v13 offset:59392
    v_exp_f32_e64 v205, v205 clamp
    v_mfma_f32_16x16x32_bf16 v[136:139], a[128:131], a[196:199], v[136:139]
    v_exp_f32_e64 v206, v206 clamp
    v_mfma_f32_16x16x32_bf16 v[140:143], a[132:135], a[196:199], v[140:143]
    ds_read_b128 a[124:127], v13 offset:60416
    v_mfma_f32_16x16x32_bf16 v[124:127], a[132:135], a[192:195], v[124:127]
    v_exp_f32_e64 v207, v207 clamp
    s_waitcnt lgkmcnt(4)
    v_mfma_f32_16x16x32_bf16 v[128:131], a[136:139], a[192:195], v[128:131]
    ds_read_b128 a[128:131], v13 offset:61440
    v_max_f32 v200, s40, v200
    v_mfma_f32_16x16x32_bf16 v[144:147], a[136:139], a[196:199], v[144:147]
    v_max_f32 v201, s40, v201
    v_mfma_f32_16x16x32_bf16 v[148:151], a[140:143], a[196:199], v[148:151]
    ds_read_b128 a[132:135], v13 offset:62464
    v_max_f32 v202, s40, v202
    v_mfma_f32_16x16x32_bf16 v[132:135], a[140:143], a[192:195], v[132:135]
    buffer_load_dwordx4 v9, s[72:75], s44 offen offset:3072 sc1 lds
    v_max_f32 v203, s40, v203
    s_waitcnt vmcnt(22) lgkmcnt(4)
    v_mfma_f32_16x16x32_bf16 v[88:91], a[112:115], a[200:203], v[88:91]
    ds_read_b128 a[136:139], v13 offset:63488
    v_add_f32 v200, v204, v200
    v_add_f32 v201, v205, v201
    v_mfma_f32_16x16x32_bf16 v[104:107], a[112:115], a[204:207], v[104:107]
    buffer_load_dwordx4 a[248:251], v8, s[20:23], s43 offen offset:0 sc1
    v_add_f32 v202, v206, v202
    v_add_f32 v203, v207, v203
    v_mfma_f32_16x16x32_bf16 v[108:111], a[116:119], a[204:207], v[108:111]
    ds_read_b128 a[140:143], v13 offset:64512
    v_cvt_pk_bf16_f32 v240, v200, v201
    v_mfma_f32_16x16x32_bf16 v[92:95], a[116:119], a[200:203], v[92:95]
    buffer_load_dwordx4 a[252:255], v8, s[20:23], s43 offen offset:1024 sc1
    v_cvt_pk_bf16_f32 v241, v202, v203
    s_waitcnt vmcnt(18) lgkmcnt(4)
    s_barrier
    v_mfma_f32_16x16x32_bf16 v[96:99], a[120:123], a[200:203], v[96:99]
    ds_read_b128 a[112:115], v216 offset:0
    v_mfma_f32_16x16x32_bf16 v[112:115], a[120:123], a[204:207], v[112:115]
    v_accvgpr_read_b32 v200, a72
    v_mfma_f32_16x16x32_bf16 v[116:119], a[124:127], a[204:207], v[116:119]
    ds_read_b128 a[116:119], v216 offset:1024
    v_accvgpr_read_b32 v201, a73
    v_mfma_f32_16x16x32_bf16 v[100:103], a[124:127], a[200:203], v[100:103]
    s_mov_b32 s44, 0x3c0000
    s_add_u32 m0, s62, 0x4000
    s_nop 0
    buffer_load_dwordx4 v9, s[72:75], s44 offen offset:0 sc1 lds
    v_accvgpr_read_b32 v202, a74
    s_waitcnt lgkmcnt(4)
    v_mfma_f32_16x16x32_bf16 v[120:123], a[128:131], a[200:203], v[120:123]
    ds_read_b128 a[120:123], v216 offset:2048
    v_accvgpr_read_b32 v203, a75
    v_mfma_f32_16x16x32_bf16 v[136:139], a[128:131], a[204:207], v[136:139]
    v_mul_f32 v204, s38, v200
    v_mul_f32 v205, s38, v201
    v_mfma_f32_16x16x32_bf16 v[140:143], a[132:135], a[204:207], v[140:143]
    ds_read_b128 a[124:127], v216 offset:3072
    v_mul_f32 v206, s38, v202
    v_mfma_f32_16x16x32_bf16 v[124:127], a[132:135], a[200:203], v[124:127]
    v_mul_f32 v207, s38, v203
    v_exp_f32_e64 v204, v204 clamp
    s_waitcnt lgkmcnt(4)
    v_mfma_f32_16x16x32_bf16 v[128:131], a[136:139], a[200:203], v[128:131]
    ds_read_b128 a[128:131], v216 offset:4096
    v_exp_f32_e64 v205, v205 clamp
    v_mfma_f32_16x16x32_bf16 v[144:147], a[136:139], a[204:207], v[144:147]
    v_exp_f32_e64 v206, v206 clamp
    v_mfma_f32_16x16x32_bf16 v[148:151], a[140:143], a[204:207], v[148:151]
    ds_read_b128 a[132:135], v216 offset:5120
    v_mfma_f32_16x16x32_bf16 v[132:135], a[140:143], a[200:203], v[132:135]
    buffer_load_dwordx4 v9, s[72:75], s44 offen offset:1024 sc1 lds
    v_exp_f32_e64 v207, v207 clamp
    s_waitcnt lgkmcnt(4)
    v_mfma_f32_16x16x32_bf16 v[88:91], a[112:115], a[208:211], v[88:91]
    ds_read_b128 a[136:139], v216 offset:6144
    v_max_f32 v200, s40, v200
    v_mfma_f32_16x16x32_bf16 v[104:107], a[112:115], a[212:215], v[104:107]
    s_mov_b32 s43, 0x700000
    buffer_load_dwordx4 a[144:147], v7, s[20:23], s43 offen offset:0 sc1
    v_max_f32 v201, s40, v201
    v_mfma_f32_16x16x32_bf16 v[108:111], a[116:119], a[212:215], v[108:111]
    ds_read_b128 a[140:143], v216 offset:7168
    v_max_f32 v202, s40, v202
    v_mfma_f32_16x16x32_bf16 v[92:95], a[116:119], a[208:211], v[92:95]
    buffer_load_dwordx4 a[148:151], v7, s[20:23], s43 offen offset:1024 sc1
    v_max_f32 v203, s40, v203
    s_waitcnt lgkmcnt(4)
    v_mfma_f32_16x16x32_bf16 v[96:99], a[120:123], a[208:211], v[96:99]
    ds_read_b128 a[112:115], v216 offset:8192
    v_add_f32 v200, v204, v200
    v_add_f32 v201, v205, v201
    v_mfma_f32_16x16x32_bf16 v[112:115], a[120:123], a[212:215], v[112:115]
    v_add_f32 v202, v206, v202
    v_add_f32 v203, v207, v203
    v_mfma_f32_16x16x32_bf16 v[116:119], a[124:127], a[212:215], v[116:119]
    ds_read_b128 a[116:119], v216 offset:9216
    v_cvt_pk_bf16_f32 v242, v200, v201
    v_mfma_f32_16x16x32_bf16 v[100:103], a[124:127], a[208:211], v[100:103]
    buffer_load_dwordx4 v9, s[72:75], s44 offen offset:2048 sc1 lds
    v_cvt_pk_bf16_f32 v243, v202, v203
    s_waitcnt lgkmcnt(4)
    v_mfma_f32_16x16x32_bf16 v[120:123], a[128:131], a[208:211], v[120:123]
    ds_read_b128 a[120:123], v216 offset:10240
    v_mfma_f32_16x16x32_bf16 v[136:139], a[128:131], a[212:215], v[136:139]
    v_accvgpr_read_b32 v200, a60
    v_mfma_f32_16x16x32_bf16 v[140:143], a[132:135], a[212:215], v[140:143]
    ds_read_b128 a[124:127], v216 offset:11264
    v_accvgpr_read_b32 v201, a61
    v_mfma_f32_16x16x32_bf16 v[124:127], a[132:135], a[208:211], v[124:127]
    v_accvgpr_read_b32 v202, a62
    s_waitcnt lgkmcnt(4)
    v_mfma_f32_16x16x32_bf16 v[128:131], a[136:139], a[208:211], v[128:131]
    ds_read_b128 a[128:131], v216 offset:12288
    v_accvgpr_read_b32 v203, a63
    v_mfma_f32_16x16x32_bf16 v[144:147], a[136:139], a[212:215], v[144:147]
    s_cmp_eq_u32 s48, 0
    s_cbranch_scc0 M_np201
    buffer_load_dwordx2 v[18:19], v21, s[92:95], 0 offen sc1
M_np201:
    v_mul_f32 v204, s38, v200
    v_mul_f32 v205, s38, v201
    v_mfma_f32_16x16x32_bf16 v[148:151], a[140:143], a[212:215], v[148:151]
    ds_read_b128 a[132:135], v216 offset:13312
    v_mul_f32 v206, s38, v202
    v_mfma_f32_16x16x32_bf16 v[132:135], a[140:143], a[208:211], v[132:135]
    buffer_load_dwordx4 v9, s[72:75], s44 offen offset:3072 sc1 lds
    v_mul_f32 v207, s38, v203
    v_exp_f32_e64 v204, v204 clamp
    s_waitcnt vmcnt(22) lgkmcnt(4)
    v_mfma_f32_16x16x32_bf16 v[88:91], a[112:115], a[216:219], v[88:91]
    ds_read_b128 a[136:139], v216 offset:14336
    v_exp_f32_e64 v205, v205 clamp
    v_mfma_f32_16x16x32_bf16 v[104:107], a[112:115], a[220:223], v[104:107]
    buffer_load_dwordx4 a[152:155], v8, s[20:23], s43 offen offset:0 sc1
    v_exp_f32_e64 v206, v206 clamp
    v_mfma_f32_16x16x32_bf16 v[108:111], a[116:119], a[220:223], v[108:111]
    ds_read_b128 a[140:143], v216 offset:15360
    v_mfma_f32_16x16x32_bf16 v[92:95], a[116:119], a[216:219], v[92:95]
    buffer_load_dwordx4 a[156:159], v8, s[20:23], s43 offen offset:1024 sc1
    v_exp_f32_e64 v207, v207 clamp
    s_waitcnt lgkmcnt(4)
    v_mfma_f32_16x16x32_bf16 v[96:99], a[120:123], a[216:219], v[96:99]
    ds_read_b128 a[112:115], v216 offset:16384
    v_max_f32 v200, s40, v200
    v_mfma_f32_16x16x32_bf16 v[112:115], a[120:123], a[220:223], v[112:115]
    v_max_f32 v201, s40, v201
    v_mfma_f32_16x16x32_bf16 v[116:119], a[124:127], a[220:223], v[116:119]
    ds_read_b128 a[116:119], v216 offset:17408
    v_max_f32 v202, s40, v202
    v_mfma_f32_16x16x32_bf16 v[100:103], a[124:127], a[216:219], v[100:103]
    s_mov_b32 s44, 0x400000
    s_add_u32 m0, s62, 0x8000
    s_nop 0
    buffer_load_dwordx4 v9, s[72:75], s44 offen offset:0 sc1 lds
    v_max_f32 v203, s40, v203
    s_waitcnt lgkmcnt(4)
    v_mfma_f32_16x16x32_bf16 v[120:123], a[128:131], a[216:219], v[120:123]
    ds_read_b128 a[120:123], v216 offset:18432
    v_add_f32 v200, v204, v200
    v_add_f32 v201, v205, v201
    v_mfma_f32_16x16x32_bf16 v[136:139], a[128:131], a[220:223], v[136:139]
    v_add_f32 v202, v206, v202
    v_add_f32 v203, v207, v203
    v_mfma_f32_16x16x32_bf16 v[140:143], a[132:135], a[220:223], v[140:143]
    ds_read_b128 a[124:127], v216 offset:19456
    v_cvt_pk_bf16_f32 v244, v200, v201
    v_mfma_f32_16x16x32_bf16 v[124:127], a[132:135], a[216:219], v[124:127]
    v_cvt_pk_bf16_f32 v245, v202, v203
    s_waitcnt lgkmcnt(4)
    v_mfma_f32_16x16x32_bf16 v[128:131], a[136:139], a[216:219], v[128:131]
    ds_read_b128 a[128:131], v216 offset:20480
    v_mfma_f32_16x16x32_bf16 v[144:147], a[136:139], a[220:223], v[144:147]
    v_accvgpr_read_b32 v200, a76
    v_mfma_f32_16x16x32_bf16 v[148:151], a[140:143], a[220:223], v[148:151]
    ds_read_b128 a[132:135], v216 offset:21504
    v_accvgpr_read_b32 v201, a77
    v_mfma_f32_16x16x32_bf16 v[132:135], a[140:143], a[216:219], v[132:135]
    buffer_load_dwordx4 v9, s[72:75], s44 offen offset:1024 sc1 lds
    v_accvgpr_read_b32 v202, a78
    s_waitcnt vmcnt(22) lgkmcnt(4)
    v_mfma_f32_16x16x32_bf16 v[88:91], a[112:115], a[224:227], v[88:91]
    ds_read_b128 a[136:139], v216 offset:22528
    v_accvgpr_read_b32 v203, a79
    v_mfma_f32_16x16x32_bf16 v[104:107], a[112:115], a[228:231], v[104:107]
    s_mov_b32 s43, 0x780000
    buffer_load_dwordx4 a[160:163], v7, s[20:23], s43 offen offset:0 sc1
    v_mul_f32 v204, s38, v200
    v_mul_f32 v205, s38, v201
    v_mfma_f32_16x16x32_bf16 v[108:111], a[116:119], a[228:231], v[108:111]
    ds_read_b128 a[140:143], v216 offset:23552
    v_mul_f32 v206, s38, v202
    v_mfma_f32_16x16x32_bf16 v[92:95], a[116:119], a[224:227], v[92:95]
    buffer_load_dwordx4 a[164:167], v7, s[20:23], s43 offen offset:1024 sc1
    v_mul_f32 v207, s38, v203
    v_exp_f32_e64 v204, v204 clamp
    s_waitcnt lgkmcnt(4)
    v_mfma_f32_16x16x32_bf16 v[96:99], a[120:123], a[224:227], v[96:99]
    ds_read_b128 a[112:115], v216 offset:24576
    v_exp_f32_e64 v205, v205 clamp
    v_mfma_f32_16x16x32_bf16 v[112:115], a[120:123], a[228:231], v[112:115]
    v_exp_f32_e64 v206, v206 clamp
    v_mfma_f32_16x16x32_bf16 v[116:119], a[124:127], a[228:231], v[116:119]
    ds_read_b128 a[116:119], v216 offset:25600
    v_mfma_f32_16x16x32_bf16 v[100:103], a[124:127], a[224:227], v[100:103]
    buffer_load_dwordx4 v9, s[72:75], s44 offen offset:2048 sc1 lds
    v_exp_f32_e64 v207, v207 clamp
    s_waitcnt lgkmcnt(4)
    v_mfma_f32_16x16x32_bf16 v[120:123], a[128:131], a[224:227], v[120:123]
    ds_read_b128 a[120:123], v216 offset:26624
    v_max_f32 v200, s40, v200
    v_mfma_f32_16x16x32_bf16 v[136:139], a[128:131], a[228:231], v[136:139]
    v_max_f32 v201, s40, v201
    v_mfma_f32_16x16x32_bf16 v[140:143], a[132:135], a[228:231], v[140:143]
    ds_read_b128 a[124:127], v216 offset:27648
    v_max_f32 v202, s40, v202
    v_mfma_f32_16x16x32_bf16 v[124:127], a[132:135], a[224:227], v[124:127]
    v_max_f32 v203, s40, v203
    s_waitcnt lgkmcnt(4)
    v_mfma_f32_16x16x32_bf16 v[128:131], a[136:139], a[224:227], v[128:131]
    ds_read_b128 a[128:131], v216 offset:28672
    v_add_f32 v200, v204, v200
    v_add_f32 v201, v205, v201
    v_mfma_f32_16x16x32_bf16 v[144:147], a[136:139], a[228:231], v[144:147]
    v_add_f32 v202, v206, v202
    v_add_f32 v203, v207, v203
    v_mfma_f32_16x16x32_bf16 v[148:151], a[140:143], a[228:231], v[148:151]
    ds_read_b128 a[132:135], v216 offset:29696
    v_cvt_pk_bf16_f32 v246, v200, v201
    v_mfma_f32_16x16x32_bf16 v[132:135], a[140:143], a[224:227], v[132:135]
    buffer_load_dwordx4 v9, s[72:75], s44 offen offset:3072 sc1 lds
    v_cvt_pk_bf16_f32 v247, v202, v203
    s_waitcnt vmcnt(22) lgkmcnt(4)
    v_mfma_f32_16x16x32_bf16 v[88:91], a[112:115], a[232:235], v[88:91]
    ds_read_b128 a[136:139], v216 offset:30720
    v_mfma_f32_16x16x32_bf16 v[104:107], a[112:115], a[236:239], v[104:107]
    buffer_load_dwordx4 a[168:171], v8, s[20:23], s43 offen offset:0 sc1
    v_accvgpr_read_b32 v200, a64
    v_mfma_f32_16x16x32_bf16 v[108:111], a[116:119], a[236:239], v[108:111]
    ds_read_b128 a[140:143], v216 offset:31744
    v_accvgpr_read_b32 v201, a65
    v_mfma_f32_16x16x32_bf16 v[92:95], a[116:119], a[232:235], v[92:95]
    buffer_load_dwordx4 a[172:175], v8, s[20:23], s43 offen offset:1024 sc1
    v_accvgpr_read_b32 v202, a66
    s_cmp_eq_u32 s48, 0
    s_cbranch_scc0 M_nc201
    s_waitcnt vmcnt(11)
    s_mov_b32 s91, 0
M_pc11:
    v_xor_b32 v14, s12, v18
    v_bfe_u32 v15, v19, 5, 1
    v_xor_b32 v15, 1, v15
    v_or_b32 v14, v14, v15
    v_cmp_ne_u32 vcc, 0, v14
    s_nop 3
    s_and_b32 s13, vcc_hi, 0xffffffff
    s_or_b32 s13, s13, vcc_lo
    s_cmp_eq_u32 s13, 0
    s_cbranch_scc1 M_pc11_ok
    s_add_u32 s91, s91, 1
    s_cmp_ge_u32 s91, 0x40000
    s_cbranch_scc1 M_pc11_ok
    s_sleep 8
    buffer_load_dwordx2 v[18:19], v21, s[92:95], 0 offen sc1
    s_waitcnt vmcnt(0)
    s_branch M_pc11
M_pc11_ok:
M_nc201:
    s_waitcnt vmcnt(18) lgkmcnt(4)
    s_barrier
    v_mfma_f32_16x16x32_bf16 v[96:99], a[120:123], a[232:235], v[96:99]
    ds_read_b128 a[112:115], v216 offset:32768
    v_accvgpr_read_b32 v203, a67
    v_mfma_f32_16x16x32_bf16 v[112:115], a[120:123], a[236:239], v[112:115]
    v_mul_f32 v204, s38, v200
    v_mul_f32 v205, s38, v201
    v_mfma_f32_16x16x32_bf16 v[116:119], a[124:127], a[236:239], v[116:119]
    ds_read_b128 a[116:119], v216 offset:33792
    v_mul_f32 v206, s38, v202
    v_mfma_f32_16x16x32_bf16 v[100:103], a[124:127], a[232:235], v[100:103]
    s_mov_b32 s44, 0x440000
    s_add_u32 m0, s62, 0xc000
    s_nop 0
    buffer_load_dwordx4 v9, s[72:75], s44 offen offset:0 sc1 lds
    v_mul_f32 v207, s38, v203
    v_exp_f32_e64 v204, v204 clamp
    s_waitcnt lgkmcnt(4)
    v_mfma_f32_16x16x32_bf16 v[120:123], a[128:131], a[232:235], v[120:123]
    ds_read_b128 a[120:123], v216 offset:34816
    v_exp_f32_e64 v205, v205 clamp
    v_mfma_f32_16x16x32_bf16 v[136:139], a[128:131], a[236:239], v[136:139]
    s_mov_b32 s65, 0
    buffer_load_dwordx4 v[24:27], v225, s[24:27], s65 offen sc1
    v_exp_f32_e64 v206, v206 clamp
    v_mfma_f32_16x16x32_bf16 v[140:143], a[132:135], a[236:239], v[140:143]
    ds_read_b128 a[124:127], v216 offset:35840
    v_mfma_f32_16x16x32_bf16 v[124:127], a[132:135], a[232:235], v[124:127]
    v_exp_f32_e64 v207, v207 clamp
    s_waitcnt lgkmcnt(4)
    v_mfma_f32_16x16x32_bf16 v[128:131], a[136:139], a[232:235], v[128:131]
    ds_read_b128 a[128:131], v216 offset:36864
    v_max_f32 v200, s40, v200
    v_mfma_f32_16x16x32_bf16 v[144:147], a[136:139], a[236:239], v[144:147]
    v_max_f32 v201, s40, v201
    v_mfma_f32_16x16x32_bf16 v[148:151], a[140:143], a[236:239], v[148:151]
    ds_read_b128 a[132:135], v216 offset:37888
    v_max_f32 v202, s40, v202
    v_mfma_f32_16x16x32_bf16 v[132:135], a[140:143], a[232:235], v[132:135]
    buffer_load_dwordx4 v9, s[72:75], s44 offen offset:1024 sc1 lds
    v_max_f32 v203, s40, v203
    s_waitcnt lgkmcnt(4)
    v_mfma_f32_16x16x32_bf16 v[88:91], a[112:115], a[240:243], v[88:91]
    ds_read_b128 a[136:139], v216 offset:38912
    v_add_f32 v200, v204, v200
    v_add_f32 v201, v205, v201
    v_mfma_f32_16x16x32_bf16 v[104:107], a[112:115], a[244:247], v[104:107]
    s_mov_b32 s43, 0x800000
    buffer_load_dwordx4 a[176:179], v7, s[20:23], s43 offen offset:0 sc1
    s_mov_b32 s65, 6144
    buffer_load_dwordx4 v[28:31], v225, s[24:27], s65 offen sc1
    v_add_f32 v202, v206, v202
    v_add_f32 v203, v207, v203
    v_mfma_f32_16x16x32_bf16 v[108:111], a[116:119], a[244:247], v[108:111]
    ds_read_b128 a[140:143], v216 offset:39936
    v_cvt_pk_bf16_f32 v248, v200, v201
    v_mfma_f32_16x16x32_bf16 v[92:95], a[116:119], a[240:243], v[92:95]
    buffer_load_dwordx4 a[180:183], v7, s[20:23], s43 offen offset:1024 sc1
    v_cvt_pk_bf16_f32 v249, v202, v203
    s_waitcnt lgkmcnt(4)
    v_mfma_f32_16x16x32_bf16 v[96:99], a[120:123], a[240:243], v[96:99]
    ds_read_b128 a[112:115], v216 offset:40960
    v_mfma_f32_16x16x32_bf16 v[112:115], a[120:123], a[244:247], v[112:115]
    v_accvgpr_read_b32 v200, a80
    v_mfma_f32_16x16x32_bf16 v[116:119], a[124:127], a[244:247], v[116:119]
    ds_read_b128 a[116:119], v216 offset:41984
    v_accvgpr_read_b32 v201, a81
    v_mfma_f32_16x16x32_bf16 v[100:103], a[124:127], a[240:243], v[100:103]
    buffer_load_dwordx4 v9, s[72:75], s44 offen offset:2048 sc1 lds
    v_accvgpr_read_b32 v202, a82
    s_waitcnt lgkmcnt(4)
    v_mfma_f32_16x16x32_bf16 v[120:123], a[128:131], a[240:243], v[120:123]
    ds_read_b128 a[120:123], v216 offset:43008
    v_accvgpr_read_b32 v203, a83
    v_mfma_f32_16x16x32_bf16 v[136:139], a[128:131], a[244:247], v[136:139]
    s_mov_b32 s65, 12288
    buffer_load_dwordx4 v[32:35], v225, s[24:27], s65 offen sc1
    v_mul_f32 v204, s38, v200
    v_mul_f32 v205, s38, v201
    v_mfma_f32_16x16x32_bf16 v[140:143], a[132:135], a[244:247], v[140:143]
    ds_read_b128 a[124:127], v216 offset:44032
    v_mul_f32 v206, s38, v202
    v_mfma_f32_16x16x32_bf16 v[124:127], a[132:135], a[240:243], v[124:127]
    v_mul_f32 v207, s38, v203
    v_exp_f32_e64 v204, v204 clamp
    s_waitcnt lgkmcnt(4)
    v_mfma_f32_16x16x32_bf16 v[128:131], a[136:139], a[240:243], v[128:131]
    ds_read_b128 a[128:131], v216 offset:45056
    v_exp_f32_e64 v205, v205 clamp
    v_mfma_f32_16x16x32_bf16 v[144:147], a[136:139], a[244:247], v[144:147]
    v_exp_f32_e64 v206, v206 clamp
    v_mfma_f32_16x16x32_bf16 v[148:151], a[140:143], a[244:247], v[148:151]
    ds_read_b128 a[132:135], v216 offset:46080
    v_mfma_f32_16x16x32_bf16 v[132:135], a[140:143], a[240:243], v[132:135]
    buffer_load_dwordx4 v9, s[72:75], s44 offen offset:3072 sc1 lds
    v_exp_f32_e64 v207, v207 clamp
    s_waitcnt vmcnt(25) lgkmcnt(4)
    v_mfma_f32_16x16x32_bf16 v[88:91], a[112:115], a[248:251], v[88:91]
    ds_read_b128 a[136:139], v216 offset:47104
    v_max_f32 v200, s40, v200
    v_mfma_f32_16x16x32_bf16 v[104:107], a[112:115], a[252:255], v[104:107]
    buffer_load_dwordx4 a[184:187], v8, s[20:23], s43 offen offset:0 sc1
    s_mov_b32 s65, 18432
    buffer_load_dwordx4 v[36:39], v225, s[24:27], s65 offen sc1
    v_max_f32 v201, s40, v201
    v_mfma_f32_16x16x32_bf16 v[108:111], a[116:119], a[252:255], v[108:111]
    ds_read_b128 a[140:143], v216 offset:48128
    v_max_f32 v202, s40, v202
    v_mfma_f32_16x16x32_bf16 v[92:95], a[116:119], a[248:251], v[92:95]
    buffer_load_dwordx4 a[188:191], v8, s[20:23], s43 offen offset:1024 sc1
    v_max_f32 v203, s40, v203
    s_waitcnt lgkmcnt(4)
    v_mfma_f32_16x16x32_bf16 v[96:99], a[120:123], a[248:251], v[96:99]
    ds_read_b128 a[112:115], v13 offset:0
    v_add_f32 v200, v204, v200
    v_add_f32 v201, v205, v201
    v_mfma_f32_16x16x32_bf16 v[112:115], a[120:123], a[252:255], v[112:115]
    v_add_f32 v202, v206, v202
    v_add_f32 v203, v207, v203
    v_mfma_f32_16x16x32_bf16 v[116:119], a[124:127], a[252:255], v[116:119]
    ds_read_b128 a[116:119], v13 offset:1024
    v_cvt_pk_bf16_f32 v250, v200, v201
    v_mfma_f32_16x16x32_bf16 v[100:103], a[124:127], a[248:251], v[100:103]
    s_mov_b32 s44, 0x480000
    s_add_u32 m0, s62, 0x10000
    s_nop 0
    buffer_load_dwordx4 v9, s[72:75], s44 offen offset:0 sc1 lds
    v_cvt_pk_bf16_f32 v251, v202, v203
    s_waitcnt lgkmcnt(4)
    v_mfma_f32_16x16x32_bf16 v[120:123], a[128:131], a[248:251], v[120:123]
    ds_read_b128 a[120:123], v13 offset:2048
    v_mfma_f32_16x16x32_bf16 v[136:139], a[128:131], a[252:255], v[136:139]
    s_mov_b32 s65, 24576
    buffer_load_dwordx4 v[40:43], v225, s[24:27], s65 offen sc1
    v_accvgpr_read_b32 v200, a68
    v_mfma_f32_16x16x32_bf16 v[140:143], a[132:135], a[252:255], v[140:143]
    ds_read_b128 a[124:127], v13 offset:3072
    v_accvgpr_read_b32 v201, a69
    v_mfma_f32_16x16x32_bf16 v[124:127], a[132:135], a[248:251], v[124:127]
    v_accvgpr_read_b32 v202, a70
    s_waitcnt lgkmcnt(4)
    v_mfma_f32_16x16x32_bf16 v[128:131], a[136:139], a[248:251], v[128:131]
    ds_read_b128 a[128:131], v13 offset:4096
    v_accvgpr_read_b32 v203, a71
    v_mfma_f32_16x16x32_bf16 v[144:147], a[136:139], a[252:255], v[144:147]
    v_mul_f32 v204, s38, v200
    v_mul_f32 v205, s38, v201
    v_mfma_f32_16x16x32_bf16 v[148:151], a[140:143], a[252:255], v[148:151]
    ds_read_b128 a[132:135], v13 offset:5120
    v_mul_f32 v206, s38, v202
    v_mfma_f32_16x16x32_bf16 v[132:135], a[140:143], a[248:251], v[132:135]
    buffer_load_dwordx4 v9, s[72:75], s44 offen offset:1024 sc1 lds
    v_mul_f32 v207, s38, v203
    v_exp_f32_e64 v204, v204 clamp
    s_waitcnt vmcnt(27) lgkmcnt(4)
    v_mfma_f32_16x16x32_bf16 v[88:91], a[112:115], a[144:147], v[88:91]
    ds_read_b128 a[136:139], v13 offset:6144
    v_exp_f32_e64 v205, v205 clamp
    v_mfma_f32_16x16x32_bf16 v[104:107], a[112:115], a[148:151], v[104:107]
    s_mov_b32 s43, 0x880000
    buffer_load_dwordx4 a[192:195], v7, s[20:23], s43 offen offset:0 sc1
    s_mov_b32 s65, 30720
    buffer_load_dwordx4 v[44:47], v225, s[24:27], s65 offen sc1
    v_exp_f32_e64 v206, v206 clamp
    v_mfma_f32_16x16x32_bf16 v[108:111], a[116:119], a[148:151], v[108:111]
    ds_read_b128 a[140:143], v13 offset:7168
    v_mfma_f32_16x16x32_bf16 v[92:95], a[116:119], a[144:147], v[92:95]
    buffer_load_dwordx4 a[196:199], v7, s[20:23], s43 offen offset:1024 sc1
    v_exp_f32_e64 v207, v207 clamp
    s_waitcnt lgkmcnt(4)
    v_mfma_f32_16x16x32_bf16 v[96:99], a[120:123], a[144:147], v[96:99]
    ds_read_b128 a[112:115], v13 offset:8192
    v_max_f32 v200, s40, v200
    v_mfma_f32_16x16x32_bf16 v[112:115], a[120:123], a[148:151], v[112:115]
    v_max_f32 v201, s40, v201
    v_mfma_f32_16x16x32_bf16 v[116:119], a[124:127], a[148:151], v[116:119]
    ds_read_b128 a[116:119], v13 offset:9216
    v_max_f32 v202, s40, v202
    v_mfma_f32_16x16x32_bf16 v[100:103], a[124:127], a[144:147], v[100:103]
    buffer_load_dwordx4 v9, s[72:75], s44 offen offset:2048 sc1 lds
    v_max_f32 v203, s40, v203
    s_waitcnt lgkmcnt(4)
    v_mfma_f32_16x16x32_bf16 v[120:123], a[128:131], a[144:147], v[120:123]
    ds_read_b128 a[120:123], v13 offset:10240
    v_add_f32 v200, v204, v200
    v_add_f32 v201, v205, v201
    v_mfma_f32_16x16x32_bf16 v[136:139], a[128:131], a[148:151], v[136:139]
    s_mov_b32 s65, 36864
    buffer_load_dwordx4 v[48:51], v225, s[24:27], s65 offen sc1
    v_add_f32 v202, v206, v202
    v_add_f32 v203, v207, v203
    v_mfma_f32_16x16x32_bf16 v[140:143], a[132:135], a[148:151], v[140:143]
    ds_read_b128 a[124:127], v13 offset:11264
    v_cvt_pk_bf16_f32 v252, v200, v201
    v_mfma_f32_16x16x32_bf16 v[124:127], a[132:135], a[144:147], v[124:127]
    v_cvt_pk_bf16_f32 v253, v202, v203
    s_waitcnt lgkmcnt(4)
    v_mfma_f32_16x16x32_bf16 v[128:131], a[136:139], a[144:147], v[128:131]
    ds_read_b128 a[128:131], v13 offset:12288
    v_mfma_f32_16x16x32_bf16 v[144:147], a[136:139], a[148:151], v[144:147]
    v_accvgpr_read_b32 v200, a84
    v_mfma_f32_16x16x32_bf16 v[148:151], a[140:143], a[148:151], v[148:151]
    ds_read_b128 a[132:135], v13 offset:13312
    v_accvgpr_read_b32 v201, a85
    v_mfma_f32_16x16x32_bf16 v[132:135], a[140:143], a[144:147], v[132:135]
    buffer_load_dwordx4 v9, s[72:75], s44 offen offset:3072 sc1 lds
    v_accvgpr_read_b32 v202, a86
    s_waitcnt vmcnt(29) lgkmcnt(4)
    v_mfma_f32_16x16x32_bf16 v[88:91], a[112:115], a[152:155], v[88:91]
    ds_read_b128 a[136:139], v13 offset:14336
    v_accvgpr_read_b32 v203, a87
    v_mfma_f32_16x16x32_bf16 v[104:107], a[112:115], a[156:159], v[104:107]
    buffer_load_dwordx4 a[200:203], v8, s[20:23], s43 offen offset:0 sc1
    s_mov_b32 s65, 43008
    buffer_load_dwordx4 v[52:55], v225, s[24:27], s65 offen sc1
    v_mul_f32 v204, s38, v200
    v_mul_f32 v205, s38, v201
    v_mfma_f32_16x16x32_bf16 v[108:111], a[116:119], a[156:159], v[108:111]
    ds_read_b128 a[140:143], v13 offset:15360
    v_mul_f32 v206, s38, v202
    v_mfma_f32_16x16x32_bf16 v[92:95], a[116:119], a[152:155], v[92:95]
    buffer_load_dwordx4 a[204:207], v8, s[20:23], s43 offen offset:1024 sc1
    v_mul_f32 v207, s38, v203
    v_exp_f32_e64 v204, v204 clamp
    s_waitcnt vmcnt(26) lgkmcnt(4)
    s_barrier
    v_mfma_f32_16x16x32_bf16 v[96:99], a[120:123], a[152:155], v[96:99]
    ds_read_b128 a[112:115], v13 offset:16384
    v_exp_f32_e64 v205, v205 clamp
    v_mfma_f32_16x16x32_bf16 v[112:115], a[120:123], a[156:159], v[112:115]
    v_exp_f32_e64 v206, v206 clamp
    v_mfma_f32_16x16x32_bf16 v[116:119], a[124:127], a[156:159], v[116:119]
    ds_read_b128 a[116:119], v13 offset:17408
    v_mfma_f32_16x16x32_bf16 v[100:103], a[124:127], a[152:155], v[100:103]
    s_mov_b32 s44, 0x4c0000
    s_add_u32 m0, s62, 0x14000
    s_nop 0
    buffer_load_dwordx4 v9, s[72:75], s44 offen offset:0 sc1 lds
    v_exp_f32_e64 v207, v207 clamp
    s_waitcnt lgkmcnt(4)
    v_mfma_f32_16x16x32_bf16 v[120:123], a[128:131], a[152:155], v[120:123]
    ds_read_b128 a[120:123], v13 offset:18432
    v_max_f32 v200, s40, v200
    v_mfma_f32_16x16x32_bf16 v[136:139], a[128:131], a[156:159], v[136:139]
    v_max_f32 v201, s40, v201
    v_mfma_f32_16x16x32_bf16 v[140:143], a[132:135], a[156:159], v[140:143]
    ds_read_b128 a[124:127], v13 offset:19456
    v_max_f32 v202, s40, v202
    v_mfma_f32_16x16x32_bf16 v[124:127], a[132:135], a[152:155], v[124:127]
    v_max_f32 v203, s40, v203
    s_waitcnt lgkmcnt(4)
    v_mfma_f32_16x16x32_bf16 v[128:131], a[136:139], a[152:155], v[128:131]
    ds_read_b128 a[128:131], v13 offset:20480
    v_add_f32 v200, v204, v200
    v_add_f32 v201, v205, v201
    v_mfma_f32_16x16x32_bf16 v[144:147], a[136:139], a[156:159], v[144:147]
    buffer_load_dwordx4 v[56:59], v226, s[24:27], 0 offen offset:2048 sc1
    v_add_f32 v202, v206, v202
    v_add_f32 v203, v207, v203
    v_mfma_f32_16x16x32_bf16 v[148:151], a[140:143], a[156:159], v[148:151]
    ds_read_b128 a[132:135], v13 offset:21504
    v_cvt_pk_bf16_f32 v254, v200, v201
    v_mfma_f32_16x16x32_bf16 v[132:135], a[140:143], a[152:155], v[132:135]
    buffer_load_dwordx4 v9, s[72:75], s44 offen offset:1024 sc1 lds
    v_cvt_pk_bf16_f32 v255, v202, v203
    s_waitcnt lgkmcnt(4)
    v_mfma_f32_16x16x32_bf16 v[88:91], a[112:115], a[160:163], v[88:91]
    ds_read_b128 a[136:139], v13 offset:22528
    v_mfma_f32_16x16x32_bf16 v[104:107], a[112:115], a[164:167], v[104:107]
    s_mov_b32 s43, 0x900000
    buffer_load_dwordx4 a[208:211], v7, s[20:23], s43 offen offset:0 sc1
    v_mfma_f32_16x16x32_bf16 v[108:111], a[116:119], a[164:167], v[108:111]
    ds_read_b128 a[140:143], v13 offset:23552
    v_mfma_f32_16x16x32_bf16 v[92:95], a[116:119], a[160:163], v[92:95]
    buffer_load_dwordx4 a[212:215], v7, s[20:23], s43 offen offset:1024 sc1
    s_waitcnt lgkmcnt(4)
    v_mfma_f32_16x16x32_bf16 v[96:99], a[120:123], a[160:163], v[96:99]
    ds_read_b128 a[112:115], v13 offset:24576
    v_mfma_f32_16x16x32_bf16 v[112:115], a[120:123], a[164:167], v[112:115]
    v_mfma_f32_16x16x32_bf16 v[116:119], a[124:127], a[164:167], v[116:119]
    ds_read_b128 a[116:119], v13 offset:25600
    v_mfma_f32_16x16x32_bf16 v[100:103], a[124:127], a[160:163], v[100:103]
    buffer_load_dwordx4 v9, s[72:75], s44 offen offset:2048 sc1 lds
    s_waitcnt lgkmcnt(4)
    v_mfma_f32_16x16x32_bf16 v[120:123], a[128:131], a[160:163], v[120:123]
    ds_read_b128 a[120:123], v13 offset:26624
    v_mfma_f32_16x16x32_bf16 v[136:139], a[128:131], a[164:167], v[136:139]
    v_mfma_f32_16x16x32_bf16 v[140:143], a[132:135], a[164:167], v[140:143]
    ds_read_b128 a[124:127], v13 offset:27648
    v_mfma_f32_16x16x32_bf16 v[124:127], a[132:135], a[160:163], v[124:127]
    s_waitcnt lgkmcnt(4)
    v_mfma_f32_16x16x32_bf16 v[128:131], a[136:139], a[160:163], v[128:131]
    ds_read_b128 a[128:131], v13 offset:28672
    v_mfma_f32_16x16x32_bf16 v[144:147], a[136:139], a[164:167], v[144:147]
    v_mfma_f32_16x16x32_bf16 v[148:151], a[140:143], a[164:167], v[148:151]
    ds_read_b128 a[132:135], v13 offset:29696
    v_mfma_f32_16x16x32_bf16 v[132:135], a[140:143], a[160:163], v[132:135]
    buffer_load_dwordx4 v9, s[72:75], s44 offen offset:3072 sc1 lds
    s_waitcnt vmcnt(31) lgkmcnt(4)
    v_mfma_f32_16x16x32_bf16 v[88:91], a[112:115], a[168:171], v[88:91]
    ds_read_b128 a[136:139], v13 offset:30720
    v_mfma_f32_16x16x32_bf16 v[104:107], a[112:115], a[172:175], v[104:107]
    buffer_load_dwordx4 a[216:219], v8, s[20:23], s43 offen offset:0 sc1
    v_mfma_f32_16x16x32_bf16 v[108:111], a[116:119], a[172:175], v[108:111]
    ds_read_b128 a[140:143], v13 offset:31744
    v_mfma_f32_16x16x32_bf16 v[92:95], a[116:119], a[168:171], v[92:95]
    buffer_load_dwordx4 a[220:223], v8, s[20:23], s43 offen offset:1024 sc1
    s_waitcnt lgkmcnt(4)
    v_mfma_f32_16x16x32_bf16 v[96:99], a[120:123], a[168:171], v[96:99]
    ds_read_b128 a[112:115], v13 offset:32768
    v_mfma_f32_16x16x32_bf16 v[112:115], a[120:123], a[172:175], v[112:115]
    v_mfma_f32_16x16x32_bf16 v[116:119], a[124:127], a[172:175], v[116:119]
    ds_read_b128 a[116:119], v13 offset:33792
    v_mfma_f32_16x16x32_bf16 v[100:103], a[124:127], a[168:171], v[100:103]
    s_mov_b32 s44, 0x500000
    s_add_u32 m0, s62, 0x18000
    s_nop 0
    buffer_load_dwordx4 v9, s[72:75], s44 offen offset:0 sc1 lds
    s_waitcnt lgkmcnt(4)
    v_mfma_f32_16x16x32_bf16 v[120:123], a[128:131], a[168:171], v[120:123]
    ds_read_b128 a[120:123], v13 offset:34816
    v_mfma_f32_16x16x32_bf16 v[136:139], a[128:131], a[172:175], v[136:139]
    v_mfma_f32_16x16x32_bf16 v[140:143], a[132:135], a[172:175], v[140:143]
    ds_read_b128 a[124:127], v13 offset:35840
    v_mfma_f32_16x16x32_bf16 v[124:127], a[132:135], a[168:171], v[124:127]
    s_waitcnt lgkmcnt(4)
    v_mfma_f32_16x16x32_bf16 v[128:131], a[136:139], a[168:171], v[128:131]
    ds_read_b128 a[128:131], v13 offset:36864
    v_mfma_f32_16x16x32_bf16 v[144:147], a[136:139], a[172:175], v[144:147]
    v_mfma_f32_16x16x32_bf16 v[148:151], a[140:143], a[172:175], v[148:151]
    ds_read_b128 a[132:135], v13 offset:37888
    v_mfma_f32_16x16x32_bf16 v[132:135], a[140:143], a[168:171], v[132:135]
    buffer_load_dwordx4 v9, s[72:75], s44 offen offset:1024 sc1 lds
    s_waitcnt vmcnt(29) lgkmcnt(4)
    v_mfma_f32_16x16x32_bf16 v[88:91], a[112:115], a[176:179], v[88:91]
    ds_read_b128 a[136:139], v13 offset:38912
    s_waitcnt vmcnt(9)
    v_add_f32 v24, v40, v24
    v_add_f32 v25, v41, v25
    v_mfma_f32_16x16x32_bf16 v[104:107], a[112:115], a[180:183], v[104:107]
    s_mov_b32 s43, 0x980000
    buffer_load_dwordx4 a[224:227], v7, s[20:23], s43 offen offset:0 sc1
    v_add_f32 v26, v42, v26
    v_add_f32 v27, v43, v27
    v_add_f32 v28, v44, v28
    v_add_f32 v29, v45, v29
    v_mfma_f32_16x16x32_bf16 v[108:111], a[116:119], a[180:183], v[108:111]
    ds_read_b128 a[140:143], v13 offset:39936
    v_add_f32 v30, v46, v30
    v_add_f32 v31, v47, v31
    v_add_f32 v32, v48, v32
    v_add_f32 v33, v49, v33
    v_add_f32 v34, v50, v34
    v_mfma_f32_16x16x32_bf16 v[92:95], a[116:119], a[176:179], v[92:95]
    buffer_load_dwordx4 a[228:231], v7, s[20:23], s43 offen offset:1024 sc1
    v_add_f32 v35, v51, v35
    v_add_f32 v36, v52, v36
    v_add_f32 v37, v53, v37
    v_add_f32 v38, v54, v38
    v_add_f32 v39, v55, v39
    s_waitcnt lgkmcnt(4)
    v_mfma_f32_16x16x32_bf16 v[96:99], a[120:123], a[176:179], v[96:99]
    ds_read_b128 a[112:115], v13 offset:40960
    v_add_f32 v24, v32, v24
    v_add_f32 v25, v33, v25
    v_add_f32 v26, v34, v26
    v_add_f32 v27, v35, v27
    v_add_f32 v28, v36, v28
    v_mfma_f32_16x16x32_bf16 v[112:115], a[120:123], a[180:183], v[112:115]
    v_add_f32 v29, v37, v29
    v_add_f32 v30, v38, v30
    v_add_f32 v31, v39, v31
    v_add_f32 v24, v28, v24
    v_add_f32 v25, v29, v25
    v_mfma_f32_16x16x32_bf16 v[116:119], a[124:127], a[180:183], v[116:119]
    ds_read_b128 a[116:119], v13 offset:41984
    v_add_f32 v26, v30, v26
    v_add_f32 v27, v31, v27
    v_mfma_f32_16x16x32_bf16 v[100:103], a[124:127], a[176:179], v[100:103]
    buffer_load_dwordx4 v9, s[72:75], s44 offen offset:2048 sc1 lds
    v_add_f32_dpp v56, v56, v56 quad_perm:[1,0,3,2] row_mask:0xf bank_mask:0xf
    v_add_f32_dpp v57, v57, v57 quad_perm:[1,0,3,2] row_mask:0xf bank_mask:0xf
    v_add_f32_dpp v58, v58, v58 quad_perm:[1,0,3,2] row_mask:0xf bank_mask:0xf
    s_waitcnt lgkmcnt(4)
    v_mfma_f32_16x16x32_bf16 v[120:123], a[128:131], a[176:179], v[120:123]
    ds_read_b128 a[120:123], v13 offset:43008
    v_add_f32_dpp v59, v59, v59 quad_perm:[1,0,3,2] row_mask:0xf bank_mask:0xf
    v_add_f32_dpp v56, v56, v56 quad_perm:[2,3,0,1] row_mask:0xf bank_mask:0xf
    v_mfma_f32_16x16x32_bf16 v[136:139], a[128:131], a[180:183], v[136:139]
    v_add_f32_dpp v57, v57, v57 quad_perm:[2,3,0,1] row_mask:0xf bank_mask:0xf
    v_add_f32_dpp v58, v58, v58 quad_perm:[2,3,0,1] row_mask:0xf bank_mask:0xf
    v_add_f32_dpp v59, v59, v59 quad_perm:[2,3,0,1] row_mask:0xf bank_mask:0xf
    v_mfma_f32_16x16x32_bf16 v[140:143], a[132:135], a[180:183], v[140:143]
    ds_read_b128 a[124:127], v13 offset:44032
    v_add_f32_dpp v56, v56, v56 row_half_mirror row_mask:0xf bank_mask:0xf
    v_add_f32_dpp v57, v57, v57 row_half_mirror row_mask:0xf bank_mask:0xf
    v_mfma_f32_16x16x32_bf16 v[124:127], a[132:135], a[176:179], v[124:127]
    v_add_f32_dpp v58, v58, v58 row_half_mirror row_mask:0xf bank_mask:0xf
    v_add_f32_dpp v59, v59, v59 row_half_mirror row_mask:0xf bank_mask:0xf
    v_cvt_pk_bf16_f32 v24, v24, v25
    s_waitcnt lgkmcnt(4)
    v_mfma_f32_16x16x32_bf16 v[128:131], a[136:139], a[176:179], v[128:131]
    ds_read_b128 a[128:131], v13 offset:45056
    v_cvt_pk_bf16_f32 v25, v26, v27
    v_cvt_pk_bf16_f32 v56, v56, v57
    v_mfma_f32_16x16x32_bf16 v[144:147], a[136:139], a[180:183], v[144:147]
    v_cvt_pk_bf16_f32 v57, v58, v59
    ds_write_b64 v227, v[24:25]
    ds_write_b64 v228, v[56:57]
    v_mfma_f32_16x16x32_bf16 v[148:151], a[140:143], a[180:183], v[148:151]
    ds_read_b128 a[132:135], v13 offset:46080
    v_mfma_f32_16x16x32_bf16 v[132:135], a[140:143], a[176:179], v[132:135]
    buffer_load_dwordx4 v9, s[72:75], s44 offen offset:3072 sc1 lds
    s_waitcnt lgkmcnt(6)
    v_mfma_f32_16x16x32_bf16 v[88:91], a[112:115], a[184:187], v[88:91]
    ds_read_b128 a[136:139], v13 offset:47104
    v_mfma_f32_16x16x32_bf16 v[104:107], a[112:115], a[188:191], v[104:107]
    buffer_load_dwordx4 a[232:235], v8, s[20:23], s43 offen offset:0 sc1
    v_mfma_f32_16x16x32_bf16 v[108:111], a[116:119], a[188:191], v[108:111]
    ds_read_b128 a[140:143], v13 offset:48128
    v_mfma_f32_16x16x32_bf16 v[92:95], a[116:119], a[184:187], v[92:95]
    buffer_load_dwordx4 a[236:239], v8, s[20:23], s43 offen offset:1024 sc1
    s_waitcnt lgkmcnt(3)
    s_barrier
    v_mfma_f32_16x16x32_bf16 v[96:99], a[120:123], a[184:187], v[96:99]
    ds_read_b128 a[112:115], v13 offset:49152
    v_mfma_f32_16x16x32_bf16 v[112:115], a[120:123], a[188:191], v[112:115]
    ds_read_b128 v[60:63], v230
    v_mfma_f32_16x16x32_bf16 v[116:119], a[124:127], a[188:191], v[116:119]
    ds_read_b128 a[116:119], v13 offset:50176
    v_mfma_f32_16x16x32_bf16 v[100:103], a[124:127], a[184:187], v[100:103]
    s_mov_b32 s44, 0x540000
    s_add_u32 m0, s62, 0x0
    s_nop 0
    buffer_load_dwordx4 v9, s[72:75], s44 offen offset:0 sc1 lds
    ds_read_b128 v[64:67], v230 offset:1024
    s_waitcnt lgkmcnt(6)
    v_mfma_f32_16x16x32_bf16 v[120:123], a[128:131], a[184:187], v[120:123]
    ds_read_b128 a[120:123], v13 offset:51200
    v_mfma_f32_16x16x32_bf16 v[136:139], a[128:131], a[188:191], v[136:139]
    ds_read_b128 v[68:71], v229
    v_mfma_f32_16x16x32_bf16 v[140:143], a[132:135], a[188:191], v[140:143]
    ds_read_b128 a[124:127], v13 offset:52224
    v_mfma_f32_16x16x32_bf16 v[124:127], a[132:135], a[184:187], v[124:127]
    s_waitcnt lgkmcnt(7)
    v_mfma_f32_16x16x32_bf16 v[128:131], a[136:139], a[184:187], v[128:131]
    ds_read_b128 a[128:131], v13 offset:53248
    v_mfma_f32_16x16x32_bf16 v[144:147], a[136:139], a[188:191], v[144:147]
    v_mfma_f32_16x16x32_bf16 v[148:151], a[140:143], a[188:191], v[148:151]
    ds_read_b128 a[132:135], v13 offset:54272
    v_mfma_f32_16x16x32_bf16 v[132:135], a[140:143], a[184:187], v[132:135]
    buffer_load_dwordx4 v9, s[72:75], s44 offen offset:1024 sc1 lds
    s_waitcnt lgkmcnt(6)
    v_mfma_f32_16x16x32_bf16 v[88:91], a[112:115], a[192:195], v[88:91]
    ds_read_b128 a[136:139], v13 offset:55296
    v_mfma_f32_16x16x32_bf16 v[104:107], a[112:115], a[196:199], v[104:107]
    s_mov_b32 s43, 0xa00000
    buffer_load_dwordx4 a[240:243], v7, s[20:23], s43 offen offset:0 sc1
    v_mfma_f32_16x16x32_bf16 v[108:111], a[116:119], a[196:199], v[108:111]
    ds_read_b128 a[140:143], v13 offset:56320
    v_mfma_f32_16x16x32_bf16 v[92:95], a[116:119], a[192:195], v[92:95]
    buffer_load_dwordx4 a[244:247], v7, s[20:23], s43 offen offset:1024 sc1
    s_waitcnt lgkmcnt(4)
    v_mfma_f32_16x16x32_bf16 v[96:99], a[120:123], a[192:195], v[96:99]
    ds_read_b128 a[112:115], v13 offset:57344
    v_mfma_f32_16x16x32_bf16 v[112:115], a[120:123], a[196:199], v[112:115]
    v_mfma_f32_16x16x32_bf16 v[116:119], a[124:127], a[196:199], v[116:119]
    ds_read_b128 a[116:119], v13 offset:58368
    s_add_u32 s64, s49, 112
    v_mfma_f32_16x16x32_bf16 v[100:103], a[124:127], a[192:195], v[100:103]
    buffer_load_dwordx4 v9, s[72:75], s44 offen offset:2048 sc1 lds
    s_lshl_b32 s64, s64, 17
    s_waitcnt lgkmcnt(4)
    v_mfma_f32_16x16x32_bf16 v[120:123], a[128:131], a[192:195], v[120:123]
    ds_read_b128 a[120:123], v13 offset:59392
    v_mfma_f32_16x16x32_bf16 v[160:163], v[68:71], v[240:243], 0
    v_mfma_f32_16x16x32_bf16 v[136:139], a[128:131], a[196:199], v[136:139]
    v_mfma_f32_16x16x32_bf16 v[152:155], v[60:63], v[240:243], 0
    v_mfma_f32_16x16x32_bf16 v[140:143], a[132:135], a[196:199], v[140:143]
    ds_read_b128 a[124:127], v13 offset:60416
    v_mfma_f32_16x16x32_bf16 v[156:159], v[64:67], v[240:243], 0
    v_mfma_f32_16x16x32_bf16 v[124:127], a[132:135], a[192:195], v[124:127]
    v_mfma_f32_16x16x32_bf16 v[172:175], v[68:71], v[244:247], 0
    s_waitcnt lgkmcnt(4)
    v_mfma_f32_16x16x32_bf16 v[128:131], a[136:139], a[192:195], v[128:131]
    ds_read_b128 a[128:131], v13 offset:61440
    v_mfma_f32_16x16x32_bf16 v[164:167], v[60:63], v[244:247], 0
    v_mfma_f32_16x16x32_bf16 v[144:147], a[136:139], a[196:199], v[144:147]
    v_mfma_f32_16x16x32_bf16 v[168:171], v[64:67], v[244:247], 0
    v_mfma_f32_16x16x32_bf16 v[148:151], a[140:143], a[196:199], v[148:151]
    ds_read_b128 a[132:135], v13 offset:62464
    v_mfma_f32_16x16x32_bf16 v[184:187], v[68:71], v[248:251], 0
    v_mfma_f32_16x16x32_bf16 v[132:135], a[140:143], a[192:195], v[132:135]
    buffer_load_dwordx4 v9, s[72:75], s44 offen offset:3072 sc1 lds
    v_mfma_f32_16x16x32_bf16 v[176:179], v[60:63], v[248:251], 0
    s_waitcnt lgkmcnt(4)
    v_mfma_f32_16x16x32_bf16 v[88:91], a[112:115], a[200:203], v[88:91]
    ds_read_b128 a[136:139], v13 offset:63488
    v_mfma_f32_16x16x32_bf16 v[180:183], v[64:67], v[248:251], 0
    v_mfma_f32_16x16x32_bf16 v[104:107], a[112:115], a[204:207], v[104:107]
    buffer_load_dwordx4 a[248:251], v8, s[20:23], s43 offen offset:0 sc1
    v_mfma_f32_16x16x32_bf16 v[196:199], v[68:71], v[252:255], 0
    v_mfma_f32_16x16x32_bf16 v[108:111], a[116:119], a[204:207], v[108:111]
    ds_read_b128 a[140:143], v13 offset:64512
    v_mfma_f32_16x16x32_bf16 v[188:191], v[60:63], v[252:255], 0
    v_mfma_f32_16x16x32_bf16 v[92:95], a[116:119], a[200:203], v[92:95]
    buffer_load_dwordx4 a[252:255], v8, s[20:23], s43 offen offset:1024 sc1
    v_mfma_f32_16x16x32_bf16 v[192:195], v[64:67], v[252:255], 0
    s_waitcnt lgkmcnt(4)
    v_mfma_f32_16x16x32_bf16 v[96:99], a[120:123], a[200:203], v[96:99]
    ds_read_b128 a[112:115], v216 offset:0
    v_add_f32 v160, s40, v160
    v_mfma_f32_16x16x32_bf16 v[112:115], a[120:123], a[204:207], v[112:115]
    v_add_f32 v172, s40, v172
    v_mfma_f32_16x16x32_bf16 v[116:119], a[124:127], a[204:207], v[116:119]
    ds_read_b128 a[116:119], v216 offset:1024
    v_add_f32 v184, s40, v184
    v_mfma_f32_16x16x32_bf16 v[100:103], a[124:127], a[200:203], v[100:103]
    s_mov_b32 s44, 0x580000
    s_add_u32 m0, s62, 0x4000
    s_nop 0
    buffer_load_dwordx4 v9, s[72:75], s44 offen offset:0 sc1 lds
    v_add_f32 v196, s40, v196
    s_waitcnt lgkmcnt(4)
    v_mfma_f32_16x16x32_bf16 v[120:123], a[128:131], a[200:203], v[120:123]
    ds_read_b128 a[120:123], v216 offset:2048
    v_rcp_f32 v160, v160
    v_mfma_f32_16x16x32_bf16 v[136:139], a[128:131], a[204:207], v[136:139]
    v_rcp_f32 v172, v172
    v_mfma_f32_16x16x32_bf16 v[140:143], a[132:135], a[204:207], v[140:143]
    ds_read_b128 a[124:127], v216 offset:3072
    v_rcp_f32 v184, v184
    v_mfma_f32_16x16x32_bf16 v[124:127], a[132:135], a[200:203], v[124:127]
    v_rcp_f32 v196, v196
    s_waitcnt lgkmcnt(4)
    v_mfma_f32_16x16x32_bf16 v[128:131], a[136:139], a[200:203], v[128:131]
    ds_read_b128 a[128:131], v216 offset:4096
    v_pk_mul_f32 v[152:153], v[152:153], v[160:161] op_sel_hi:[1,0]
    v_mfma_f32_16x16x32_bf16 v[144:147], a[136:139], a[204:207], v[144:147]
    v_pk_mul_f32 v[154:155], v[154:155], v[160:161] op_sel_hi:[1,0]
    v_mfma_f32_16x16x32_bf16 v[148:151], a[140:143], a[204:207], v[148:151]
    ds_read_b128 a[132:135], v216 offset:5120
    v_pk_mul_f32 v[156:157], v[156:157], v[160:161] op_sel_hi:[1,0]
    v_mfma_f32_16x16x32_bf16 v[132:135], a[140:143], a[200:203], v[132:135]
    buffer_load_dwordx4 v9, s[72:75], s44 offen offset:1024 sc1 lds
    v_pk_mul_f32 v[158:159], v[158:159], v[160:161] op_sel_hi:[1,0]
    s_waitcnt vmcnt(22) lgkmcnt(4)
    v_mfma_f32_16x16x32_bf16 v[88:91], a[112:115], a[208:211], v[88:91]
    ds_read_b128 a[136:139], v216 offset:6144
    v_cvt_pk_bf16_f32 v152, v152, v153
    v_mfma_f32_16x16x32_bf16 v[104:107], a[112:115], a[212:215], v[104:107]
    s_mov_b32 s43, 0xa80000
    buffer_load_dwordx4 a[144:147], v7, s[20:23], s43 offen offset:0 sc1
    v_cvt_pk_bf16_f32 v153, v154, v155
    v_mfma_f32_16x16x32_bf16 v[108:111], a[116:119], a[212:215], v[108:111]
    ds_read_b128 a[140:143], v216 offset:7168
    v_cvt_pk_bf16_f32 v154, v156, v157
    v_mfma_f32_16x16x32_bf16 v[92:95], a[116:119], a[208:211], v[92:95]
    buffer_load_dwordx4 a[148:151], v7, s[20:23], s43 offen offset:1024 sc1
    v_cvt_pk_bf16_f32 v155, v158, v159
    s_waitcnt lgkmcnt(4)
    v_mfma_f32_16x16x32_bf16 v[96:99], a[120:123], a[208:211], v[96:99]
    ds_read_b128 a[112:115], v216 offset:8192
    buffer_store_dwordx4 v[152:155], v1, s[20:23], s64 offen offset:0 sc1
    v_mfma_f32_16x16x32_bf16 v[112:115], a[120:123], a[212:215], v[112:115]
    v_pk_mul_f32 v[164:165], v[164:165], v[172:173] op_sel_hi:[1,0]
    v_mfma_f32_16x16x32_bf16 v[116:119], a[124:127], a[212:215], v[116:119]
    ds_read_b128 a[116:119], v216 offset:9216
    v_pk_mul_f32 v[166:167], v[166:167], v[172:173] op_sel_hi:[1,0]
    v_mfma_f32_16x16x32_bf16 v[100:103], a[124:127], a[208:211], v[100:103]
    buffer_load_dwordx4 v9, s[72:75], s44 offen offset:2048 sc1 lds
    v_pk_mul_f32 v[168:169], v[168:169], v[172:173] op_sel_hi:[1,0]
    s_waitcnt lgkmcnt(4)
    v_mfma_f32_16x16x32_bf16 v[120:123], a[128:131], a[208:211], v[120:123]
    ds_read_b128 a[120:123], v216 offset:10240
    v_pk_mul_f32 v[170:171], v[170:171], v[172:173] op_sel_hi:[1,0]
    v_mfma_f32_16x16x32_bf16 v[136:139], a[128:131], a[212:215], v[136:139]
    v_cvt_pk_bf16_f32 v164, v164, v165
    v_mfma_f32_16x16x32_bf16 v[140:143], a[132:135], a[212:215], v[140:143]
    ds_read_b128 a[124:127], v216 offset:11264
    v_cvt_pk_bf16_f32 v165, v166, v167
    v_mfma_f32_16x16x32_bf16 v[124:127], a[132:135], a[208:211], v[124:127]
    v_cvt_pk_bf16_f32 v166, v168, v169
    s_waitcnt lgkmcnt(4)
    v_mfma_f32_16x16x32_bf16 v[128:131], a[136:139], a[208:211], v[128:131]
    ds_read_b128 a[128:131], v216 offset:12288
    v_cvt_pk_bf16_f32 v167, v170, v171
    v_mfma_f32_16x16x32_bf16 v[144:147], a[136:139], a[212:215], v[144:147]
    buffer_store_dwordx4 v[164:167], v1, s[20:23], s64 offen offset:1024 sc1
    v_mfma_f32_16x16x32_bf16 v[148:151], a[140:143], a[212:215], v[148:151]
    ds_read_b128 a[132:135], v216 offset:13312
    v_pk_mul_f32 v[176:177], v[176:177], v[184:185] op_sel_hi:[1,0]
    v_mfma_f32_16x16x32_bf16 v[132:135], a[140:143], a[208:211], v[132:135]
    buffer_load_dwordx4 v9, s[72:75], s44 offen offset:3072 sc1 lds
    v_pk_mul_f32 v[178:179], v[178:179], v[184:185] op_sel_hi:[1,0]
    s_waitcnt vmcnt(24) lgkmcnt(4)
    v_mfma_f32_16x16x32_bf16 v[88:91], a[112:115], a[216:219], v[88:91]
    ds_read_b128 a[136:139], v216 offset:14336
    v_pk_mul_f32 v[180:181], v[180:181], v[184:185] op_sel_hi:[1,0]
    v_mfma_f32_16x16x32_bf16 v[104:107], a[112:115], a[220:223], v[104:107]
    buffer_load_dwordx4 a[152:155], v8, s[20:23], s43 offen offset:0 sc1
    v_pk_mul_f32 v[182:183], v[182:183], v[184:185] op_sel_hi:[1,0]
    v_mfma_f32_16x16x32_bf16 v[108:111], a[116:119], a[220:223], v[108:111]
    ds_read_b128 a[140:143], v216 offset:15360
    v_cvt_pk_bf16_f32 v176, v176, v177
    v_mfma_f32_16x16x32_bf16 v[92:95], a[116:119], a[216:219], v[92:95]
    buffer_load_dwordx4 a[156:159], v8, s[20:23], s43 offen offset:1024 sc1
    v_cvt_pk_bf16_f32 v177, v178, v179
    s_waitcnt vmcnt(20) lgkmcnt(4)
    s_barrier
    v_mfma_f32_16x16x32_bf16 v[96:99], a[120:123], a[216:219], v[96:99]
    ds_read_b128 a[112:115], v216 offset:16384
    v_cvt_pk_bf16_f32 v178, v180, v181
    v_mfma_f32_16x16x32_bf16 v[112:115], a[120:123], a[220:223], v[112:115]
    v_cvt_pk_bf16_f32 v179, v182, v183
    v_mfma_f32_16x16x32_bf16 v[116:119], a[124:127], a[220:223], v[116:119]
    ds_read_b128 a[116:119], v216 offset:17408
    buffer_store_dwordx4 v[176:179], v1, s[20:23], s64 offen offset:2048 sc1
    v_mfma_f32_16x16x32_bf16 v[100:103], a[124:127], a[216:219], v[100:103]
    s_mov_b32 s44, 0x5c0000
    s_add_u32 m0, s62, 0x8000
    s_nop 0
    buffer_load_dwordx4 v9, s[72:75], s44 offen offset:0 sc1 lds
    v_pk_mul_f32 v[188:189], v[188:189], v[196:197] op_sel_hi:[1,0]
    s_waitcnt lgkmcnt(4)
    v_mfma_f32_16x16x32_bf16 v[120:123], a[128:131], a[216:219], v[120:123]
    ds_read_b128 a[120:123], v216 offset:18432
    v_pk_mul_f32 v[190:191], v[190:191], v[196:197] op_sel_hi:[1,0]
    v_mfma_f32_16x16x32_bf16 v[136:139], a[128:131], a[220:223], v[136:139]
    v_pk_mul_f32 v[192:193], v[192:193], v[196:197] op_sel_hi:[1,0]
    v_mfma_f32_16x16x32_bf16 v[140:143], a[132:135], a[220:223], v[140:143]
    ds_read_b128 a[124:127], v216 offset:19456
    v_pk_mul_f32 v[194:195], v[194:195], v[196:197] op_sel_hi:[1,0]
    v_mfma_f32_16x16x32_bf16 v[124:127], a[132:135], a[216:219], v[124:127]
    v_cvt_pk_bf16_f32 v188, v188, v189
    s_waitcnt lgkmcnt(4)
    v_mfma_f32_16x16x32_bf16 v[128:131], a[136:139], a[216:219], v[128:131]
    ds_read_b128 a[128:131], v216 offset:20480
    v_cvt_pk_bf16_f32 v189, v190, v191
    v_mfma_f32_16x16x32_bf16 v[144:147], a[136:139], a[220:223], v[144:147]
    v_cvt_pk_bf16_f32 v190, v192, v193
    v_mfma_f32_16x16x32_bf16 v[148:151], a[140:143], a[220:223], v[148:151]
    ds_read_b128 a[132:135], v216 offset:21504
    v_cvt_pk_bf16_f32 v191, v194, v195
    v_mfma_f32_16x16x32_bf16 v[132:135], a[140:143], a[216:219], v[132:135]
    buffer_load_dwordx4 v9, s[72:75], s44 offen offset:1024 sc1 lds
    buffer_store_dwordx4 v[188:191], v1, s[20:23], s64 offen offset:3072 sc1
    s_waitcnt lgkmcnt(4)
    v_mfma_f32_16x16x32_bf16 v[88:91], a[112:115], a[224:227], v[88:91]
    ds_read_b128 a[136:139], v216 offset:22528
    v_mfma_f32_16x16x32_bf16 v[104:107], a[112:115], a[228:231], v[104:107]
    s_mov_b32 s43, 0xb00000
    buffer_load_dwordx4 a[160:163], v7, s[20:23], s43 offen offset:0 sc1
    v_mfma_f32_16x16x32_bf16 v[108:111], a[116:119], a[228:231], v[108:111]
    ds_read_b128 a[140:143], v216 offset:23552
    v_mfma_f32_16x16x32_bf16 v[92:95], a[116:119], a[224:227], v[92:95]
    buffer_load_dwordx4 a[164:167], v7, s[20:23], s43 offen offset:1024 sc1
    s_waitcnt lgkmcnt(4)
    v_mfma_f32_16x16x32_bf16 v[96:99], a[120:123], a[224:227], v[96:99]
    ds_read_b128 a[112:115], v216 offset:24576
    v_mfma_f32_16x16x32_bf16 v[112:115], a[120:123], a[228:231], v[112:115]
    v_mfma_f32_16x16x32_bf16 v[116:119], a[124:127], a[228:231], v[116:119]
    ds_read_b128 a[116:119], v216 offset:25600
    v_mfma_f32_16x16x32_bf16 v[100:103], a[124:127], a[224:227], v[100:103]
    buffer_load_dwordx4 v9, s[72:75], s44 offen offset:2048 sc1 lds
    s_waitcnt lgkmcnt(4)
    v_mfma_f32_16x16x32_bf16 v[120:123], a[128:131], a[224:227], v[120:123]
    ds_read_b128 a[120:123], v216 offset:26624
    v_mfma_f32_16x16x32_bf16 v[136:139], a[128:131], a[228:231], v[136:139]
    v_mfma_f32_16x16x32_bf16 v[140:143], a[132:135], a[228:231], v[140:143]
    ds_read_b128 a[124:127], v216 offset:27648
    v_mfma_f32_16x16x32_bf16 v[124:127], a[132:135], a[224:227], v[124:127]
    s_waitcnt lgkmcnt(4)
    v_mfma_f32_16x16x32_bf16 v[128:131], a[136:139], a[224:227], v[128:131]
    ds_read_b128 a[128:131], v216 offset:28672
    v_mfma_f32_16x16x32_bf16 v[144:147], a[136:139], a[228:231], v[144:147]
    v_mfma_f32_16x16x32_bf16 v[148:151], a[140:143], a[228:231], v[148:151]
    ds_read_b128 a[132:135], v216 offset:29696
    v_mfma_f32_16x16x32_bf16 v[132:135], a[140:143], a[224:227], v[132:135]
    buffer_load_dwordx4 v9, s[72:75], s44 offen offset:3072 sc1 lds
    s_waitcnt vmcnt(26) lgkmcnt(4)
    v_mfma_f32_16x16x32_bf16 v[88:91], a[112:115], a[232:235], v[88:91]
    ds_read_b128 a[136:139], v216 offset:30720
    v_mfma_f32_16x16x32_bf16 v[104:107], a[112:115], a[236:239], v[104:107]
    buffer_load_dwordx4 a[168:171], v8, s[20:23], s43 offen offset:0 sc1
    v_mfma_f32_16x16x32_bf16 v[108:111], a[116:119], a[236:239], v[108:111]
    ds_read_b128 a[140:143], v216 offset:31744
    v_mfma_f32_16x16x32_bf16 v[92:95], a[116:119], a[232:235], v[92:95]
    buffer_load_dwordx4 a[172:175], v8, s[20:23], s43 offen offset:1024 sc1
    s_waitcnt lgkmcnt(4)
    v_mfma_f32_16x16x32_bf16 v[96:99], a[120:123], a[232:235], v[96:99]
    ds_read_b128 a[112:115], v216 offset:32768
    v_mfma_f32_16x16x32_bf16 v[112:115], a[120:123], a[236:239], v[112:115]
    v_mfma_f32_16x16x32_bf16 v[116:119], a[124:127], a[236:239], v[116:119]
    ds_read_b128 a[116:119], v216 offset:33792
    v_mfma_f32_16x16x32_bf16 v[100:103], a[124:127], a[232:235], v[100:103]
    s_mov_b32 s44, 0x600000
    s_add_u32 m0, s62, 0xc000
    s_nop 0
    buffer_load_dwordx4 v9, s[72:75], s44 offen offset:0 sc1 lds
    s_waitcnt lgkmcnt(4)
    v_mfma_f32_16x16x32_bf16 v[120:123], a[128:131], a[232:235], v[120:123]
    ds_read_b128 a[120:123], v216 offset:34816
    v_mfma_f32_16x16x32_bf16 v[136:139], a[128:131], a[236:239], v[136:139]
    v_mfma_f32_16x16x32_bf16 v[140:143], a[132:135], a[236:239], v[140:143]
    ds_read_b128 a[124:127], v216 offset:35840
    v_mfma_f32_16x16x32_bf16 v[124:127], a[132:135], a[232:235], v[124:127]
    s_waitcnt lgkmcnt(4)
    v_mfma_f32_16x16x32_bf16 v[128:131], a[136:139], a[232:235], v[128:131]
    ds_read_b128 a[128:131], v216 offset:36864
    v_mfma_f32_16x16x32_bf16 v[144:147], a[136:139], a[236:239], v[144:147]
    v_mfma_f32_16x16x32_bf16 v[148:151], a[140:143], a[236:239], v[148:151]
    ds_read_b128 a[132:135], v216 offset:37888
    v_mfma_f32_16x16x32_bf16 v[132:135], a[140:143], a[232:235], v[132:135]
    buffer_load_dwordx4 v9, s[72:75], s44 offen offset:1024 sc1 lds
    s_waitcnt vmcnt(26) lgkmcnt(4)
    v_mfma_f32_16x16x32_bf16 v[88:91], a[112:115], a[240:243], v[88:91]
    ds_read_b128 a[136:139], v216 offset:38912
    v_mfma_f32_16x16x32_bf16 v[104:107], a[112:115], a[244:247], v[104:107]
    s_mov_b32 s43, 0xb80000
    buffer_load_dwordx4 a[176:179], v7, s[20:23], s43 offen offset:0 sc1
    v_mfma_f32_16x16x32_bf16 v[108:111], a[116:119], a[244:247], v[108:111]
    ds_read_b128 a[140:143], v216 offset:39936
    v_mfma_f32_16x16x32_bf16 v[92:95], a[116:119], a[240:243], v[92:95]
    buffer_load_dwordx4 a[180:183], v7, s[20:23], s43 offen offset:1024 sc1
    s_waitcnt lgkmcnt(4)
    v_mfma_f32_16x16x32_bf16 v[96:99], a[120:123], a[240:243], v[96:99]
    ds_read_b128 a[112:115], v216 offset:40960
    v_mfma_f32_16x16x32_bf16 v[112:115], a[120:123], a[244:247], v[112:115]
    v_mfma_f32_16x16x32_bf16 v[116:119], a[124:127], a[244:247], v[116:119]
    ds_read_b128 a[116:119], v216 offset:41984
    v_mfma_f32_16x16x32_bf16 v[100:103], a[124:127], a[240:243], v[100:103]
    buffer_load_dwordx4 v9, s[72:75], s44 offen offset:2048 sc1 lds
    s_waitcnt lgkmcnt(4)
    v_mfma_f32_16x16x32_bf16 v[120:123], a[128:131], a[240:243], v[120:123]
    ds_read_b128 a[120:123], v216 offset:43008
    v_mfma_f32_16x16x32_bf16 v[136:139], a[128:131], a[244:247], v[136:139]
    v_mfma_f32_16x16x32_bf16 v[140:143], a[132:135], a[244:247], v[140:143]
    ds_read_b128 a[124:127], v216 offset:44032
    v_mfma_f32_16x16x32_bf16 v[124:127], a[132:135], a[240:243], v[124:127]
    s_waitcnt lgkmcnt(4)
    v_mfma_f32_16x16x32_bf16 v[128:131], a[136:139], a[240:243], v[128:131]
    ds_read_b128 a[128:131], v216 offset:45056
    v_mfma_f32_16x16x32_bf16 v[144:147], a[136:139], a[244:247], v[144:147]
    v_mfma_f32_16x16x32_bf16 v[148:151], a[140:143], a[244:247], v[148:151]
    ds_read_b128 a[132:135], v216 offset:46080
    v_mfma_f32_16x16x32_bf16 v[132:135], a[140:143], a[240:243], v[132:135]
    buffer_load_dwordx4 v9, s[72:75], s44 offen offset:3072 sc1 lds
    s_waitcnt vmcnt(26) lgkmcnt(4)
    v_mfma_f32_16x16x32_bf16 v[88:91], a[112:115], a[248:251], v[88:91]
    ds_read_b128 a[136:139], v216 offset:47104
    v_mfma_f32_16x16x32_bf16 v[104:107], a[112:115], a[252:255], v[104:107]
    buffer_load_dwordx4 a[184:187], v8, s[20:23], s43 offen offset:0 sc1
    v_mfma_f32_16x16x32_bf16 v[108:111], a[116:119], a[252:255], v[108:111]
    ds_read_b128 a[140:143], v216 offset:48128
    v_mfma_f32_16x16x32_bf16 v[92:95], a[116:119], a[248:251], v[92:95]
    buffer_load_dwordx4 a[188:191], v8, s[20:23], s43 offen offset:1024 sc1
    s_cmp_eq_u32 s48, 0
    s_cbranch_scc0 M_nc329
    s_mov_b32 s91, 0
M_pc12:
    v_xor_b32 v14, s12, v18
    v_bfe_u32 v15, v19, 4, 1
    v_xor_b32 v15, 1, v15
    v_or_b32 v14, v14, v15
    v_cmp_ne_u32 vcc, 0, v14
    s_nop 3
    s_cmp_eq_u32 vcc_lo, 0
    s_cbranch_scc1 M_pc12_ok
    s_add_u32 s91, s91, 1
    s_cmp_ge_u32 s91, 0x40000
    s_cbranch_scc1 M_pc12_ok
    s_sleep 8
    buffer_load_dwordx2 v[18:19], v17, s[92:95], 0 offen sc1
    s_waitcnt vmcnt(0)
    s_branch M_pc12
M_pc12_ok:
M_nc329:
    s_waitcnt vmcnt(14) lgkmcnt(4)
    s_barrier
    s_cmp_eq_u32 s48, 0
    s_cbranch_scc0 M_fs13
    v_mov_b32 v14, s12
    v_mov_b32 v15, 127
    s_mov_b64 exec, 1
    buffer_store_dwordx2 v[14:15], off, s[92:95], s90 sc1
    s_mov_b64 exec, -1
M_fs13:
    v_mfma_f32_16x16x32_bf16 v[96:99], a[120:123], a[248:251], v[96:99]
    ds_read_b128 a[112:115], v13 offset:0
    v_mfma_f32_16x16x32_bf16 v[112:115], a[120:123], a[252:255], v[112:115]
    v_mfma_f32_16x16x32_bf16 v[116:119], a[124:127], a[252:255], v[116:119]
    ds_read_b128 a[116:119], v13 offset:1024
    v_mfma_f32_16x16x32_bf16 v[100:103], a[124:127], a[248:251], v[100:103]
    s_mov_b32 s44, 0x640000
    s_add_u32 m0, s62, 0x10000
    s_nop 0
    buffer_load_dwordx4 v9, s[72:75], s44 offen offset:0 sc1 lds
    s_waitcnt lgkmcnt(4)
    v_mfma_f32_16x16x32_bf16 v[120:123], a[128:131], a[248:251], v[120:123]
    ds_read_b128 a[120:123], v13 offset:2048
    v_mfma_f32_16x16x32_bf16 v[136:139], a[128:131], a[252:255], v[136:139]
    v_mfma_f32_16x16x32_bf16 v[140:143], a[132:135], a[252:255], v[140:143]
    ds_read_b128 a[124:127], v13 offset:3072
    v_mfma_f32_16x16x32_bf16 v[124:127], a[132:135], a[248:251], v[124:127]
    s_waitcnt lgkmcnt(4)
    v_mfma_f32_16x16x32_bf16 v[128:131], a[136:139], a[248:251], v[128:131]
    ds_read_b128 a[128:131], v13 offset:4096
    v_mfma_f32_16x16x32_bf16 v[144:147], a[136:139], a[252:255], v[144:147]
    v_mfma_f32_16x16x32_bf16 v[148:151], a[140:143], a[252:255], v[148:151]
    ds_read_b128 a[132:135], v13 offset:5120
    v_mfma_f32_16x16x32_bf16 v[132:135], a[140:143], a[248:251], v[132:135]
    buffer_load_dwordx4 v9, s[72:75], s44 offen offset:1024 sc1 lds
    s_waitcnt lgkmcnt(4)
    v_mfma_f32_16x16x32_bf16 v[88:91], a[112:115], a[144:147], v[88:91]
    ds_read_b128 a[136:139], v13 offset:6144
    v_mfma_f32_16x16x32_bf16 v[104:107], a[112:115], a[148:151], v[104:107]
    s_mov_b32 s43, 0xc00000
    buffer_load_dwordx4 a[192:195], v7, s[20:23], s43 offen offset:0 sc1
    v_mfma_f32_16x16x32_bf16 v[108:111], a[116:119], a[148:151], v[108:111]
    ds_read_b128 a[140:143], v13 offset:7168
    v_mfma_f32_16x16x32_bf16 v[92:95], a[116:119], a[144:147], v[92:95]
    buffer_load_dwordx4 a[196:199], v7, s[20:23], s43 offen offset:1024 sc1
    s_waitcnt lgkmcnt(4)
    v_mfma_f32_16x16x32_bf16 v[96:99], a[120:123], a[144:147], v[96:99]
    ds_read_b128 a[112:115], v13 offset:8192
    v_mfma_f32_16x16x32_bf16 v[112:115], a[120:123], a[148:151], v[112:115]
    v_mfma_f32_16x16x32_bf16 v[116:119], a[124:127], a[148:151], v[116:119]
    ds_read_b128 a[116:119], v13 offset:9216
    v_mfma_f32_16x16x32_bf16 v[100:103], a[124:127], a[144:147], v[100:103]
    buffer_load_dwordx4 v9, s[72:75], s44 offen offset:2048 sc1 lds
    s_waitcnt lgkmcnt(4)
    v_mfma_f32_16x16x32_bf16 v[120:123], a[128:131], a[144:147], v[120:123]
    ds_read_b128 a[120:123], v13 offset:10240
    v_mfma_f32_16x16x32_bf16 v[136:139], a[128:131], a[148:151], v[136:139]
    v_mfma_f32_16x16x32_bf16 v[140:143], a[132:135], a[148:151], v[140:143]
    ds_read_b128 a[124:127], v13 offset:11264
    v_mfma_f32_16x16x32_bf16 v[124:127], a[132:135], a[144:147], v[124:127]
    s_waitcnt lgkmcnt(4)
    v_mfma_f32_16x16x32_bf16 v[128:131], a[136:139], a[144:147], v[128:131]
    ds_read_b128 a[128:131], v13 offset:12288
    v_mfma_f32_16x16x32_bf16 v[144:147], a[136:139], a[148:151], v[144:147]
    v_mfma_f32_16x16x32_bf16 v[148:151], a[140:143], a[148:151], v[148:151]
    ds_read_b128 a[132:135], v13 offset:13312
    v_mfma_f32_16x16x32_bf16 v[132:135], a[140:143], a[144:147], v[132:135]
    buffer_load_dwordx4 v9, s[72:75], s44 offen offset:3072 sc1 lds
    s_waitcnt lgkmcnt(4)
    v_mfma_f32_16x16x32_bf16 v[88:91], a[112:115], a[152:155], v[88:91]
    ds_read_b128 a[136:139], v13 offset:14336
    v_mfma_f32_16x16x32_bf16 v[104:107], a[112:115], a[156:159], v[104:107]
    buffer_load_dwordx4 a[200:203], v8, s[20:23], s43 offen offset:0 sc1
    v_mfma_f32_16x16x32_bf16 v[108:111], a[116:119], a[156:159], v[108:111]
    ds_read_b128 a[140:143], v13 offset:15360
    v_mfma_f32_16x16x32_bf16 v[92:95], a[116:119], a[152:155], v[92:95]
    buffer_load_dwordx4 a[204:207], v8, s[20:23], s43 offen offset:1024 sc1
    s_waitcnt lgkmcnt(4)
    v_mfma_f32_16x16x32_bf16 v[96:99], a[120:123], a[152:155], v[96:99]
    ds_read_b128 a[112:115], v13 offset:16384
    v_mfma_f32_16x16x32_bf16 v[112:115], a[120:123], a[156:159], v[112:115]
    v_mfma_f32_16x16x32_bf16 v[116:119], a[124:127], a[156:159], v[116:119]
    ds_read_b128 a[116:119], v13 offset:17408
    v_mfma_f32_16x16x32_bf16 v[100:103], a[124:127], a[152:155], v[100:103]
    s_mov_b32 s44, 0x680000
    s_add_u32 m0, s62, 0x14000
    s_nop 0
    buffer_load_dwordx4 v9, s[72:75], s44 offen offset:0 sc1 lds
    s_waitcnt lgkmcnt(4)
    v_mfma_f32_16x16x32_bf16 v[120:123], a[128:131], a[152:155], v[120:123]
    ds_read_b128 a[120:123], v13 offset:18432
    v_mfma_f32_16x16x32_bf16 v[136:139], a[128:131], a[156:159], v[136:139]
    v_mfma_f32_16x16x32_bf16 v[140:143], a[132:135], a[156:159], v[140:143]
    ds_read_b128 a[124:127], v13 offset:19456
    v_mfma_f32_16x16x32_bf16 v[124:127], a[132:135], a[152:155], v[124:127]
    s_waitcnt lgkmcnt(4)
    v_mfma_f32_16x16x32_bf16 v[128:131], a[136:139], a[152:155], v[128:131]
    ds_read_b128 a[128:131], v13 offset:20480
    v_mfma_f32_16x16x32_bf16 v[144:147], a[136:139], a[156:159], v[144:147]
    v_mfma_f32_16x16x32_bf16 v[148:151], a[140:143], a[156:159], v[148:151]
    ds_read_b128 a[132:135], v13 offset:21504
    v_mfma_f32_16x16x32_bf16 v[132:135], a[140:143], a[152:155], v[132:135]
    buffer_load_dwordx4 v9, s[72:75], s44 offen offset:1024 sc1 lds
    s_waitcnt vmcnt(22) lgkmcnt(4)
    v_mfma_f32_16x16x32_bf16 v[88:91], a[112:115], a[160:163], v[88:91]
    ds_read_b128 a[136:139], v13 offset:22528
    v_mfma_f32_16x16x32_bf16 v[104:107], a[112:115], a[164:167], v[104:107]
    s_mov_b32 s43, 0xc80000
    buffer_load_dwordx4 a[208:211], v7, s[20:23], s43 offen offset:0 sc1
    v_pk_mov_b32 v[24:25], 0, 0
    v_mfma_f32_16x16x32_bf16 v[108:111], a[116:119], a[164:167], v[108:111]
    ds_read_b128 a[140:143], v13 offset:23552
    v_mfma_f32_16x16x32_bf16 v[92:95], a[116:119], a[160:163], v[92:95]
    buffer_load_dwordx4 a[212:215], v7, s[20:23], s43 offen offset:1024 sc1
    v_pk_mov_b32 v[26:27], 0, 0
    s_waitcnt lgkmcnt(4)
    v_mfma_f32_16x16x32_bf16 v[96:99], a[120:123], a[160:163], v[96:99]
    ds_read_b128 a[112:115], v13 offset:24576
    v_mfma_f32_16x16x32_bf16 v[112:115], a[120:123], a[164:167], v[112:115]
    v_pk_mov_b32 v[28:29], 0, 0
    v_mfma_f32_16x16x32_bf16 v[116:119], a[124:127], a[164:167], v[116:119]
    ds_read_b128 a[116:119], v13 offset:25600
    v_mfma_f32_16x16x32_bf16 v[100:103], a[124:127], a[160:163], v[100:103]
    buffer_load_dwordx4 v9, s[72:75], s44 offen offset:2048 sc1 lds
    v_pk_mov_b32 v[30:31], 0, 0
    s_waitcnt lgkmcnt(4)
    v_mfma_f32_16x16x32_bf16 v[120:123], a[128:131], a[160:163], v[120:123]
    ds_read_b128 a[120:123], v13 offset:26624
    v_mfma_f32_16x16x32_bf16 v[136:139], a[128:131], a[164:167], v[136:139]
    v_pk_mov_b32 v[32:33], 0, 0
    v_mfma_f32_16x16x32_bf16 v[140:143], a[132:135], a[164:167], v[140:143]
    ds_read_b128 a[124:127], v13 offset:27648
    v_mfma_f32_16x16x32_bf16 v[124:127], a[132:135], a[160:163], v[124:127]
    v_pk_mov_b32 v[34:35], 0, 0
    s_waitcnt lgkmcnt(4)
    v_mfma_f32_16x16x32_bf16 v[128:131], a[136:139], a[160:163], v[128:131]
    ds_read_b128 a[128:131], v13 offset:28672
    v_mfma_f32_16x16x32_bf16 v[144:147], a[136:139], a[164:167], v[144:147]
    v_pk_mov_b32 v[36:37], 0, 0
    v_mfma_f32_16x16x32_bf16 v[148:151], a[140:143], a[164:167], v[148:151]
    ds_read_b128 a[132:135], v13 offset:29696
    v_mfma_f32_16x16x32_bf16 v[132:135], a[140:143], a[160:163], v[132:135]
    buffer_load_dwordx4 v9, s[72:75], s44 offen offset:3072 sc1 lds
    v_pk_mov_b32 v[38:39], 0, 0
    s_waitcnt vmcnt(22) lgkmcnt(4)
    v_mfma_f32_16x16x32_bf16 v[88:91], a[112:115], a[168:171], v[88:91]
    ds_read_b128 a[136:139], v13 offset:30720
    v_mfma_f32_16x16x32_bf16 v[104:107], a[112:115], a[172:175], v[104:107]
    buffer_load_dwordx4 a[216:219], v8, s[20:23], s43 offen offset:0 sc1
    v_pk_mov_b32 v[40:41], 0, 0
    v_mfma_f32_16x16x32_bf16 v[108:111], a[116:119], a[172:175], v[108:111]
    ds_read_b128 a[140:143], v13 offset:31744
    v_mfma_f32_16x16x32_bf16 v[92:95], a[116:119], a[168:171], v[92:95]
    buffer_load_dwordx4 a[220:223], v8, s[20:23], s43 offen offset:1024 sc1
    v_pk_mov_b32 v[42:43], 0, 0
    s_waitcnt vmcnt(18) lgkmcnt(4)
    s_barrier
    v_mfma_f32_16x16x32_bf16 v[96:99], a[120:123], a[168:171], v[96:99]
    ds_read_b128 a[112:115], v13 offset:32768
    v_mfma_f32_16x16x32_bf16 v[112:115], a[120:123], a[172:175], v[112:115]
    v_pk_mov_b32 v[44:45], 0, 0
    v_mfma_f32_16x16x32_bf16 v[116:119], a[124:127], a[172:175], v[116:119]
    ds_read_b128 a[116:119], v13 offset:33792
    v_mfma_f32_16x16x32_bf16 v[100:103], a[124:127], a[168:171], v[100:103]
    s_mov_b32 s44, 0x6c0000
    s_add_u32 m0, s62, 0x18000
    s_nop 0
    buffer_load_dwordx4 v9, s[72:75], s44 offen offset:0 sc1 lds
    v_pk_mov_b32 v[46:47], 0, 0
    s_waitcnt lgkmcnt(4)
    v_mfma_f32_16x16x32_bf16 v[120:123], a[128:131], a[168:171], v[120:123]
    ds_read_b128 a[120:123], v13 offset:34816
    v_mfma_f32_16x16x32_bf16 v[136:139], a[128:131], a[172:175], v[136:139]
    v_pk_mov_b32 v[48:49], 0, 0
    v_mfma_f32_16x16x32_bf16 v[140:143], a[132:135], a[172:175], v[140:143]
    ds_read_b128 a[124:127], v13 offset:35840
    v_mfma_f32_16x16x32_bf16 v[124:127], a[132:135], a[168:171], v[124:127]
    v_pk_mov_b32 v[50:51], 0, 0
    s_waitcnt lgkmcnt(4)
    v_mfma_f32_16x16x32_bf16 v[128:131], a[136:139], a[168:171], v[128:131]
    ds_read_b128 a[128:131], v13 offset:36864
    v_mfma_f32_16x16x32_bf16 v[144:147], a[136:139], a[172:175], v[144:147]
    v_pk_mov_b32 v[52:53], 0, 0
    v_mfma_f32_16x16x32_bf16 v[148:151], a[140:143], a[172:175], v[148:151]
    ds_read_b128 a[132:135], v13 offset:37888
    v_mfma_f32_16x16x32_bf16 v[132:135], a[140:143], a[168:171], v[132:135]
    buffer_load_dwordx4 v9, s[72:75], s44 offen offset:1024 sc1 lds
    v_pk_mov_b32 v[54:55], 0, 0
    s_waitcnt lgkmcnt(4)
    v_mfma_f32_16x16x32_bf16 v[88:91], a[112:115], a[176:179], v[88:91]
    ds_read_b128 a[136:139], v13 offset:38912
    v_mfma_f32_16x16x32_bf16 v[104:107], a[112:115], a[180:183], v[104:107]
    s_mov_b32 s43, 0xd00000
    buffer_load_dwordx4 a[224:227], v7, s[20:23], s43 offen offset:0 sc1
    v_mfma_f32_16x16x32_bf16 v[108:111], a[116:119], a[180:183], v[108:111]
    ds_read_b128 a[140:143], v13 offset:39936
    v_mfma_f32_16x16x32_bf16 v[92:95], a[116:119], a[176:179], v[92:95]
    buffer_load_dwordx4 a[228:231], v7, s[20:23], s43 offen offset:1024 sc1
    ds_read_b128 v[72:75], v217 offset:0
    s_waitcnt lgkmcnt(5)
    v_mfma_f32_16x16x32_bf16 v[96:99], a[120:123], a[176:179], v[96:99]
    ds_read_b128 a[112:115], v13 offset:40960
    v_mfma_f32_16x16x32_bf16 v[112:115], a[120:123], a[180:183], v[112:115]
    ds_read_b128 v[76:79], v218 offset:0
    v_mfma_f32_16x16x32_bf16 v[116:119], a[124:127], a[180:183], v[116:119]
    ds_read_b128 a[116:119], v13 offset:41984
    v_mfma_f32_16x16x32_bf16 v[100:103], a[124:127], a[176:179], v[100:103]
    buffer_load_dwordx4 v9, s[72:75], s44 offen offset:2048 sc1 lds
    ds_read_b128 v[80:83], v217 offset:2048
    s_waitcnt lgkmcnt(7)
    v_mfma_f32_16x16x32_bf16 v[120:123], a[128:131], a[176:179], v[120:123]
    ds_read_b128 a[120:123], v13 offset:43008
    v_mfma_f32_16x16x32_bf16 v[136:139], a[128:131], a[180:183], v[136:139]
    ds_read_b128 v[84:87], v218 offset:2048
    v_mfma_f32_16x16x32_bf16 v[140:143], a[132:135], a[180:183], v[140:143]
    ds_read_b128 a[124:127], v13 offset:44032
    v_mfma_f32_16x16x32_bf16 v[124:127], a[132:135], a[176:179], v[124:127]
    s_waitcnt lgkmcnt(8)
    v_mfma_f32_16x16x32_bf16 v[128:131], a[136:139], a[176:179], v[128:131]
    ds_read_b128 a[128:131], v13 offset:45056
    v_mfma_f32_16x16x32_bf16 v[144:147], a[136:139], a[180:183], v[144:147]
    s_cmp_eq_u32 s48, 0
    s_cbranch_scc0 M_np393
    buffer_load_dwordx2 v[18:19], v17, s[92:95], 0 offen sc1
M_np393:
    v_mfma_f32_16x16x32_bf16 v[148:151], a[140:143], a[180:183], v[148:151]
    ds_read_b128 a[132:135], v13 offset:46080
    v_mfma_f32_16x16x32_bf16 v[132:135], a[140:143], a[176:179], v[132:135]
    buffer_load_dwordx4 v9, s[72:75], s44 offen offset:3072 sc1 lds
    s_waitcnt vmcnt(22) lgkmcnt(6)
    v_mfma_f32_16x16x32_bf16 v[88:91], a[112:115], a[184:187], v[88:91]
    ds_read_b128 a[136:139], v13 offset:47104
    v_mfma_f32_16x16x32_bf16 v[104:107], a[112:115], a[188:191], v[104:107]
    buffer_load_dwordx4 a[232:235], v8, s[20:23], s43 offen offset:0 sc1
    v_mfma_f32_16x16x32_bf16 v[108:111], a[116:119], a[188:191], v[108:111]
    ds_read_b128 a[140:143], v13 offset:48128
    v_mfma_f32_16x16x32_bf16 v[92:95], a[116:119], a[184:187], v[92:95]
    buffer_load_dwordx4 a[236:239], v8, s[20:23], s43 offen offset:1024 sc1
    s_waitcnt lgkmcnt(4)
    v_mfma_f32_16x16x32_bf16 v[96:99], a[120:123], a[184:187], v[96:99]
    ds_read_b128 a[112:115], v13 offset:49152
    v_mfma_f32_16x16x32_bf16 v[112:115], a[120:123], a[188:191], v[112:115]
    v_mfma_f32_16x16x32_bf16 v[116:119], a[124:127], a[188:191], v[116:119]
    ds_read_b128 a[116:119], v13 offset:50176
    v_mfma_f32_16x16x32_bf16 v[100:103], a[124:127], a[184:187], v[100:103]
    s_mov_b32 s44, 0x700000
    s_add_u32 m0, s62, 0x0
    s_nop 0
    buffer_load_dwordx4 v6, s[72:75], s44 offen offset:0 sc1 lds
    s_waitcnt lgkmcnt(4)
    v_mfma_f32_16x16x32_bf16 v[120:123], a[128:131], a[184:187], v[120:123]
    ds_read_b128 a[120:123], v13 offset:51200
    v_mfma_f32_16x16x32_bf16 v[136:139], a[128:131], a[188:191], v[136:139]
    v_mfma_f32_16x16x32_bf16 v[140:143], a[132:135], a[188:191], v[140:143]
    ds_read_b128 a[124:127], v13 offset:52224
    v_mfma_f32_16x16x32_bf16 v[124:127], a[132:135], a[184:187], v[124:127]
    s_waitcnt lgkmcnt(4)
    v_mfma_f32_16x16x32_bf16 v[128:131], a[136:139], a[184:187], v[128:131]
    ds_read_b128 a[128:131], v13 offset:53248
    v_mfma_f32_16x16x32_bf16 v[144:147], a[136:139], a[188:191], v[144:147]
    v_mfma_f32_16x16x32_bf16 v[148:151], a[140:143], a[188:191], v[148:151]
    ds_read_b128 a[132:135], v13 offset:54272
    v_mfma_f32_16x16x32_bf16 v[132:135], a[140:143], a[184:187], v[132:135]
    buffer_load_dwordx4 v6, s[72:75], s44 offen offset:1024 sc1 lds
    s_waitcnt vmcnt(22) lgkmcnt(4)
    v_mfma_f32_16x16x32_bf16 v[88:91], a[112:115], a[192:195], v[88:91]
    ds_read_b128 a[136:139], v13 offset:55296
    v_mfma_f32_16x16x32_bf16 v[104:107], a[112:115], a[196:199], v[104:107]
    s_mov_b32 s43, 0xd80000
    buffer_load_dwordx4 a[240:243], v7, s[20:23], s43 offen offset:0 sc1
    v_mfma_f32_16x16x32_bf16 v[108:111], a[116:119], a[196:199], v[108:111]
    ds_read_b128 a[140:143], v13 offset:56320
    v_mfma_f32_16x16x32_bf16 v[92:95], a[116:119], a[192:195], v[92:95]
    buffer_load_dwordx4 a[244:247], v7, s[20:23], s43 offen offset:1024 sc1
    v_lshlrev_b32 v184, 16, v72
    s_waitcnt lgkmcnt(4)
    v_mfma_f32_16x16x32_bf16 v[96:99], a[120:123], a[192:195], v[96:99]
    ds_read_b128 a[112:115], v13 offset:57344
    v_mfma_f32_16x16x32_bf16 v[112:115], a[120:123], a[196:199], v[112:115]
    v_and_b32 v185, 0xffff0000, v72
    v_mfma_f32_16x16x32_bf16 v[116:119], a[124:127], a[196:199], v[116:119]
    ds_read_b128 a[116:119], v13 offset:58368
    v_mfma_f32_16x16x32_bf16 v[100:103], a[124:127], a[192:195], v[100:103]
    buffer_load_dwordx4 v6, s[72:75], s44 offen offset:2048 sc1 lds
    v_lshlrev_b32 v186, 16, v73
    s_waitcnt lgkmcnt(4)
    v_mfma_f32_16x16x32_bf16 v[120:123], a[128:131], a[192:195], v[120:123]
    ds_read_b128 a[120:123], v13 offset:59392
    v_mfma_f32_16x16x32_bf16 v[136:139], a[128:131], a[196:199], v[136:139]
    v_and_b32 v187, 0xffff0000, v73
    v_mfma_f32_16x16x32_bf16 v[140:143], a[132:135], a[196:199], v[140:143]
    ds_read_b128 a[124:127], v13 offset:60416
    v_mfma_f32_16x16x32_bf16 v[124:127], a[132:135], a[192:195], v[124:127]
    v_lshlrev_b32 v188, 16, v74
    s_waitcnt lgkmcnt(4)
    v_mfma_f32_16x16x32_bf16 v[128:131], a[136:139], a[192:195], v[128:131]
    ds_read_b128 a[128:131], v13 offset:61440
    v_mfma_f32_16x16x32_bf16 v[144:147], a[136:139], a[196:199], v[144:147]
    v_and_b32 v189, 0xffff0000, v74
    v_mfma_f32_16x16x32_bf16 v[148:151], a[140:143], a[196:199], v[148:151]
    ds_read_b128 a[132:135], v13 offset:62464
    v_mfma_f32_16x16x32_bf16 v[132:135], a[140:143], a[192:195], v[132:135]
    buffer_load_dwordx4 v6, s[72:75], s44 offen offset:3072 sc1 lds
    v_lshlrev_b32 v190, 16, v75
    s_waitcnt vmcnt(22) lgkmcnt(4)
    v_mfma_f32_16x16x32_bf16 v[88:91], a[112:115], a[200:203], v[88:91]
    ds_read_b128 a[136:139], v13 offset:63488
    v_mfma_f32_16x16x32_bf16 v[104:107], a[112:115], a[204:207], v[104:107]
    buffer_load_dwordx4 a[248:251], v8, s[20:23], s43 offen offset:0 sc1
    v_and_b32 v191, 0xffff0000, v75
    v_mfma_f32_16x16x32_bf16 v[108:111], a[116:119], a[204:207], v[108:111]
    ds_read_b128 a[140:143], v13 offset:64512
    v_mfma_f32_16x16x32_bf16 v[92:95], a[116:119], a[200:203], v[92:95]
    buffer_load_dwordx4 a[252:255], v8, s[20:23], s43 offen offset:1024 sc1
    v_lshlrev_b32 v192, 16, v76
    s_cmp_eq_u32 s48, 0
    s_cbranch_scc0 M_nc393
    s_waitcnt vmcnt(11)
    s_mov_b32 s91, 0
M_pc14:
    v_xor_b32 v14, s12, v18
    v_bfe_u32 v15, v19, 6, 1
    v_xor_b32 v15, 1, v15
    v_or_b32 v14, v14, v15
    v_cmp_ne_u32 vcc, 0, v14
    s_nop 3
    s_cmp_eq_u32 vcc_lo, 0
    s_cbranch_scc1 M_pc14_ok
    s_add_u32 s91, s91, 1
    s_cmp_ge_u32 s91, 0x40000
    s_cbranch_scc1 M_pc14_ok
    s_sleep 8
    buffer_load_dwordx2 v[18:19], v17, s[92:95], 0 offen sc1
    s_waitcnt vmcnt(0)
    s_branch M_pc14
M_pc14_ok:
    s_or_b32 s13, s2, s48
    s_cmp_eq_u32 s13, 0
    s_cbranch_scc0 M_nobump
    v_mov_b32 v14, s12
    s_mov_b32 s13, 4096
    s_mov_b64 exec, 1
    buffer_store_dword v14, off, s[92:95], s13 sc1
    s_mov_b64 exec, -1
M_nobump:
M_nc393:
    s_waitcnt vmcnt(18) lgkmcnt(4)
    s_barrier
    v_mfma_f32_16x16x32_bf16 v[96:99], a[120:123], a[200:203], v[96:99]
    ds_read_b128 a[112:115], v216 offset:0
    v_mfma_f32_16x16x32_bf16 v[112:115], a[120:123], a[204:207], v[112:115]
    v_and_b32 v193, 0xffff0000, v76
    v_mfma_f32_16x16x32_bf16 v[116:119], a[124:127], a[204:207], v[116:119]
    ds_read_b128 a[116:119], v216 offset:1024
    v_mfma_f32_16x16x32_bf16 v[100:103], a[124:127], a[200:203], v[100:103]
    s_mov_b32 s44, 0x740000
    s_add_u32 m0, s62, 0x4000
    s_nop 0
    buffer_load_dwordx4 v6, s[72:75], s44 offen offset:0 sc1 lds
    v_lshlrev_b32 v194, 16, v77
    s_waitcnt lgkmcnt(4)
    v_mfma_f32_16x16x32_bf16 v[120:123], a[128:131], a[200:203], v[120:123]
    ds_read_b128 a[120:123], v216 offset:2048
    v_mfma_f32_16x16x32_bf16 v[136:139], a[128:131], a[204:207], v[136:139]
    s_mov_b32 s43, 0xe00000
    buffer_load_dwordx4 a[144:147], v2, s[20:23], s43 offen offset:0 sc1
    v_and_b32 v195, 0xffff0000, v77
    v_mfma_f32_16x16x32_bf16 v[140:143], a[132:135], a[204:207], v[140:143]
    ds_read_b128 a[124:127], v216 offset:3072
    v_mfma_f32_16x16x32_bf16 v[124:127], a[132:135], a[200:203], v[124:127]
    buffer_load_dwordx4 a[148:151], v2, s[20:23], s43 offen offset:1024 sc1
    v_lshlrev_b32 v196, 16, v78
    s_waitcnt lgkmcnt(4)
    v_mfma_f32_16x16x32_bf16 v[128:131], a[136:139], a[200:203], v[128:131]
    ds_read_b128 a[128:131], v216 offset:4096
    v_mfma_f32_16x16x32_bf16 v[144:147], a[136:139], a[204:207], v[144:147]
    v_and_b32 v197, 0xffff0000, v78
    v_mfma_f32_16x16x32_bf16 v[148:151], a[140:143], a[204:207], v[148:151]
    ds_read_b128 a[132:135], v216 offset:5120
    v_mfma_f32_16x16x32_bf16 v[132:135], a[140:143], a[200:203], v[132:135]
    buffer_load_dwordx4 v6, s[72:75], s44 offen offset:1024 sc1 lds
    v_lshlrev_b32 v198, 16, v79
    s_waitcnt lgkmcnt(4)
    v_mfma_f32_16x16x32_bf16 v[88:91], a[112:115], a[208:211], v[88:91]
    ds_read_b128 a[136:139], v216 offset:6144
    v_mfma_f32_16x16x32_bf16 v[104:107], a[112:115], a[212:215], v[104:107]
    buffer_load_dwordx4 a[152:155], v3, s[20:23], s43 offen offset:0 sc1
    v_and_b32 v199, 0xffff0000, v79
    v_mfma_f32_16x16x32_bf16 v[108:111], a[116:119], a[212:215], v[108:111]
    ds_read_b128 a[140:143], v216 offset:7168
    v_mfma_f32_16x16x32_bf16 v[92:95], a[116:119], a[208:211], v[92:95]
    buffer_load_dwordx4 a[156:159], v3, s[20:23], s43 offen offset:1024 sc1
    v_lshlrev_b32 v200, 16, v80
    s_waitcnt lgkmcnt(4)
    v_mfma_f32_16x16x32_bf16 v[96:99], a[120:123], a[208:211], v[96:99]
    ds_read_b128 a[112:115], v216 offset:8192
    v_mfma_f32_16x16x32_bf16 v[112:115], a[120:123], a[212:215], v[112:115]
    v_and_b32 v201, 0xffff0000, v80
    v_mfma_f32_16x16x32_bf16 v[116:119], a[124:127], a[212:215], v[116:119]
    ds_read_b128 a[116:119], v216 offset:9216
    v_mfma_f32_16x16x32_bf16 v[100:103], a[124:127], a[208:211], v[100:103]
    buffer_load_dwordx4 v6, s[72:75], s44 offen offset:2048 sc1 lds
    v_lshlrev_b32 v202, 16, v81
    s_waitcnt lgkmcnt(4)
    v_mfma_f32_16x16x32_bf16 v[120:123], a[128:131], a[208:211], v[120:123]
    ds_read_b128 a[120:123], v216 offset:10240
    v_mfma_f32_16x16x32_bf16 v[136:139], a[128:131], a[212:215], v[136:139]
    buffer_load_dwordx4 a[160:163], v4, s[20:23], s43 offen offset:0 sc1
    v_and_b32 v203, 0xffff0000, v81
    v_mfma_f32_16x16x32_bf16 v[140:143], a[132:135], a[212:215], v[140:143]
    ds_read_b128 a[124:127], v216 offset:11264
    v_mfma_f32_16x16x32_bf16 v[124:127], a[132:135], a[208:211], v[124:127]
    buffer_load_dwordx4 a[164:167], v4, s[20:23], s43 offen offset:1024 sc1
    v_lshlrev_b32 v204, 16, v82
    s_waitcnt lgkmcnt(4)
    v_mfma_f32_16x16x32_bf16 v[128:131], a[136:139], a[208:211], v[128:131]
    ds_read_b128 a[128:131], v216 offset:12288
    v_mfma_f32_16x16x32_bf16 v[144:147], a[136:139], a[212:215], v[144:147]
    v_and_b32 v205, 0xffff0000, v82
    v_mfma_f32_16x16x32_bf16 v[148:151], a[140:143], a[212:215], v[148:151]
    ds_read_b128 a[132:135], v216 offset:13312
    v_mfma_f32_16x16x32_bf16 v[132:135], a[140:143], a[208:211], v[132:135]
    buffer_load_dwordx4 v6, s[72:75], s44 offen offset:3072 sc1 lds
    v_lshlrev_b32 v206, 16, v83
    s_waitcnt vmcnt(26) lgkmcnt(4)
    v_mfma_f32_16x16x32_bf16 v[88:91], a[112:115], a[216:219], v[88:91]
    ds_read_b128 a[136:139], v216 offset:14336
    v_mfma_f32_16x16x32_bf16 v[104:107], a[112:115], a[220:223], v[104:107]
    buffer_load_dwordx4 a[168:171], v5, s[20:23], s43 offen offset:0 sc1
    v_and_b32 v207, 0xffff0000, v83
    v_mfma_f32_16x16x32_bf16 v[108:111], a[116:119], a[220:223], v[108:111]
    ds_read_b128 a[140:143], v216 offset:15360
    v_mfma_f32_16x16x32_bf16 v[92:95], a[116:119], a[216:219], v[92:95]
    buffer_load_dwordx4 a[172:175], v5, s[20:23], s43 offen offset:1024 sc1
    v_lshlrev_b32 v208, 16, v84
    s_waitcnt lgkmcnt(4)
    v_mfma_f32_16x16x32_bf16 v[96:99], a[120:123], a[216:219], v[96:99]
    ds_read_b128 a[112:115], v216 offset:16384
    v_mfma_f32_16x16x32_bf16 v[112:115], a[120:123], a[220:223], v[112:115]
    v_and_b32 v209, 0xffff0000, v84
    v_mfma_f32_16x16x32_bf16 v[116:119], a[124:127], a[220:223], v[116:119]
    ds_read_b128 a[116:119], v216 offset:17408
    v_mfma_f32_16x16x32_bf16 v[100:103], a[124:127], a[216:219], v[100:103]
    s_mov_b32 s44, 0x780000
    s_add_u32 m0, s62, 0x8000
    s_nop 0
    buffer_load_dwordx4 v6, s[72:75], s44 offen offset:0 sc1 lds
    v_lshlrev_b32 v210, 16, v85
    s_waitcnt lgkmcnt(4)
    v_mfma_f32_16x16x32_bf16 v[120:123], a[128:131], a[216:219], v[120:123]
    ds_read_b128 a[120:123], v216 offset:18432
    v_mfma_f32_16x16x32_bf16 v[136:139], a[128:131], a[220:223], v[136:139]
    v_and_b32 v211, 0xffff0000, v85
    v_mfma_f32_16x16x32_bf16 v[140:143], a[132:135], a[220:223], v[140:143]
    ds_read_b128 a[124:127], v216 offset:19456
    v_mfma_f32_16x16x32_bf16 v[124:127], a[132:135], a[216:219], v[124:127]
    v_lshlrev_b32 v212, 16, v86
    s_waitcnt lgkmcnt(4)
    v_mfma_f32_16x16x32_bf16 v[128:131], a[136:139], a[216:219], v[128:131]
    ds_read_b128 a[128:131], v216 offset:20480
    v_mfma_f32_16x16x32_bf16 v[144:147], a[136:139], a[220:223], v[144:147]
    v_and_b32 v213, 0xffff0000, v86
    v_mfma_f32_16x16x32_bf16 v[148:151], a[140:143], a[220:223], v[148:151]
    ds_read_b128 a[132:135], v216 offset:21504
    v_lshlrev_b32 v214, 16, v87
    v_mfma_f32_16x16x32_bf16 v[132:135], a[140:143], a[216:219], v[132:135]
    buffer_load_dwordx4 v6, s[72:75], s44 offen offset:1024 sc1 lds
    v_and_b32 v215, 0xffff0000, v87
    s_waitcnt vmcnt(26) lgkmcnt(4)
    v_mfma_f32_16x16x32_bf16 v[88:91], a[112:115], a[224:227], v[88:91]
    ds_read_b128 a[136:139], v216 offset:22528
    v_mfma_f32_16x16x32_bf16 v[104:107], a[112:115], a[228:231], v[104:107]
    s_mov_b32 s43, 0xe80000
    buffer_load_dwordx4 a[176:179], v2, s[20:23], s43 offen offset:0 sc1
    v_mfma_f32_16x16x32_bf16 v[108:111], a[116:119], a[228:231], v[108:111]
    ds_read_b128 a[140:143], v216 offset:23552
    v_mfma_f32_16x16x32_bf16 v[92:95], a[116:119], a[224:227], v[92:95]
    buffer_load_dwordx4 a[180:183], v2, s[20:23], s43 offen offset:1024 sc1
    s_waitcnt lgkmcnt(4)
    v_mfma_f32_16x16x32_bf16 v[96:99], a[120:123], a[224:227], v[96:99]
    ds_read_b128 a[112:115], v216 offset:24576
    v_mfma_f32_16x16x32_bf16 v[112:115], a[120:123], a[228:231], v[112:115]
    v_mfma_f32_16x16x32_bf16 v[116:119], a[124:127], a[228:231], v[116:119]
    ds_read_b128 a[116:119], v216 offset:25600
    v_mfma_f32_16x16x32_bf16 v[100:103], a[124:127], a[224:227], v[100:103]
    buffer_load_dwordx4 v6, s[72:75], s44 offen offset:2048 sc1 lds
    s_waitcnt lgkmcnt(4)
    v_mfma_f32_16x16x32_bf16 v[120:123], a[128:131], a[224:227], v[120:123]
    ds_read_b128 a[120:123], v216 offset:26624
    v_mfma_f32_16x16x32_bf16 v[136:139], a[128:131], a[228:231], v[136:139]
    v_mfma_f32_16x16x32_bf16 v[140:143], a[132:135], a[228:231], v[140:143]
    ds_read_b128 a[124:127], v216 offset:27648
    v_mfma_f32_16x16x32_bf16 v[124:127], a[132:135], a[224:227], v[124:127]
    s_waitcnt lgkmcnt(4)
    v_mfma_f32_16x16x32_bf16 v[128:131], a[136:139], a[224:227], v[128:131]
    ds_read_b128 a[128:131], v216 offset:28672
    v_mfma_f32_16x16x32_bf16 v[144:147], a[136:139], a[228:231], v[144:147]
    v_mfma_f32_16x16x32_bf16 v[148:151], a[140:143], a[228:231], v[148:151]
    ds_read_b128 a[132:135], v216 offset:29696
    v_mfma_f32_16x16x32_bf16 v[132:135], a[140:143], a[224:227], v[132:135]
    buffer_load_dwordx4 v6, s[72:75], s44 offen offset:3072 sc1 lds
    s_waitcnt vmcnt(26) lgkmcnt(4)
    v_mfma_f32_16x16x32_bf16 v[88:91], a[112:115], a[232:235], v[88:91]
    ds_read_b128 a[136:139], v216 offset:30720
    v_mfma_f32_16x16x32_bf16 v[104:107], a[112:115], a[236:239], v[104:107]
    buffer_load_dwordx4 a[184:187], v3, s[20:23], s43 offen offset:0 sc1
    v_mfma_f32_16x16x32_bf16 v[108:111], a[116:119], a[236:239], v[108:111]
    ds_read_b128 a[140:143], v216 offset:31744
    v_mfma_f32_16x16x32_bf16 v[92:95], a[116:119], a[232:235], v[92:95]
    buffer_load_dwordx4 a[188:191], v3, s[20:23], s43 offen offset:1024 sc1
    s_waitcnt vmcnt(22) lgkmcnt(4)
    s_barrier
    v_mfma_f32_16x16x32_bf16 v[96:99], a[120:123], a[232:235], v[96:99]
    ds_read_b128 a[112:115], v216 offset:32768
    v_mfma_f32_16x16x32_bf16 v[112:115], a[120:123], a[236:239], v[112:115]
    v_mfma_f32_16x16x32_bf16 v[116:119], a[124:127], a[236:239], v[116:119]
    ds_read_b128 a[116:119], v216 offset:33792
    v_mfma_f32_16x16x32_bf16 v[100:103], a[124:127], a[232:235], v[100:103]
    s_mov_b32 s44, 0x7c0000
    s_add_u32 m0, s62, 0xc000
    s_nop 0
    buffer_load_dwordx4 v6, s[72:75], s44 offen offset:0 sc1 lds
    s_waitcnt lgkmcnt(4)
    v_mfma_f32_16x16x32_bf16 v[120:123], a[128:131], a[232:235], v[120:123]
    ds_read_b128 a[120:123], v216 offset:34816
    v_mfma_f32_16x16x32_bf16 v[136:139], a[128:131], a[236:239], v[136:139]
    v_mfma_f32_16x16x32_bf16 v[140:143], a[132:135], a[236:239], v[140:143]
    ds_read_b128 a[124:127], v216 offset:35840
    v_mfma_f32_16x16x32_bf16 v[124:127], a[132:135], a[232:235], v[124:127]
    s_waitcnt lgkmcnt(4)
    v_mfma_f32_16x16x32_bf16 v[128:131], a[136:139], a[232:235], v[128:131]
    ds_read_b128 a[128:131], v216 offset:36864
    v_mfma_f32_16x16x32_bf16 v[144:147], a[136:139], a[236:239], v[144:147]
    v_mfma_f32_16x16x32_bf16 v[148:151], a[140:143], a[236:239], v[148:151]
    ds_read_b128 a[132:135], v216 offset:37888
    v_mfma_f32_16x16x32_bf16 v[132:135], a[140:143], a[232:235], v[132:135]
    buffer_load_dwordx4 v6, s[72:75], s44 offen offset:1024 sc1 lds
    s_waitcnt lgkmcnt(4)
    v_mfma_f32_16x16x32_bf16 v[88:91], a[112:115], a[240:243], v[88:91]
    ds_read_b128 a[136:139], v216 offset:38912
    v_mfma_f32_16x16x32_bf16 v[104:107], a[112:115], a[244:247], v[104:107]
    buffer_load_dwordx4 a[192:195], v4, s[20:23], s43 offen offset:0 sc1
    v_mfma_f32_16x16x32_bf16 v[108:111], a[116:119], a[244:247], v[108:111]
    ds_read_b128 a[140:143], v216 offset:39936
    v_mfma_f32_16x16x32_bf16 v[92:95], a[116:119], a[240:243], v[92:95]
    buffer_load_dwordx4 a[196:199], v4, s[20:23], s43 offen offset:1024 sc1
    s_waitcnt lgkmcnt(4)
    v_mfma_f32_16x16x32_bf16 v[96:99], a[120:123], a[240:243], v[96:99]
    ds_read_b128 a[112:115], v216 offset:40960
    v_mfma_f32_16x16x32_bf16 v[112:115], a[120:123], a[244:247], v[112:115]
    v_mfma_f32_16x16x32_bf16 v[116:119], a[124:127], a[244:247], v[116:119]
    ds_read_b128 a[116:119], v216 offset:41984
    v_mfma_f32_16x16x32_bf16 v[100:103], a[124:127], a[240:243], v[100:103]
    buffer_load_dwordx4 v6, s[72:75], s44 offen offset:2048 sc1 lds
    s_add_u32 s16, s14, 0x3400000
    s_addc_u32 s17, s15, 0
    s_mov_b32 s18, 0x800000
    s_mov_b32 s19, 0x00020000
    s_waitcnt lgkmcnt(4)
    v_mfma_f32_16x16x32_bf16 v[120:123], a[128:131], a[240:243], v[120:123]
    ds_read_b128 a[120:123], v216 offset:43008
    v_mfma_f32_16x16x32_bf16 v[136:139], a[128:131], a[244:247], v[136:139]
    v_mfma_f32_16x16x32_bf16 v[140:143], a[132:135], a[244:247], v[140:143]
    ds_read_b128 a[124:127], v216 offset:44032
    v_mfma_f32_16x16x32_bf16 v[124:127], a[132:135], a[240:243], v[124:127]
    s_waitcnt lgkmcnt(4)
    v_mfma_f32_16x16x32_bf16 v[128:131], a[136:139], a[240:243], v[128:131]
    ds_read_b128 a[128:131], v216 offset:45056
    v_mfma_f32_16x16x32_bf16 v[144:147], a[136:139], a[244:247], v[144:147]
    s_lshl_b32 s65, s2, 2
    v_mfma_f32_16x16x32_bf16 v[148:151], a[140:143], a[244:247], v[148:151]
    ds_read_b128 a[132:135], v216 offset:46080
    v_mfma_f32_16x16x32_bf16 v[132:135], a[140:143], a[240:243], v[132:135]
    buffer_load_dwordx4 v6, s[72:75], s44 offen offset:3072 sc1 lds
    s_waitcnt vmcnt(26) lgkmcnt(4)
    v_mfma_f32_16x16x32_bf16 v[88:91], a[112:115], a[248:251], v[88:91]
    ds_read_b128 a[136:139], v216 offset:47104
    v_mfma_f32_16x16x32_bf16 v[104:107], a[112:115], a[252:255], v[104:107]
    buffer_load_dwordx4 a[200:203], v5, s[20:23], s43 offen offset:0 sc1
    v_mfma_f32_16x16x32_bf16 v[108:111], a[116:119], a[252:255], v[108:111]
    ds_read_b128 a[140:143], v216 offset:48128
    v_mfma_f32_16x16x32_bf16 v[92:95], a[116:119], a[248:251], v[92:95]
    buffer_load_dwordx4 a[204:207], v5, s[20:23], s43 offen offset:1024 sc1
    s_add_u32 s65, s65, s48
    s_waitcnt lgkmcnt(4)
    v_mfma_f32_16x16x32_bf16 v[96:99], a[120:123], a[248:251], v[96:99]
    ds_read_b128 a[112:115], v13 offset:0
    v_mfma_f32_16x16x32_bf16 v[112:115], a[120:123], a[252:255], v[112:115]
    v_mfma_f32_16x16x32_bf16 v[116:119], a[124:127], a[252:255], v[116:119]
    ds_read_b128 a[116:119], v13 offset:1024
    v_mfma_f32_16x16x32_bf16 v[100:103], a[124:127], a[248:251], v[100:103]
    s_mov_b32 s44, 0x800000
    s_add_u32 m0, s62, 0x10000
    s_nop 0
    buffer_load_dwordx4 v6, s[72:75], s44 offen offset:0 sc1 lds
    s_waitcnt lgkmcnt(4)
    v_mfma_f32_16x16x32_bf16 v[120:123], a[128:131], a[248:251], v[120:123]
    ds_read_b128 a[120:123], v13 offset:2048
    v_mfma_f32_16x16x32_bf16 v[136:139], a[128:131], a[252:255], v[136:139]
    s_lshl_b32 s65, s65, 13
    v_mfma_f32_16x16x32_bf16 v[140:143], a[132:135], a[252:255], v[140:143]
    ds_read_b128 a[124:127], v13 offset:3072
    v_mfma_f32_16x16x32_bf16 v[124:127], a[132:135], a[248:251], v[124:127]
    s_waitcnt lgkmcnt(4)
    v_mfma_f32_16x16x32_bf16 v[128:131], a[136:139], a[248:251], v[128:131]
    ds_read_b128 a[128:131], v13 offset:4096
    v_mfma_f32_16x16x32_bf16 v[144:147], a[136:139], a[252:255], v[144:147]
    v_mfma_f32_16x16x32_bf16 v[148:151], a[140:143], a[252:255], v[148:151]
    ds_read_b128 a[132:135], v13 offset:5120
    v_mfma_f32_16x16x32_bf16 v[132:135], a[140:143], a[248:251], v[132:135]
    buffer_load_dwordx4 v6, s[72:75], s44 offen offset:1024 sc1 lds
    s_add_u32 s66, s65, 4096
    s_waitcnt vmcnt(27) lgkmcnt(4)
    v_mfma_f32_16x16x32_bf16 v[24:27], a[112:115], a[144:147], v[24:27]
    ds_read_b128 a[136:139], v13 offset:6144
    v_mfma_f32_16x16x32_bf16 v[40:43], a[112:115], a[148:151], v[40:43]
    s_mov_b32 s43, 0xf00000
    buffer_load_dwordx4 a[208:211], v2, s[20:23], s43 offen offset:0 sc1
    v_mfma_f32_16x16x32_bf16 v[44:47], a[116:119], a[148:151], v[44:47]
    ds_read_b128 a[140:143], v13 offset:7168
    v_mfma_f32_16x16x32_bf16 v[28:31], a[116:119], a[144:147], v[28:31]
    buffer_load_dwordx4 a[212:215], v2, s[20:23], s43 offen offset:1024 sc1
    s_waitcnt lgkmcnt(4)
    v_mfma_f32_16x16x32_bf16 v[32:35], a[120:123], a[144:147], v[32:35]
    ds_read_b128 a[112:115], v13 offset:8192
    v_mfma_f32_16x16x32_bf16 v[48:51], a[120:123], a[148:151], v[48:51]
    v_cvt_pk_bf16_f32 v120, v120, v121
    v_mfma_f32_16x16x32_bf16 v[52:55], a[124:127], a[148:151], v[52:55]
    ds_read_b128 a[116:119], v13 offset:9216
    v_cvt_pk_bf16_f32 v121, v122, v123
    v_mfma_f32_16x16x32_bf16 v[36:39], a[124:127], a[144:147], v[36:39]
    buffer_load_dwordx4 v6, s[72:75], s44 offen offset:2048 sc1 lds
    v_cvt_pk_bf16_f32 v122, v124, v125
    s_waitcnt vmcnt(27) lgkmcnt(4)
    v_mfma_f32_16x16x32_bf16 v[24:27], a[128:131], a[152:155], v[24:27]
    ds_read_b128 a[120:123], v13 offset:10240
    v_cvt_pk_bf16_f32 v123, v126, v127
    v_mfma_f32_16x16x32_bf16 v[40:43], a[128:131], a[156:159], v[40:43]
    buffer_load_dwordx4 a[216:219], v3, s[20:23], s43 offen offset:0 sc1
    buffer_store_dwordx4 v[120:123], v13, s[16:19], s65 offen offset:0 sc1
    v_mfma_f32_16x16x32_bf16 v[44:47], a[132:135], a[156:159], v[44:47]
    ds_read_b128 a[124:127], v13 offset:11264
    v_mfma_f32_16x16x32_bf16 v[28:31], a[132:135], a[152:155], v[28:31]
    buffer_load_dwordx4 a[220:223], v3, s[20:23], s43 offen offset:1024 sc1
    v_cvt_pk_bf16_f32 v124, v128, v129
    s_waitcnt lgkmcnt(4)
    v_mfma_f32_16x16x32_bf16 v[32:35], a[136:139], a[152:155], v[32:35]
    ds_read_b128 a[128:131], v13 offset:12288
    v_cvt_pk_bf16_f32 v125, v130, v131
    v_mfma_f32_16x16x32_bf16 v[48:51], a[136:139], a[156:159], v[48:51]
    v_cvt_pk_bf16_f32 v126, v132, v133
    v_mfma_f32_16x16x32_bf16 v[52:55], a[140:143], a[156:159], v[52:55]
    ds_read_b128 a[132:135], v13 offset:13312
    v_cvt_pk_bf16_f32 v127, v134, v135
    v_mfma_f32_16x16x32_bf16 v[36:39], a[140:143], a[152:155], v[36:39]
    buffer_load_dwordx4 v6, s[72:75], s44 offen offset:3072 sc1 lds
    buffer_store_dwordx4 v[124:127], v13, s[16:19], s65 offen offset:1024 sc1
    s_waitcnt vmcnt(29) lgkmcnt(4)
    v_mfma_f32_16x16x32_bf16 v[24:27], a[112:115], a[160:163], v[24:27]
    ds_read_b128 a[136:139], v13 offset:14336
    v_mfma_f32_16x16x32_bf16 v[40:43], a[112:115], a[164:167], v[40:43]
    buffer_load_dwordx4 a[224:227], v4, s[20:23], s43 offen offset:0 sc1
    v_cvt_pk_bf16_f32 v128, v136, v137
    v_mfma_f32_16x16x32_bf16 v[44:47], a[116:119], a[164:167], v[44:47]
    ds_read_b128 a[140:143], v13 offset:15360
    v_cvt_pk_bf16_f32 v129, v138, v139
    v_mfma_f32_16x16x32_bf16 v[28:31], a[116:119], a[160:163], v[28:31]
    buffer_load_dwordx4 a[228:231], v4, s[20:23], s43 offen offset:1024 sc1
    v_cvt_pk_bf16_f32 v130, v140, v141
    s_waitcnt vmcnt(22) lgkmcnt(4)
    s_barrier
    v_mfma_f32_16x16x32_bf16 v[32:35], a[120:123], a[160:163], v[32:35]
    ds_read_b128 a[112:115], v13 offset:16384
    v_cvt_pk_bf16_f32 v131, v142, v143
    v_mfma_f32_16x16x32_bf16 v[48:51], a[120:123], a[164:167], v[48:51]
    buffer_store_dwordx4 v[128:131], v13, s[16:19], s65 offen offset:2048 sc1
    v_mfma_f32_16x16x32_bf16 v[52:55], a[124:127], a[164:167], v[52:55]
    ds_read_b128 a[116:119], v13 offset:17408
    v_mfma_f32_16x16x32_bf16 v[36:39], a[124:127], a[160:163], v[36:39]
    s_mov_b32 s44, 0x840000
    s_add_u32 m0, s62, 0x14000
    s_nop 0
    buffer_load_dwordx4 v6, s[72:75], s44 offen offset:0 sc1 lds
    v_cvt_pk_bf16_f32 v132, v144, v145
    s_waitcnt lgkmcnt(4)
    v_mfma_f32_16x16x32_bf16 v[24:27], a[128:131], a[168:171], v[24:27]
    ds_read_b128 a[120:123], v13 offset:18432
    v_cvt_pk_bf16_f32 v133, v146, v147
    v_mfma_f32_16x16x32_bf16 v[40:43], a[128:131], a[172:175], v[40:43]
    buffer_load_dwordx4 a[232:235], v5, s[20:23], s43 offen offset:0 sc1
    v_cvt_pk_bf16_f32 v134, v148, v149
    v_mfma_f32_16x16x32_bf16 v[44:47], a[132:135], a[172:175], v[44:47]
    ds_read_b128 a[124:127], v13 offset:19456
    v_cvt_pk_bf16_f32 v135, v150, v151
    v_mfma_f32_16x16x32_bf16 v[28:31], a[132:135], a[168:171], v[28:31]
    buffer_load_dwordx4 a[236:239], v5, s[20:23], s43 offen offset:1024 sc1
    buffer_store_dwordx4 v[132:135], v13, s[16:19], s65 offen offset:3072 sc1
    s_waitcnt lgkmcnt(4)
    v_mfma_f32_16x16x32_bf16 v[32:35], a[136:139], a[168:171], v[32:35]
    ds_read_b128 a[128:131], v13 offset:20480
    v_mfma_f32_16x16x32_bf16 v[48:51], a[136:139], a[172:175], v[48:51]
    v_mfma_f32_16x16x32_bf16 v[52:55], a[140:143], a[172:175], v[52:55]
    ds_read_b128 a[132:135], v13 offset:21504
    v_mfma_f32_16x16x32_bf16 v[36:39], a[140:143], a[168:171], v[36:39]
    buffer_load_dwordx4 v6, s[72:75], s44 offen offset:1024 sc1 lds
    s_waitcnt lgkmcnt(4)
    v_mfma_f32_16x16x32_bf16 v[24:27], a[112:115], a[176:179], v[24:27]
    ds_read_b128 a[136:139], v13 offset:22528
    v_mfma_f32_16x16x32_bf16 v[40:43], a[112:115], a[180:183], v[40:43]
    s_mov_b32 s43, 0xf80000
    buffer_load_dwordx4 a[240:243], v2, s[20:23], s43 offen offset:0 sc1
    v_mfma_f32_16x16x32_bf16 v[44:47], a[116:119], a[180:183], v[44:47]
    ds_read_b128 a[140:143], v13 offset:23552
    v_mfma_f32_16x16x32_bf16 v[28:31], a[116:119], a[176:179], v[28:31]
    buffer_load_dwordx4 a[244:247], v2, s[20:23], s43 offen offset:1024 sc1
    s_waitcnt lgkmcnt(4)
    v_mfma_f32_16x16x32_bf16 v[32:35], a[120:123], a[176:179], v[32:35]
    ds_read_b128 a[112:115], v13 offset:24576
    v_mfma_f32_16x16x32_bf16 v[48:51], a[120:123], a[180:183], v[48:51]
    v_mfma_f32_16x16x32_bf16 v[52:55], a[124:127], a[180:183], v[52:55]
    ds_read_b128 a[116:119], v13 offset:25600
    v_mfma_f32_16x16x32_bf16 v[36:39], a[124:127], a[176:179], v[36:39]
    buffer_load_dwordx4 v6, s[72:75], s44 offen offset:2048 sc1 lds
    s_waitcnt vmcnt(29) lgkmcnt(4)
    v_mfma_f32_16x16x32_bf16 v[24:27], a[128:131], a[184:187], v[24:27]
    ds_read_b128 a[120:123], v13 offset:26624
    v_mfma_f32_16x16x32_bf16 v[40:43], a[128:131], a[188:191], v[40:43]
    buffer_load_dwordx4 a[248:251], v3, s[20:23], s43 offen offset:0 sc1
    v_mfma_f32_16x16x32_bf16 v[44:47], a[132:135], a[188:191], v[44:47]
    ds_read_b128 a[124:127], v13 offset:27648
    v_mfma_f32_16x16x32_bf16 v[28:31], a[132:135], a[184:187], v[28:31]
    buffer_load_dwordx4 a[252:255], v3, s[20:23], s43 offen offset:1024 sc1
    s_waitcnt lgkmcnt(4)
    v_mfma_f32_16x16x32_bf16 v[32:35], a[136:139], a[184:187], v[32:35]
    ds_read_b128 a[128:131], v13 offset:28672
    v_mfma_f32_16x16x32_bf16 v[48:51], a[136:139], a[188:191], v[48:51]
    v_mfma_f32_16x16x32_bf16 v[52:55], a[140:143], a[188:191], v[52:55]
    ds_read_b128 a[132:135], v13 offset:29696
    v_mfma_f32_16x16x32_bf16 v[36:39], a[140:143], a[184:187], v[36:39]
    buffer_load_dwordx4 v6, s[72:75], s44 offen offset:3072 sc1 lds
    s_waitcnt vmcnt(28) lgkmcnt(4)
    v_mfma_f32_16x16x32_bf16 v[24:27], a[112:115], a[192:195], v[24:27]
    ds_read_b128 a[136:139], v13 offset:30720
    v_mfma_f32_16x16x32_bf16 v[40:43], a[112:115], a[196:199], v[40:43]
    buffer_load_dwordx4 a[144:147], v4, s[20:23], s43 offen offset:0 sc1
    v_mfma_f32_16x16x32_bf16 v[44:47], a[116:119], a[196:199], v[44:47]
    ds_read_b128 a[140:143], v13 offset:31744
    v_mfma_f32_16x16x32_bf16 v[28:31], a[116:119], a[192:195], v[28:31]
    buffer_load_dwordx4 a[148:151], v4, s[20:23], s43 offen offset:1024 sc1
    s_waitcnt lgkmcnt(4)
    v_mfma_f32_16x16x32_bf16 v[32:35], a[120:123], a[192:195], v[32:35]
    ds_read_b128 a[112:115], v13 offset:32768
    v_mfma_f32_16x16x32_bf16 v[48:51], a[120:123], a[196:199], v[48:51]
    v_mfma_f32_16x16x32_bf16 v[52:55], a[124:127], a[196:199], v[52:55]
    ds_read_b128 a[116:119], v13 offset:33792
    v_mfma_f32_16x16x32_bf16 v[36:39], a[124:127], a[192:195], v[36:39]
    s_mov_b32 s44, 0x880000
    s_add_u32 m0, s62, 0x18000
    s_nop 0
    buffer_load_dwordx4 v6, s[72:75], s44 offen offset:0 sc1 lds
    s_waitcnt vmcnt(27) lgkmcnt(4)
    v_mfma_f32_16x16x32_bf16 v[24:27], a[128:131], a[200:203], v[24:27]
    ds_read_b128 a[120:123], v13 offset:34816
    v_mfma_f32_16x16x32_bf16 v[40:43], a[128:131], a[204:207], v[40:43]
    buffer_load_dwordx4 a[152:155], v5, s[20:23], s43 offen offset:0 sc1
    v_mfma_f32_16x16x32_bf16 v[44:47], a[132:135], a[204:207], v[44:47]
    ds_read_b128 a[124:127], v13 offset:35840
    v_mfma_f32_16x16x32_bf16 v[28:31], a[132:135], a[200:203], v[28:31]
    buffer_load_dwordx4 a[156:159], v5, s[20:23], s43 offen offset:1024 sc1
    s_waitcnt lgkmcnt(4)
    v_mfma_f32_16x16x32_bf16 v[32:35], a[136:139], a[200:203], v[32:35]
    ds_read_b128 a[128:131], v13 offset:36864
    v_mfma_f32_16x16x32_bf16 v[48:51], a[136:139], a[204:207], v[48:51]
    v_mfma_f32_16x16x32_bf16 v[52:55], a[140:143], a[204:207], v[52:55]
    ds_read_b128 a[132:135], v13 offset:37888
    v_mfma_f32_16x16x32_bf16 v[36:39], a[140:143], a[200:203], v[36:39]
    buffer_load_dwordx4 v6, s[72:75], s44 offen offset:1024 sc1 lds
    s_waitcnt vmcnt(26) lgkmcnt(4)
    v_mfma_f32_16x16x32_bf16 v[24:27], a[112:115], a[208:211], v[24:27]
    ds_read_b128 a[136:139], v13 offset:38912
    v_mfma_f32_16x16x32_bf16 v[40:43], a[112:115], a[212:215], v[40:43]
    s_mov_b32 s43, 0x1000000
    buffer_load_dwordx4 a[160:163], v2, s[20:23], s43 offen offset:0 sc1
    v_mfma_f32_16x16x32_bf16 v[44:47], a[116:119], a[212:215], v[44:47]
    ds_read_b128 a[140:143], v13 offset:39936
    v_mfma_f32_16x16x32_bf16 v[28:31], a[116:119], a[208:211], v[28:31]
    buffer_load_dwordx4 a[164:167], v2, s[20:23], s43 offen offset:1024 sc1
    s_waitcnt lgkmcnt(4)
    v_mfma_f32_16x16x32_bf16 v[32:35], a[120:123], a[208:211], v[32:35]
    ds_read_b128 a[112:115], v13 offset:40960
    v_mfma_f32_16x16x32_bf16 v[48:51], a[120:123], a[212:215], v[48:51]
    v_mfma_f32_16x16x32_bf16 v[52:55], a[124:127], a[212:215], v[52:55]
    ds_read_b128 a[116:119], v13 offset:41984
    v_mfma_f32_16x16x32_bf16 v[36:39], a[124:127], a[208:211], v[36:39]
    buffer_load_dwordx4 v6, s[72:75], s44 offen offset:2048 sc1 lds
    s_waitcnt vmcnt(25) lgkmcnt(4)
    v_mfma_f32_16x16x32_bf16 v[24:27], a[128:131], a[216:219], v[24:27]
    ds_read_b128 a[120:123], v13 offset:43008
    v_mfma_f32_16x16x32_bf16 v[40:43], a[128:131], a[220:223], v[40:43]
    buffer_load_dwordx4 a[168:171], v3, s[20:23], s43 offen offset:0 sc1
    v_mfma_f32_16x16x32_bf16 v[44:47], a[132:135], a[220:223], v[44:47]
    ds_read_b128 a[124:127], v13 offset:44032
    v_mfma_f32_16x16x32_bf16 v[28:31], a[132:135], a[216:219], v[28:31]
    buffer_load_dwordx4 a[172:175], v3, s[20:23], s43 offen offset:1024 sc1
    s_waitcnt lgkmcnt(4)
    v_mfma_f32_16x16x32_bf16 v[32:35], a[136:139], a[216:219], v[32:35]
    ds_read_b128 a[128:131], v13 offset:45056
    v_mfma_f32_16x16x32_bf16 v[48:51], a[136:139], a[220:223], v[48:51]
    s_waitcnt vmcnt(18)
    v_mov_b32 v14, s12
    v_mov_b32 v15, 1
    s_mov_b64 exec, 1
    buffer_store_dwordx2 v[14:15], off, s[16:19], s66 sc1
    s_mov_b64 exec, -1
    s_xor_b32 s65, s65, 1048576
    s_xor_b32 s66, s66, 1048576
    v_mfma_f32_16x16x32_bf16 v[52:55], a[140:143], a[220:223], v[52:55]
    ds_read_b128 a[132:135], v13 offset:46080
    v_mfma_f32_16x16x32_bf16 v[36:39], a[140:143], a[216:219], v[36:39]
    buffer_load_dwordx4 v6, s[72:75], s44 offen offset:3072 sc1 lds
    s_waitcnt lgkmcnt(4)
    v_mfma_f32_16x16x32_bf16 v[24:27], a[112:115], a[224:227], v[24:27]
    ds_read_b128 a[136:139], v13 offset:47104
    v_mfma_f32_16x16x32_bf16 v[40:43], a[112:115], a[228:231], v[40:43]
    buffer_load_dwordx4 a[176:179], v4, s[20:23], s43 offen offset:0 sc1
    v_mfma_f32_16x16x32_bf16 v[44:47], a[116:119], a[228:231], v[44:47]
    ds_read_b128 a[140:143], v13 offset:48128
    v_mfma_f32_16x16x32_bf16 v[28:31], a[116:119], a[224:227], v[28:31]
    buffer_load_dwordx4 a[180:183], v4, s[20:23], s43 offen offset:1024 sc1
    s_waitcnt lgkmcnt(4)
    s_barrier
    v_mfma_f32_16x16x32_bf16 v[32:35], a[120:123], a[224:227], v[32:35]
    ds_read_b128 a[112:115], v13 offset:49152
    v_mfma_f32_16x16x32_bf16 v[48:51], a[120:123], a[228:231], v[48:51]
    v_mfma_f32_16x16x32_bf16 v[52:55], a[124:127], a[228:231], v[52:55]
    ds_read_b128 a[116:119], v13 offset:50176
    v_mfma_f32_16x16x32_bf16 v[36:39], a[124:127], a[224:227], v[36:39]
    s_mov_b32 s44, 0x8c0000
    s_add_u32 m0, s62, 0x0
    s_nop 0
    buffer_load_dwordx4 v6, s[72:75], s44 offen offset:0 sc1 lds
    s_waitcnt lgkmcnt(4)
    v_mfma_f32_16x16x32_bf16 v[24:27], a[128:131], a[232:235], v[24:27]
    ds_read_b128 a[120:123], v13 offset:51200
    v_mfma_f32_16x16x32_bf16 v[40:43], a[128:131], a[236:239], v[40:43]
    buffer_load_dwordx4 a[184:187], v5, s[20:23], s43 offen offset:0 sc1
    v_mfma_f32_16x16x32_bf16 v[44:47], a[132:135], a[236:239], v[44:47]
    ds_read_b128 a[124:127], v13 offset:52224
    v_mfma_f32_16x16x32_bf16 v[28:31], a[132:135], a[232:235], v[28:31]
    buffer_load_dwordx4 a[188:191], v5, s[20:23], s43 offen offset:1024 sc1
    s_waitcnt lgkmcnt(4)
    v_mfma_f32_16x16x32_bf16 v[32:35], a[136:139], a[232:235], v[32:35]
    ds_read_b128 a[128:131], v13 offset:53248
    v_mfma_f32_16x16x32_bf16 v[48:51], a[136:139], a[236:239], v[48:51]
    v_mfma_f32_16x16x32_bf16 v[52:55], a[140:143], a[236:239], v[52:55]
    ds_read_b128 a[132:135], v13 offset:54272
    v_mfma_f32_16x16x32_bf16 v[36:39], a[140:143], a[232:235], v[36:39]
    buffer_load_dwordx4 v6, s[72:75], s44 offen offset:1024 sc1 lds
    s_waitcnt vmcnt(23) lgkmcnt(4)
    v_mfma_f32_16x16x32_bf16 v[24:27], a[112:115], a[240:243], v[24:27]
    ds_read_b128 a[136:139], v13 offset:55296
    v_mfma_f32_16x16x32_bf16 v[40:43], a[112:115], a[244:247], v[40:43]
    s_mov_b32 s43, 0x1080000
    buffer_load_dwordx4 a[192:195], v2, s[20:23], s43 offen offset:0 sc1
    v_mfma_f32_16x16x32_bf16 v[44:47], a[116:119], a[244:247], v[44:47]
    ds_read_b128 a[140:143], v13 offset:56320
    v_mfma_f32_16x16x32_bf16 v[28:31], a[116:119], a[240:243], v[28:31]
    buffer_load_dwordx4 a[196:199], v2, s[20:23], s43 offen offset:1024 sc1
    s_waitcnt lgkmcnt(4)
    v_mfma_f32_16x16x32_bf16 v[32:35], a[120:123], a[240:243], v[32:35]
    ds_read_b128 a[112:115], v13 offset:57344
    v_mfma_f32_16x16x32_bf16 v[48:51], a[120:123], a[244:247], v[48:51]
    v_mfma_f32_16x16x32_bf16 v[52:55], a[124:127], a[244:247], v[52:55]
    ds_read_b128 a[116:119], v13 offset:58368
    v_mfma_f32_16x16x32_bf16 v[36:39], a[124:127], a[240:243], v[36:39]
    buffer_load_dwordx4 v6, s[72:75], s44 offen offset:2048 sc1 lds
    s_waitcnt vmcnt(23) lgkmcnt(4)
    v_mfma_f32_16x16x32_bf16 v[24:27], a[128:131], a[248:251], v[24:27]
    ds_read_b128 a[120:123], v13 offset:59392
    v_mfma_f32_16x16x32_bf16 v[40:43], a[128:131], a[252:255], v[40:43]
    buffer_load_dwordx4 a[200:203], v3, s[20:23], s43 offen offset:0 sc1
    v_mfma_f32_16x16x32_bf16 v[44:47], a[132:135], a[252:255], v[44:47]
    ds_read_b128 a[124:127], v13 offset:60416
    v_mfma_f32_16x16x32_bf16 v[28:31], a[132:135], a[248:251], v[28:31]
    buffer_load_dwordx4 a[204:207], v3, s[20:23], s43 offen offset:1024 sc1
    s_waitcnt lgkmcnt(4)
    v_mfma_f32_16x16x32_bf16 v[32:35], a[136:139], a[248:251], v[32:35]
    ds_read_b128 a[128:131], v13 offset:61440
    v_mfma_f32_16x16x32_bf16 v[48:51], a[136:139], a[252:255], v[48:51]
    buffer_load_dwordx2 v[18:19], off, s[16:19], s66 sc1
    v_mfma_f32_16x16x32_bf16 v[52:55], a[140:143], a[252:255], v[52:55]
    ds_read_b128 a[132:135], v13 offset:62464
    v_mfma_f32_16x16x32_bf16 v[36:39], a[140:143], a[248:251], v[36:39]
    buffer_load_dwordx4 v6, s[72:75], s44 offen offset:3072 sc1 lds
    s_waitcnt vmcnt(24) lgkmcnt(4)
    v_mfma_f32_16x16x32_bf16 v[24:27], a[112:115], a[144:147], v[24:27]
    ds_read_b128 a[136:139], v13 offset:63488
    v_mfma_f32_16x16x32_bf16 v[40:43], a[112:115], a[148:151], v[40:43]
    buffer_load_dwordx4 a[208:211], v4, s[20:23], s43 offen offset:0 sc1
    v_mfma_f32_16x16x32_bf16 v[44:47], a[116:119], a[148:151], v[44:47]
    ds_read_b128 a[140:143], v13 offset:64512
    v_mfma_f32_16x16x32_bf16 v[28:31], a[116:119], a[144:147], v[28:31]
    buffer_load_dwordx4 a[212:215], v4, s[20:23], s43 offen offset:1024 sc1
    s_waitcnt lgkmcnt(4)
    v_mfma_f32_16x16x32_bf16 v[32:35], a[120:123], a[144:147], v[32:35]
    ds_read_b128 a[112:115], v216 offset:0
    v_mfma_f32_16x16x32_bf16 v[48:51], a[120:123], a[148:151], v[48:51]
    v_mfma_f32_16x16x32_bf16 v[52:55], a[124:127], a[148:151], v[52:55]
    ds_read_b128 a[116:119], v216 offset:1024
    v_mfma_f32_16x16x32_bf16 v[36:39], a[124:127], a[144:147], v[36:39]
    s_waitcnt vmcnt(23) lgkmcnt(4)
    v_mfma_f32_16x16x32_bf16 v[24:27], a[128:131], a[152:155], v[24:27]
    ds_read_b128 a[120:123], v216 offset:2048
    v_mfma_f32_16x16x32_bf16 v[40:43], a[128:131], a[156:159], v[40:43]
    buffer_load_dwordx4 a[216:219], v5, s[20:23], s43 offen offset:0 sc1
    v_mfma_f32_16x16x32_bf16 v[44:47], a[132:135], a[156:159], v[44:47]
    ds_read_b128 a[124:127], v216 offset:3072
    v_mfma_f32_16x16x32_bf16 v[28:31], a[132:135], a[152:155], v[28:31]
    buffer_load_dwordx4 a[220:223], v5, s[20:23], s43 offen offset:1024 sc1
    s_waitcnt lgkmcnt(4)
    v_mfma_f32_16x16x32_bf16 v[32:35], a[136:139], a[152:155], v[32:35]
    ds_read_b128 a[128:131], v216 offset:4096
    v_mfma_f32_16x16x32_bf16 v[48:51], a[136:139], a[156:159], v[48:51]
    v_mfma_f32_16x16x32_bf16 v[52:55], a[140:143], a[156:159], v[52:55]
    ds_read_b128 a[132:135], v216 offset:5120
    v_mfma_f32_16x16x32_bf16 v[36:39], a[140:143], a[152:155], v[36:39]
    s_waitcnt vmcnt(22) lgkmcnt(4)
    v_mfma_f32_16x16x32_bf16 v[24:27], a[112:115], a[160:163], v[24:27]
    ds_read_b128 a[136:139], v216 offset:6144
    v_mfma_f32_16x16x32_bf16 v[40:43], a[112:115], a[164:167], v[40:43]
    s_mov_b32 s43, 0x1100000
    buffer_load_dwordx4 a[224:227], v2, s[20:23], s43 offen offset:0 sc1
    v_mfma_f32_16x16x32_bf16 v[44:47], a[116:119], a[164:167], v[44:47]
    ds_read_b128 a[140:143], v216 offset:7168
    v_mfma_f32_16x16x32_bf16 v[28:31], a[116:119], a[160:163], v[28:31]
    buffer_load_dwordx4 a[228:231], v2, s[20:23], s43 offen offset:1024 sc1
    s_waitcnt lgkmcnt(4)
    v_mfma_f32_16x16x32_bf16 v[32:35], a[120:123], a[160:163], v[32:35]
    ds_read_b128 a[112:115], v216 offset:8192
    v_mfma_f32_16x16x32_bf16 v[48:51], a[120:123], a[164:167], v[48:51]
    v_mfma_f32_16x16x32_bf16 v[52:55], a[124:127], a[164:167], v[52:55]
    ds_read_b128 a[116:119], v216 offset:9216
    v_mfma_f32_16x16x32_bf16 v[36:39], a[124:127], a[160:163], v[36:39]
    s_waitcnt vmcnt(21) lgkmcnt(4)
    v_mfma_f32_16x16x32_bf16 v[24:27], a[128:131], a[168:171], v[24:27]
    ds_read_b128 a[120:123], v216 offset:10240
    v_mfma_f32_16x16x32_bf16 v[40:43], a[128:131], a[172:175], v[40:43]
    buffer_load_dwordx4 a[232:235], v3, s[20:23], s43 offen offset:0 sc1
    v_mfma_f32_16x16x32_bf16 v[44:47], a[132:135], a[172:175], v[44:47]
    ds_read_b128 a[124:127], v216 offset:11264
    v_mfma_f32_16x16x32_bf16 v[28:31], a[132:135], a[168:171], v[28:31]
    buffer_load_dwordx4 a[236:239], v3, s[20:23], s43 offen offset:1024 sc1
    s_waitcnt lgkmcnt(4)
    v_mfma_f32_16x16x32_bf16 v[32:35], a[136:139], a[168:171], v[32:35]
    ds_read_b128 a[128:131], v216 offset:12288
    v_mfma_f32_16x16x32_bf16 v[48:51], a[136:139], a[172:175], v[48:51]
    s_waitcnt vmcnt(9)
    s_mov_b32 s91, 0
M_exc:
    v_xor_b32 v14, s12, v18
    v_bfe_u32 v15, v19, 0, 1
    v_xor_b32 v15, 1, v15
    v_or_b32 v14, v14, v15
    v_cmp_ne_u32 vcc, 0, v14
    s_nop 3
    s_cmp_eq_u32 vcc_lo, 0
    s_cbranch_scc1 M_exc_ok
    s_add_u32 s91, s91, 1
    s_cmp_ge_u32 s91, 0x40000
    s_cbranch_scc1 M_exc_ok
    s_sleep 1
    buffer_load_dwordx2 v[18:19], off, s[16:19], s66 sc1
    s_waitcnt vmcnt(0)
    s_branch M_exc
M_exc_ok:
    buffer_load_dwordx4 v[120:123], v13, s[16:19], s65 offen offset:0 sc1
    v_mfma_f32_16x16x32_bf16 v[52:55], a[140:143], a[172:175], v[52:55]
    ds_read_b128 a[132:135], v216 offset:13312
    v_mfma_f32_16x16x32_bf16 v[36:39], a[140:143], a[168:171], v[36:39]
    s_waitcnt lgkmcnt(4)
    v_mfma_f32_16x16x32_bf16 v[24:27], a[112:115], a[176:179], v[24:27]
    ds_read_b128 a[136:139], v216 offset:14336
    v_mfma_f32_16x16x32_bf16 v[40:43], a[112:115], a[180:183], v[40:43]
    buffer_load_dwordx4 a[240:243], v4, s[20:23], s43 offen offset:0 sc1
    buffer_load_dwordx4 v[124:127], v13, s[16:19], s65 offen offset:1024 sc1
    v_mfma_f32_16x16x32_bf16 v[44:47], a[116:119], a[180:183], v[44:47]
    ds_read_b128 a[140:143], v216 offset:15360
    v_mfma_f32_16x16x32_bf16 v[28:31], a[116:119], a[176:179], v[28:31]
    buffer_load_dwordx4 a[244:247], v4, s[20:23], s43 offen offset:1024 sc1
    s_waitcnt lgkmcnt(4)
    s_barrier
    v_mfma_f32_16x16x32_bf16 v[32:35], a[120:123], a[176:179], v[32:35]
    ds_read_b128 a[112:115], v216 offset:16384
    v_mfma_f32_16x16x32_bf16 v[48:51], a[120:123], a[180:183], v[48:51]
    buffer_load_dwordx4 v[128:131], v13, s[16:19], s65 offen offset:2048 sc1
    v_mfma_f32_16x16x32_bf16 v[52:55], a[124:127], a[180:183], v[52:55]
    ds_read_b128 a[116:119], v216 offset:17408
    v_mfma_f32_16x16x32_bf16 v[36:39], a[124:127], a[176:179], v[36:39]
    s_waitcnt lgkmcnt(4)
    v_mfma_f32_16x16x32_bf16 v[24:27], a[128:131], a[184:187], v[24:27]
    ds_read_b128 a[120:123], v216 offset:18432
    v_mfma_f32_16x16x32_bf16 v[40:43], a[128:131], a[188:191], v[40:43]
    buffer_load_dwordx4 a[248:251], v5, s[20:23], s43 offen offset:0 sc1
    buffer_load_dwordx4 v[132:135], v13, s[16:19], s65 offen offset:3072 sc1
    v_mfma_f32_16x16x32_bf16 v[44:47], a[132:135], a[188:191], v[44:47]
    ds_read_b128 a[124:127], v216 offset:19456
    v_mfma_f32_16x16x32_bf16 v[28:31], a[132:135], a[184:187], v[28:31]
    buffer_load_dwordx4 a[252:255], v5, s[20:23], s43 offen offset:1024 sc1
    s_waitcnt lgkmcnt(4)
    v_mfma_f32_16x16x32_bf16 v[32:35], a[136:139], a[184:187], v[32:35]
    ds_read_b128 a[128:131], v216 offset:20480
    v_mfma_f32_16x16x32_bf16 v[48:51], a[136:139], a[188:191], v[48:51]
    v_mfma_f32_16x16x32_bf16 v[52:55], a[140:143], a[188:191], v[52:55]
    ds_read_b128 a[132:135], v216 offset:21504
    v_mfma_f32_16x16x32_bf16 v[36:39], a[140:143], a[184:187], v[36:39]
    s_waitcnt lgkmcnt(4)
    v_mfma_f32_16x16x32_bf16 v[24:27], a[112:115], a[192:195], v[24:27]
    ds_read_b128 a[136:139], v216 offset:22528
    v_mfma_f32_16x16x32_bf16 v[40:43], a[112:115], a[196:199], v[40:43]
    s_mov_b32 s43, 0x1180000
    buffer_load_dwordx4 a[144:147], v2, s[20:23], s43 offen offset:0 sc1
    v_mfma_f32_16x16x32_bf16 v[44:47], a[116:119], a[196:199], v[44:47]
    ds_read_b128 a[140:143], v216 offset:23552
    v_mfma_f32_16x16x32_bf16 v[28:31], a[116:119], a[192:195], v[28:31]
    buffer_load_dwordx4 a[148:151], v2, s[20:23], s43 offen offset:1024 sc1
    s_waitcnt lgkmcnt(4)
    v_mfma_f32_16x16x32_bf16 v[32:35], a[120:123], a[192:195], v[32:35]
    ds_read_b128 a[112:115], v216 offset:24576
    v_mfma_f32_16x16x32_bf16 v[48:51], a[120:123], a[196:199], v[48:51]
    v_mfma_f32_16x16x32_bf16 v[52:55], a[124:127], a[196:199], v[52:55]
    ds_read_b128 a[116:119], v216 offset:25600
    v_mfma_f32_16x16x32_bf16 v[36:39], a[124:127], a[192:195], v[36:39]
    s_waitcnt lgkmcnt(4)
    v_mfma_f32_16x16x32_bf16 v[24:27], a[128:131], a[200:203], v[24:27]
    ds_read_b128 a[120:123], v216 offset:26624
    v_mfma_f32_16x16x32_bf16 v[40:43], a[128:131], a[204:207], v[40:43]
    buffer_load_dwordx4 a[152:155], v3, s[20:23], s43 offen offset:0 sc1
    v_mfma_f32_16x16x32_bf16 v[44:47], a[132:135], a[204:207], v[44:47]
    ds_read_b128 a[124:127], v216 offset:27648
    v_mfma_f32_16x16x32_bf16 v[28:31], a[132:135], a[200:203], v[28:31]
    buffer_load_dwordx4 a[156:159], v3, s[20:23], s43 offen offset:1024 sc1
    s_waitcnt lgkmcnt(4)
    v_mfma_f32_16x16x32_bf16 v[32:35], a[136:139], a[200:203], v[32:35]
    ds_read_b128 a[128:131], v216 offset:28672
    v_mfma_f32_16x16x32_bf16 v[48:51], a[136:139], a[204:207], v[48:51]
    v_mfma_f32_16x16x32_bf16 v[52:55], a[140:143], a[204:207], v[52:55]
    ds_read_b128 a[132:135], v216 offset:29696
    v_mfma_f32_16x16x32_bf16 v[36:39], a[140:143], a[200:203], v[36:39]
    s_waitcnt vmcnt(18) lgkmcnt(4)
    v_mfma_f32_16x16x32_bf16 v[24:27], a[112:115], a[208:211], v[24:27]
    ds_read_b128 a[136:139], v216 offset:30720
    v_mfma_f32_16x16x32_bf16 v[40:43], a[112:115], a[212:215], v[40:43]
    buffer_load_dwordx4 a[160:163], v4, s[20:23], s43 offen offset:0 sc1
    v_mfma_f32_16x16x32_bf16 v[44:47], a[116:119], a[212:215], v[44:47]
    ds_read_b128 a[140:143], v216 offset:31744
    v_mfma_f32_16x16x32_bf16 v[28:31], a[116:119], a[208:211], v[28:31]
    buffer_load_dwordx4 a[164:167], v4, s[20:23], s43 offen offset:1024 sc1
    s_waitcnt lgkmcnt(4)
    v_mfma_f32_16x16x32_bf16 v[32:35], a[120:123], a[208:211], v[32:35]
    ds_read_b128 a[112:115], v216 offset:32768
    v_mfma_f32_16x16x32_bf16 v[48:51], a[120:123], a[212:215], v[48:51]
    v_mfma_f32_16x16x32_bf16 v[52:55], a[124:127], a[212:215], v[52:55]
    ds_read_b128 a[116:119], v216 offset:33792
    v_mfma_f32_16x16x32_bf16 v[36:39], a[124:127], a[208:211], v[36:39]
    s_waitcnt vmcnt(18) lgkmcnt(4)
    v_mfma_f32_16x16x32_bf16 v[24:27], a[128:131], a[216:219], v[24:27]
    ds_read_b128 a[120:123], v216 offset:34816
    s_waitcnt vmcnt(7)
    v_lshlrev_b32 v152, 16, v120
    v_mfma_f32_16x16x32_bf16 v[40:43], a[128:131], a[220:223], v[40:43]
    buffer_load_dwordx4 a[168:171], v5, s[20:23], s43 offen offset:0 sc1
    v_and_b32 v153, 0xffff0000, v120
    v_lshlrev_b32 v154, 16, v121
    v_mfma_f32_16x16x32_bf16 v[44:47], a[132:135], a[220:223], v[44:47]
    ds_read_b128 a[124:127], v216 offset:35840
    v_and_b32 v155, 0xffff0000, v121
    v_lshlrev_b32 v156, 16, v122
    v_mfma_f32_16x16x32_bf16 v[28:31], a[132:135], a[216:219], v[28:31]
    buffer_load_dwordx4 a[172:175], v5, s[20:23], s43 offen offset:1024 sc1
    v_and_b32 v157, 0xffff0000, v122
    v_lshlrev_b32 v158, 16, v123
    v_and_b32 v159, 0xffff0000, v123
    s_waitcnt lgkmcnt(4)
    v_mfma_f32_16x16x32_bf16 v[32:35], a[136:139], a[216:219], v[32:35]
    ds_read_b128 a[128:131], v216 offset:36864
    v_lshlrev_b32 v160, 16, v124
    v_and_b32 v161, 0xffff0000, v124
    v_mfma_f32_16x16x32_bf16 v[48:51], a[136:139], a[220:223], v[48:51]
    v_lshlrev_b32 v162, 16, v125
    v_and_b32 v163, 0xffff0000, v125
    v_lshlrev_b32 v164, 16, v126
    v_mfma_f32_16x16x32_bf16 v[52:55], a[140:143], a[220:223], v[52:55]
    ds_read_b128 a[132:135], v216 offset:37888
    v_and_b32 v165, 0xffff0000, v126
    v_lshlrev_b32 v166, 16, v127
    v_mfma_f32_16x16x32_bf16 v[36:39], a[140:143], a[216:219], v[36:39]
    v_and_b32 v167, 0xffff0000, v127
    v_lshlrev_b32 v168, 16, v128
    s_waitcnt lgkmcnt(4)
    v_mfma_f32_16x16x32_bf16 v[24:27], a[112:115], a[224:227], v[24:27]
    ds_read_b128 a[136:139], v216 offset:38912
    v_and_b32 v169, 0xffff0000, v128
    v_lshlrev_b32 v170, 16, v129
    v_mfma_f32_16x16x32_bf16 v[40:43], a[112:115], a[228:231], v[40:43]
    v_and_b32 v171, 0xffff0000, v129
    v_lshlrev_b32 v172, 16, v130
    v_and_b32 v173, 0xffff0000, v130
    v_mfma_f32_16x16x32_bf16 v[44:47], a[116:119], a[228:231], v[44:47]
    ds_read_b128 a[140:143], v216 offset:39936
    v_lshlrev_b32 v174, 16, v131
    v_and_b32 v175, 0xffff0000, v131
    v_mfma_f32_16x16x32_bf16 v[28:31], a[116:119], a[224:227], v[28:31]
    v_lshlrev_b32 v176, 16, v132
    v_and_b32 v177, 0xffff0000, v132
    v_lshlrev_b32 v178, 16, v133
    s_waitcnt lgkmcnt(4)
    v_mfma_f32_16x16x32_bf16 v[32:35], a[120:123], a[224:227], v[32:35]
    ds_read_b128 a[112:115], v216 offset:40960
    v_and_b32 v179, 0xffff0000, v133
    v_lshlrev_b32 v180, 16, v134
    v_mfma_f32_16x16x32_bf16 v[48:51], a[120:123], a[228:231], v[48:51]
    v_and_b32 v181, 0xffff0000, v134
    v_lshlrev_b32 v182, 16, v135
    v_and_b32 v183, 0xffff0000, v135
    v_mfma_f32_16x16x32_bf16 v[52:55], a[124:127], a[228:231], v[52:55]
    ds_read_b128 a[116:119], v216 offset:41984
    v_add_f32 v88, v152, v88
    v_add_f32 v89, v153, v89
    v_add_f32 v90, v154, v90
    v_add_f32 v91, v155, v91
    v_mfma_f32_16x16x32_bf16 v[36:39], a[124:127], a[224:227], v[36:39]
    v_add_f32 v92, v156, v92
    v_add_f32 v93, v157, v93
    v_add_f32 v94, v158, v94
    v_add_f32 v95, v159, v95
    s_waitcnt lgkmcnt(4)
    v_mfma_f32_16x16x32_bf16 v[24:27], a[128:131], a[232:235], v[24:27]
    ds_read_b128 a[120:123], v216 offset:43008
    v_add_f32 v96, v160, v96
    v_add_f32 v97, v161, v97
    v_add_f32 v98, v162, v98
    v_add_f32 v99, v163, v99
    v_add_f32 v100, v164, v100
    v_mfma_f32_16x16x32_bf16 v[40:43], a[128:131], a[236:239], v[40:43]
    v_add_f32 v101, v165, v101
    v_add_f32 v102, v166, v102
    v_add_f32 v103, v167, v103
    v_add_f32 v104, v168, v104
    v_add_f32 v105, v169, v105
    v_mfma_f32_16x16x32_bf16 v[44:47], a[132:135], a[236:239], v[44:47]
    ds_read_b128 a[124:127], v216 offset:44032
    v_add_f32 v106, v170, v106
    v_add_f32 v107, v171, v107
    v_add_f32 v108, v172, v108
    v_add_f32 v109, v173, v109
    v_add_f32 v110, v174, v110
    v_mfma_f32_16x16x32_bf16 v[28:31], a[132:135], a[232:235], v[28:31]
    v_add_f32 v111, v175, v111
    v_add_f32 v112, v176, v112
    v_add_f32 v113, v177, v113
    v_add_f32 v114, v178, v114
    v_add_f32 v115, v179, v115
    s_waitcnt lgkmcnt(4)
    v_mfma_f32_16x16x32_bf16 v[32:35], a[136:139], a[232:235], v[32:35]
    ds_read_b128 a[128:131], v216 offset:45056
    v_add_f32 v116, v180, v116
    v_add_f32 v117, v181, v117
    v_add_f32 v118, v182, v118
    v_add_f32 v119, v183, v119
    v_mul_f32 v152, s36, v88
    v_mfma_f32_16x16x32_bf16 v[48:51], a[136:139], a[236:239], v[48:51]
    v_mul_f32 v153, s36, v89
    v_mul_f32 v154, s36, v90
    v_mul_f32 v155, s36, v91
    v_mul_f32 v156, s36, v92
    v_mul_f32 v157, s36, v93
    v_mfma_f32_16x16x32_bf16 v[52:55], a[140:143], a[236:239], v[52:55]
    ds_read_b128 a[132:135], v216 offset:46080
    v_mul_f32 v158, s36, v94
    v_mul_f32 v159, s36, v95
    v_mul_f32 v160, s36, v96
    v_mul_f32 v161, s36, v97
    v_mfma_f32_16x16x32_bf16 v[36:39], a[140:143], a[232:235], v[36:39]
    v_mul_f32 v162, s36, v98
    v_mul_f32 v163, s36, v99
    v_mul_f32 v164, s36, v100
    v_mul_f32 v165, s36, v101
    s_waitcnt lgkmcnt(4)
    v_mfma_f32_16x16x32_bf16 v[24:27], a[112:115], a[240:243], v[24:27]
    ds_read_b128 a[136:139], v216 offset:47104
    v_mul_f32 v166, s36, v102
    v_mul_f32 v167, s36, v103
    v_mul_f32 v168, s36, v104
    v_mul_f32 v169, s36, v105
    v_mul_f32 v170, s36, v106
    v_mfma_f32_16x16x32_bf16 v[40:43], a[112:115], a[244:247], v[40:43]
    v_mul_f32 v171, s36, v107
    v_mul_f32 v172, s36, v108
    v_mul_f32 v173, s36, v109
    v_mul_f32 v174, s36, v110
    v_mul_f32 v175, s36, v111
    v_mfma_f32_16x16x32_bf16 v[44:47], a[116:119], a[244:247], v[44:47]
    ds_read_b128 a[140:143], v216 offset:48128
    v_mul_f32 v176, s36, v112
    v_mul_f32 v177, s36, v113
    v_mul_f32 v178, s36, v114
    v_mul_f32 v179, s36, v115
    v_mfma_f32_16x16x32_bf16 v[28:31], a[116:119], a[240:243], v[28:31]
    v_mul_f32 v180, s36, v116
    v_mul_f32 v181, s36, v117
    v_mul_f32 v182, s36, v118
    v_mul_f32 v183, s36, v119
    v_exp_f32 v152, v152
    s_waitcnt lgkmcnt(4)
    s_barrier
    v_mfma_f32_16x16x32_bf16 v[32:35], a[120:123], a[240:243], v[32:35]
    ds_read_b128 a[112:115], v13 offset:0
    v_exp_f32 v153, v153
    v_exp_f32 v154, v154
    v_mfma_f32_16x16x32_bf16 v[48:51], a[120:123], a[244:247], v[48:51]
    v_exp_f32 v155, v155
    v_exp_f32 v156, v156
    v_exp_f32 v157, v157
    v_mfma_f32_16x16x32_bf16 v[52:55], a[124:127], a[244:247], v[52:55]
    ds_read_b128 a[116:119], v13 offset:1024
    v_exp_f32 v158, v158
    v_exp_f32 v159, v159
    v_mfma_f32_16x16x32_bf16 v[36:39], a[124:127], a[240:243], v[36:39]
    v_exp_f32 v160, v160
    v_exp_f32 v161, v161
    s_waitcnt vmcnt(8) lgkmcnt(4)
    v_mfma_f32_16x16x32_bf16 v[24:27], a[128:131], a[248:251], v[24:27]
    ds_read_b128 a[120:123], v13 offset:2048
    v_exp_f32 v162, v162
    v_exp_f32 v163, v163
    v_mfma_f32_16x16x32_bf16 v[40:43], a[128:131], a[252:255], v[40:43]
    v_exp_f32 v164, v164
    v_exp_f32 v165, v165
    v_exp_f32 v166, v166
    v_mfma_f32_16x16x32_bf16 v[44:47], a[132:135], a[252:255], v[44:47]
    ds_read_b128 a[124:127], v13 offset:3072
    v_exp_f32 v167, v167
    v_exp_f32 v168, v168
    v_mfma_f32_16x16x32_bf16 v[28:31], a[132:135], a[248:251], v[28:31]
    v_exp_f32 v169, v169
    v_exp_f32 v170, v170
    v_exp_f32 v171, v171
    s_waitcnt lgkmcnt(4)
    v_mfma_f32_16x16x32_bf16 v[32:35], a[136:139], a[248:251], v[32:35]
    ds_read_b128 a[128:131], v13 offset:4096
    v_exp_f32 v172, v172
    v_exp_f32 v173, v173
    v_mfma_f32_16x16x32_bf16 v[48:51], a[136:139], a[252:255], v[48:51]
    v_exp_f32 v174, v174
    v_exp_f32 v175, v175
    v_mfma_f32_16x16x32_bf16 v[52:55], a[140:143], a[252:255], v[52:55]
    ds_read_b128 a[132:135], v13 offset:5120
    v_exp_f32 v176, v176
    v_exp_f32 v177, v177
    v_mfma_f32_16x16x32_bf16 v[36:39], a[140:143], a[248:251], v[36:39]
    v_exp_f32 v178, v178
    v_exp_f32 v179, v179
    v_exp_f32 v180, v180
    s_waitcnt vmcnt(6) lgkmcnt(4)
    v_mfma_f32_16x16x32_bf16 v[24:27], a[112:115], a[144:147], v[24:27]
    ds_read_b128 a[136:139], v13 offset:6144
    v_exp_f32 v181, v181
    v_exp_f32 v182, v182
    v_exp_f32 v183, v183
    v_mfma_f32_16x16x32_bf16 v[40:43], a[112:115], a[148:151], v[40:43]
    v_add_f32 v152, 1.0, v152
    v_add_f32 v153, 1.0, v153
    v_add_f32 v154, 1.0, v154
    v_add_f32 v155, 1.0, v155
    v_mfma_f32_16x16x32_bf16 v[44:47], a[116:119], a[148:151], v[44:47]
    ds_read_b128 a[140:143], v13 offset:7168
    v_add_f32 v156, 1.0, v156
    v_add_f32 v157, 1.0, v157
    v_add_f32 v158, 1.0, v158
    v_add_f32 v159, 1.0, v159
    v_add_f32 v160, 1.0, v160
    v_mfma_f32_16x16x32_bf16 v[28:31], a[116:119], a[144:147], v[28:31]
    v_add_f32 v161, 1.0, v161
    v_add_f32 v162, 1.0, v162
    v_add_f32 v163, 1.0, v163
    v_add_f32 v164, 1.0, v164
    v_add_f32 v165, 1.0, v165
    s_waitcnt lgkmcnt(4)
    v_mfma_f32_16x16x32_bf16 v[32:35], a[120:123], a[144:147], v[32:35]
    ds_read_b128 a[112:115], v13 offset:8192
    v_add_f32 v166, 1.0, v166
    v_add_f32 v167, 1.0, v167
    v_add_f32 v168, 1.0, v168
    v_add_f32 v169, 1.0, v169
    v_mfma_f32_16x16x32_bf16 v[48:51], a[120:123], a[148:151], v[48:51]
    v_add_f32 v170, 1.0, v170
    v_add_f32 v171, 1.0, v171
    v_add_f32 v172, 1.0, v172
    v_add_f32 v173, 1.0, v173
    v_mfma_f32_16x16x32_bf16 v[52:55], a[124:127], a[148:151], v[52:55]
    ds_read_b128 a[116:119], v13 offset:9216
    v_add_f32 v174, 1.0, v174
    v_add_f32 v175, 1.0, v175
    v_add_f32 v176, 1.0, v176
    v_add_f32 v177, 1.0, v177
    v_add_f32 v178, 1.0, v178
    v_mfma_f32_16x16x32_bf16 v[36:39], a[124:127], a[144:147], v[36:39]
    v_add_f32 v179, 1.0, v179
    v_add_f32 v180, 1.0, v180
    v_add_f32 v181, 1.0, v181
    v_add_f32 v182, 1.0, v182
    v_add_f32 v183, 1.0, v183
    s_waitcnt vmcnt(4) lgkmcnt(4)
    v_mfma_f32_16x16x32_bf16 v[24:27], a[128:131], a[152:155], v[24:27]
    ds_read_b128 a[120:123], v13 offset:10240
    v_rcp_f32 v152, v152
    v_rcp_f32 v153, v153
    v_mfma_f32_16x16x32_bf16 v[40:43], a[128:131], a[156:159], v[40:43]
    v_rcp_f32 v154, v154
    v_rcp_f32 v155, v155
    v_rcp_f32 v156, v156
    v_mfma_f32_16x16x32_bf16 v[44:47], a[132:135], a[156:159], v[44:47]
    ds_read_b128 a[124:127], v13 offset:11264
    v_rcp_f32 v157, v157
    v_rcp_f32 v158, v158
    v_mfma_f32_16x16x32_bf16 v[28:31], a[132:135], a[152:155], v[28:31]
    v_rcp_f32 v159, v159
    v_rcp_f32 v160, v160
    v_rcp_f32 v161, v161
    s_waitcnt lgkmcnt(4)
    v_mfma_f32_16x16x32_bf16 v[32:35], a[136:139], a[152:155], v[32:35]
    ds_read_b128 a[128:131], v13 offset:12288
    v_rcp_f32 v162, v162
    v_rcp_f32 v163, v163
    v_mfma_f32_16x16x32_bf16 v[48:51], a[136:139], a[156:159], v[48:51]
    v_rcp_f32 v164, v164
    v_rcp_f32 v165, v165
    v_mfma_f32_16x16x32_bf16 v[52:55], a[140:143], a[156:159], v[52:55]
    ds_read_b128 a[132:135], v13 offset:13312
    v_rcp_f32 v166, v166
    v_rcp_f32 v167, v167
    v_mfma_f32_16x16x32_bf16 v[36:39], a[140:143], a[152:155], v[36:39]
    v_rcp_f32 v168, v168
    v_rcp_f32 v169, v169
    v_rcp_f32 v170, v170
    s_waitcnt vmcnt(2) lgkmcnt(4)
    v_mfma_f32_16x16x32_bf16 v[24:27], a[112:115], a[160:163], v[24:27]
    ds_read_b128 a[136:139], v13 offset:14336
    v_rcp_f32 v171, v171
    v_rcp_f32 v172, v172
    v_mfma_f32_16x16x32_bf16 v[40:43], a[112:115], a[164:167], v[40:43]
    v_rcp_f32 v173, v173
    v_rcp_f32 v174, v174
    v_rcp_f32 v175, v175
    v_mfma_f32_16x16x32_bf16 v[44:47], a[116:119], a[164:167], v[44:47]
    ds_read_b128 a[140:143], v13 offset:15360
    v_rcp_f32 v176, v176
    v_rcp_f32 v177, v177
    v_mfma_f32_16x16x32_bf16 v[28:31], a[116:119], a[160:163], v[28:31]
    v_rcp_f32 v178, v178
    v_rcp_f32 v179, v179
    v_rcp_f32 v180, v180
    s_waitcnt lgkmcnt(4)
    v_mfma_f32_16x16x32_bf16 v[32:35], a[120:123], a[160:163], v[32:35]
    v_rcp_f32 v181, v181
    v_rcp_f32 v182, v182
    v_mfma_f32_16x16x32_bf16 v[48:51], a[120:123], a[164:167], v[48:51]
    v_rcp_f32 v183, v183
    v_mul_f32 v88, v152, v88
    v_mul_f32 v89, v153, v89
    v_mfma_f32_16x16x32_bf16 v[52:55], a[124:127], a[164:167], v[52:55]
    v_mul_f32 v90, v154, v90
    v_mul_f32 v91, v155, v91
    v_mul_f32 v92, v156, v92
    v_mul_f32 v93, v157, v93
    v_mul_f32 v94, v158, v94
    v_mfma_f32_16x16x32_bf16 v[36:39], a[124:127], a[160:163], v[36:39]
    v_mul_f32 v95, v159, v95
    v_mul_f32 v96, v160, v96
    v_mul_f32 v97, v161, v97
    v_mul_f32 v98, v162, v98
    v_mul_f32 v99, v163, v99
    s_waitcnt vmcnt(0) lgkmcnt(2)
    v_mfma_f32_16x16x32_bf16 v[24:27], a[128:131], a[168:171], v[24:27]
    v_mul_f32 v100, v164, v100
    v_mul_f32 v101, v165, v101
    v_mul_f32 v102, v166, v102
    v_mul_f32 v103, v167, v103
    v_mul_f32 v104, v168, v104
    v_mfma_f32_16x16x32_bf16 v[40:43], a[128:131], a[172:175], v[40:43]
    v_mul_f32 v105, v169, v105
    v_mul_f32 v106, v170, v106
    v_mul_f32 v107, v171, v107
    v_mul_f32 v108, v172, v108
    v_mul_f32 v109, v173, v109
    v_mfma_f32_16x16x32_bf16 v[44:47], a[132:135], a[172:175], v[44:47]
    v_mul_f32 v110, v174, v110
    v_mul_f32 v111, v175, v111
    v_mul_f32 v112, v176, v112
    v_mul_f32 v113, v177, v113
    v_mul_f32 v114, v178, v114
    v_mfma_f32_16x16x32_bf16 v[28:31], a[132:135], a[168:171], v[28:31]
    v_mul_f32 v115, v179, v115
    v_mul_f32 v116, v180, v116
    v_mul_f32 v117, v181, v117
    v_mul_f32 v118, v182, v118
    v_mul_f32 v119, v183, v119
    s_waitcnt lgkmcnt(0)
    v_mfma_f32_16x16x32_bf16 v[32:35], a[136:139], a[168:171], v[32:35]
    v_mfma_f32_16x16x32_bf16 v[48:51], a[136:139], a[172:175], v[48:51]
    v_mfma_f32_16x16x32_bf16 v[52:55], a[140:143], a[172:175], v[52:55]
    v_mfma_f32_16x16x32_bf16 v[36:39], a[140:143], a[168:171], v[36:39]
    s_nop 4
    v_pk_fma_f32 v[24:25], v[24:25], v[88:89], v[184:185]
    v_pk_fma_f32 v[26:27], v[26:27], v[90:91], v[186:187]
    v_pk_fma_f32 v[28:29], v[28:29], v[92:93], v[188:189]
    v_pk_fma_f32 v[30:31], v[30:31], v[94:95], v[190:191]
    v_cvt_pk_bf16_f32 v72, v24, v25
    v_cvt_pk_bf16_f32 v73, v26, v27
    v_cvt_pk_bf16_f32 v74, v28, v29
    v_cvt_pk_bf16_f32 v75, v30, v31
    ds_write_b128 v217, v[72:75] offset:0
    v_pk_fma_f32 v[32:33], v[32:33], v[96:97], v[192:193]
    v_pk_fma_f32 v[34:35], v[34:35], v[98:99], v[194:195]
    v_pk_fma_f32 v[36:37], v[36:37], v[100:101], v[196:197]
    v_pk_fma_f32 v[38:39], v[38:39], v[102:103], v[198:199]
    v_cvt_pk_bf16_f32 v76, v32, v33
    v_cvt_pk_bf16_f32 v77, v34, v35
    v_cvt_pk_bf16_f32 v78, v36, v37
    v_cvt_pk_bf16_f32 v79, v38, v39
    ds_write_b128 v218, v[76:79] offset:0
    s_mov_b32 s45, 16384
    s_mov_b32 s46, 32768
    s_mov_b32 s64, 49152
    ds_read_b128 v[152:155], v219 offset:0
    ds_read_b128 v[156:159], v219 offset:1024
    v_pk_fma_f32 v[40:41], v[40:41], v[104:105], v[200:201]
    v_pk_fma_f32 v[42:43], v[42:43], v[106:107], v[202:203]
    v_pk_fma_f32 v[44:45], v[44:45], v[108:109], v[204:205]
    v_pk_fma_f32 v[46:47], v[46:47], v[110:111], v[206:207]
    v_cvt_pk_bf16_f32 v80, v40, v41
    v_cvt_pk_bf16_f32 v81, v42, v43
    v_cvt_pk_bf16_f32 v82, v44, v45
    v_cvt_pk_bf16_f32 v83, v46, v47
    ds_write_b128 v217, v[80:83] offset:2048
    v_pk_fma_f32 v[48:49], v[48:49], v[112:113], v[208:209]
    v_pk_fma_f32 v[50:51], v[50:51], v[114:115], v[210:211]
    v_pk_fma_f32 v[52:53], v[52:53], v[116:117], v[212:213]
    v_pk_fma_f32 v[54:55], v[54:55], v[118:119], v[214:215]
    v_cvt_pk_bf16_f32 v84, v48, v49
    v_cvt_pk_bf16_f32 v85, v50, v51
    v_cvt_pk_bf16_f32 v86, v52, v53
    v_cvt_pk_bf16_f32 v87, v54, v55
    ds_write_b128 v218, v[84:87] offset:2048
    ds_read_b128 v[160:163], v219 offset:2048
    ds_read_b128 v[164:167], v219 offset:3072
    s_waitcnt lgkmcnt(5)
    buffer_store_dwordx4 v[152:155], v224, s[32:35], 0 offen sc0 sc1 nt
    s_waitcnt lgkmcnt(4)
    buffer_store_dwordx4 v[156:159], v224, s[32:35], s45 offen sc0 sc1 nt
    s_waitcnt lgkmcnt(1)
    buffer_store_dwordx4 v[160:163], v224, s[32:35], s46 offen sc0 sc1 nt
    s_waitcnt lgkmcnt(0)
    buffer_store_dwordx4 v[164:167], v224, s[32:35], s64 offen sc0 sc1 nt
M_end:
    s_endpgm
.p2align 8
.fill 5309, 4, 0xbf810000
.section .rodata,"a"
.p2align 6
.amdhsa_kernel recurrent_scan__linear_attn_block__swiglu_ffn__prompt_kernel
  .amdhsa_next_free_vgpr 512
  .amdhsa_next_free_sgpr 102
  .amdhsa_accum_offset 256
  .amdhsa_group_segment_fixed_size 0
  .amdhsa_kernarg_size 80
  .amdhsa_user_sgpr_count 2
  .amdhsa_user_sgpr_kernarg_segment_ptr 1
  .amdhsa_system_sgpr_workgroup_id_x 1
.end_amdhsa_kernel
```
